```python
import torch

def _softmax(x, axis=-1):
    return torch.softmax(x, dim=axis)
def _gelu(x):
    return torch.nn.functional.gelu(x, approximate="tanh")
def _silu(x):
    return torch.nn.functional.silu(x)
def _sigmoid(x):
    return torch.sigmoid(x)
def _layernorm(x, axis=-1, eps=1e-5):
    m = x.mean(dim=axis, keepdim=True)
    v = x.var(dim=axis, keepdim=True, unbiased=False)
    return (x - m) / torch.sqrt(v + eps)
def _scatter_add(tgt, idx, src, axis=0):
    return tgt.clone().index_add_(axis, idx, src)
def _segment_sum(src, seg, n):
    out = torch.zeros((n,) + src.shape[1:], dtype=src.dtype)
    return out.index_add_(0, seg, src)
def _pad(x, pw):
    flat = tuple(v for pair in reversed(pw) for v in pair)
    return torch.nn.functional.pad(x, flat)

kernel_name = 'interleave_layers__softmax_full_mha__ssm_conv_h3__prompt'

def setup_inputs():

    _w = (lambda a: (lambda t: t.to(torch.bfloat16) if t.is_floating_point() else t)(torch.as_tensor(a)))
    def _A_setup():
        B, S, D = 1, 2048, 576
        return {
            "x": _w((lambda *s: torch.randn(*s, dtype=torch.bfloat16) * 0.05)(B, S, D)),
            "wqkv": _w((lambda *s: torch.randn(*s, dtype=torch.bfloat16) * 0.05)(D, 3 * D)),
            "wo": _w((lambda *s: torch.randn(*s, dtype=torch.bfloat16) * 0.05)(D, D)),
        }
    _A_in = _A_setup()

    def _B_setup():
        B, S, D = 1, 2048, 576
        ks = 4
        return {
            "q": _w((lambda *s: torch.randn(*s, dtype=torch.bfloat16) * 0.05)(B, S, D)),
            "k": _w((lambda *s: torch.randn(*s, dtype=torch.bfloat16) * 0.4)(B, S, D)),
            "v": _w((lambda *s: torch.randn(*s, dtype=torch.bfloat16) * 0.4)(B, S, D)),
            "shift_k": _w((lambda *s: torch.randn(*s, dtype=torch.bfloat16) * 0.4)(D, ks) * 0.5),
            "ssm_k": _w((lambda *s: torch.randn(*s, dtype=torch.bfloat16) * 0.8)(D, S) * (1.0 / S ** 0.5)),
            "ssm_D": _w((lambda *s: torch.randn(*s, dtype=torch.bfloat16) * 0.4)(D)),
        }
    _B_in = _B_setup()

    return {
        "A_x": _A_in["x"],
        "A_wqkv": _A_in["wqkv"],
        "A_wo": _A_in["wo"],
        "B_q": _B_in["q"],
        "B_k": _B_in["k"],
        "B_v": _B_in["v"],
        "B_shift_k": _B_in["shift_k"],
        "B_ssm_k": _B_in["ssm_k"],
        "B_ssm_D": _B_in["ssm_D"],
    }

def reference(A_x, A_wqkv, A_wo, B_q, B_k, B_v, B_shift_k, B_ssm_k, B_ssm_D):
    def _A_ref(x, wqkv, wo):
        B, S, D = x.shape
        H = 32; Dh = D // H
        qkv = (lambda x, *d: x.permute(*d))((x @ wqkv).reshape(B, S, 3, H, Dh), 2, 0, 3, 1, 4)
        q, k, v = qkv[0], qkv[1], qkv[2]
        scale = Dh ** -0.5
        scores = torch.einsum("bhqd,bhkd->bhqk", q, k) * scale
        p = _softmax(scores, axis=-1)
        o = torch.einsum("bhqk,bhkd->bhqd", p, v)
        return (lambda x, *d: x.permute(*d))(o, 0, 2, 1, 3).reshape(B, S, D) @ wo

    def _B_ref(q, k, v, shift_k, ssm_k, ssm_D):
        B, S, D = q.shape
        ks = shift_k.shape[-1]
        k_pad = _pad(k, ((0, 0), (ks - 1, 0), (0, 0)))
        k_shift = torch.zeros_like(k)
        for t in range(ks):
            k_shift = k_shift + k_pad[:, t:t + S, :] * shift_k[:, ks - 1 - t][None, None, :]
        kv = k_shift * v
        L = 2 * S
        kv_pad = _pad(kv, ((0, 0), (0, S), (0, 0)))
        kf_pad = _pad(ssm_k, ((0, 0), (0, S)))
        kv_f = (lambda x, axes=(-2,-1): torch.fft.rfft2(x.float(), dim=axes))(kv_pad[:, None, :, :], axes=(1, 2))
        kf_f = (lambda x, axes=(-2,-1): torch.fft.rfft2(x.float(), dim=axes))(kf_pad[:, None, :], axes=(1, 2))
        kf_f = (lambda x, *d: x.permute(*d))(kf_f, 1, 2, 0)
        y_f = kv_f * kf_f[None, :, :, :]
        y = (lambda x, s, axes=(-2,-1): torch.fft.irfft2(x, s=s, dim=axes).to(torch.bfloat16))(y_f, (1, L), axes=(1, 2))[:, 0, :S, :]
        y = y + kv * ssm_D[None, None, :]
        return q * y

    x = A_x
    x = x + _A_ref(_layernorm(x, axis=-1), A_wqkv, A_wo)
    x = x + _B_ref(_layernorm(x, axis=-1), B_k, B_v, B_shift_k, B_ssm_k, B_ssm_D)
    x = x + _A_ref(_layernorm(x, axis=-1), A_wqkv, A_wo)
    x = x + _B_ref(_layernorm(x, axis=-1), B_k, B_v, B_shift_k, B_ssm_k, B_ssm_D)
    return x
```

```asm
; @launch grid=(256,1,1) block=(512,1,1) lds=163840
.amdgcn_target "amdgcn-amd-amdhsa--gfx950"
.text
.globl interleave_layers__softmax_full_mha__ssm_conv_h3__prompt_kernel
.p2align 8
.type interleave_layers__softmax_full_mha__ssm_conv_h3__prompt_kernel,@function
interleave_layers__softmax_full_mha__ssm_conv_h3__prompt_kernel:
    s_cmp_ge_u32 s2, 256
    s_cbranch_scc1 M_END
    s_load_dwordx2 s[4:5], s[0:1], 0
    s_load_dwordx2 s[6:7], s[0:1], 88
    v_lshrrev_b32 v2, 6, v0
    v_and_b32 v1, 63, v0
    v_readfirstlane_b32 s22, v2
    s_waitcnt lgkmcnt(0)
    s_add_u32 s56, s6, 31211520
    s_addc_u32 s57, s7, 0
    s_load_dword s60, s[56:57], 0
    s_mov_b32 s12, s6
    s_mov_b32 s13, s7
    s_mov_b32 s14, 0x1dc5000
    s_mov_b32 s15, 0x20000
    s_mov_b32 s61, 0
    s_mov_b32 s62, 0
    s_mov_b32 s63, 0
    s_mov_b32 s64, 0
    s_waitcnt lgkmcnt(0)
    s_mul_i32 s60, s60, 0x9e3779b1
    s_add_u32 s60, s60, 0x7f4a7c15
    s_and_b32 s20, s2, 7
    s_lshr_b32 s21, s2, 3
    s_lshr_b32 s23, s20, 1
    s_lshl_b32 s23, s23, 2
    s_lshr_b32 s24, s21, 3
    s_add_u32 s23, s23, s24
    s_and_b32 s24, s20, 1
    s_lshl_b32 s24, s24, 3
    s_and_b32 s25, s21, 7
    s_add_u32 s24, s24, s25
    s_and_b32 s25, s22, 3
    s_mul_i32 s26, s23, 147456
    s_lshl_b32 s28, s24, 2
    s_add_u32 s28, s28, s25
    s_mul_i32 s28, s28, 36864
    s_lshl_b32 s29, s25, 12
    s_and_b32 s27, s24, 7
    s_and_b32 s30, s23, 3
    s_lshl_b32 s30, s30, 1
    s_add_u32 s27, s27, s30
    s_sub_u32 s30, s27, 9
    s_cmp_ge_u32 s27, 9
    s_cselect_b32 s27, s30, s27
    v_and_b32 v1, 63, v0
    v_lshlrev_b32 v248, 4, v1
    v_and_b32 v249, 31, v1
    v_lshrrev_b32 v250, 5, v1
    s_cmp_ge_u32 s22, 4
    s_cbranch_scc1 A_HELP
    s_load_dwordx2 s[8:9], s[0:1], 8
    s_waitcnt lgkmcnt(0)
    s_mov_b32 s10, 1990656
    s_mov_b32 s11, 0x20000
    s_lshr_b32 s20, s2, 4
    s_bfe_u32 s21, s2, 0x20002
    s_and_b32 s23, s2, 3
    v_and_b32 v3, 31, v1
    v_lshrrev_b32 v4, 5, v1
    s_mul_i32 s24, s20, 36
    v_lshrrev_b32 v5, 4, v3
    v_mul_u32_u24 v5, 18, v5
    s_cmp_eq_u32 s21, 3
    s_cbranch_scc1 A_WT3
    s_cmp_eq_u32 s21, 2
    s_cbranch_scc1 A_WT2
    v_bfe_u32 v6, v3, 2, 1
    v_lshlrev_b32 v6, 3, v6
    v_bfe_u32 v7, v3, 3, 1
    v_lshl_add_u32 v6, v7, 2, v6
    v_and_b32 v7, 3, v3
    v_add3_u32 v6, v6, v7, v5
    s_mul_i32 s25, s21, 576
    s_add_u32 s25, s25, s24
    v_add_u32 v6, s25, v6
    v_lshlrev_b32 v6, 1, v6
    s_branch A_WD
A_WT2:
    v_and_b32 v6, 15, v3
    v_add_u32 v6, v6, v5
    s_add_u32 s25, s24, 1152
    v_add_u32 v6, s25, v6
    v_lshlrev_b32 v6, 1, v6
    s_branch A_WD
A_WT3:
    v_lshrrev_b32 v6, 2, v3
    v_mul_u32_u24 v6, 576, v6
    v_bfe_u32 v7, v3, 1, 1
    v_mul_u32_u24 v7, 18, v7
    v_and_b32 v8, 1, v3
    v_add3_u32 v6, v6, v7, v8
    s_add_u32 s25, s24, 16
    v_add_u32 v6, s25, v6
    v_lshlrev_b32 v6, 1, v6
    v_cmp_gt_u32 vcc, 12, v3
    v_mov_b32 v7, 0x40000000
    s_nop 0
    v_cndmask_b32 v6, v7, v6, vcc
A_WD:
    v_mul_u32_u24 v7, 27648, v4
    v_add_u32 v6, v6, v7
    s_lshl_b32 s25, s22, 1
    s_add_u32 s25, s25, 1
    s_cmp_eq_u32 s22, 0
    s_cselect_b32 s25, 0, s25
    s_mul_i32 s26, s23, 9
    s_add_u32 s25, s25, s26
    s_mul_i32 s26, s25, 55296
    s_add_u32 s27, s26, 0
    buffer_load_ushort v16, v6, s[8:11], s27 offen
    s_add_u32 s27, s26, 3456
    buffer_load_ushort v17, v6, s[8:11], s27 offen
    s_add_u32 s27, s26, 6912
    buffer_load_ushort v18, v6, s[8:11], s27 offen
    s_add_u32 s27, s26, 10368
    buffer_load_ushort v19, v6, s[8:11], s27 offen
    s_add_u32 s27, s26, 13824
    buffer_load_ushort v20, v6, s[8:11], s27 offen
    s_add_u32 s27, s26, 17280
    buffer_load_ushort v21, v6, s[8:11], s27 offen
    s_add_u32 s27, s26, 20736
    buffer_load_ushort v22, v6, s[8:11], s27 offen
    s_add_u32 s27, s26, 24192
    buffer_load_ushort v23, v6, s[8:11], s27 offen
    s_add_u32 s27, s26, 55296
    buffer_load_ushort v24, v6, s[8:11], s27 offen
    s_add_u32 s27, s26, 58752
    buffer_load_ushort v25, v6, s[8:11], s27 offen
    s_add_u32 s27, s26, 62208
    buffer_load_ushort v26, v6, s[8:11], s27 offen
    s_add_u32 s27, s26, 65664
    buffer_load_ushort v27, v6, s[8:11], s27 offen
    s_add_u32 s27, s26, 69120
    buffer_load_ushort v28, v6, s[8:11], s27 offen
    s_add_u32 s27, s26, 72576
    buffer_load_ushort v29, v6, s[8:11], s27 offen
    s_add_u32 s27, s26, 76032
    buffer_load_ushort v30, v6, s[8:11], s27 offen
    s_add_u32 s27, s26, 79488
    buffer_load_ushort v31, v6, s[8:11], s27 offen
    s_cmp_lg_u32 s22, 0
    s_cbranch_scc1 A_WL2
    s_add_u32 s27, s26, 110592
    buffer_load_ushort v32, v6, s[8:11], s27 offen
    s_add_u32 s27, s26, 114048
    buffer_load_ushort v33, v6, s[8:11], s27 offen
    s_add_u32 s27, s26, 117504
    buffer_load_ushort v34, v6, s[8:11], s27 offen
    s_add_u32 s27, s26, 120960
    buffer_load_ushort v35, v6, s[8:11], s27 offen
    s_add_u32 s27, s26, 124416
    buffer_load_ushort v36, v6, s[8:11], s27 offen
    s_add_u32 s27, s26, 127872
    buffer_load_ushort v37, v6, s[8:11], s27 offen
    s_add_u32 s27, s26, 131328
    buffer_load_ushort v38, v6, s[8:11], s27 offen
    s_add_u32 s27, s26, 134784
    buffer_load_ushort v39, v6, s[8:11], s27 offen
A_WL2:
    s_load_dwordx2 s[40:41], s[0:1], 32
    s_load_dwordx2 s[44:45], s[0:1], 40
    s_load_dwordx2 s[48:49], s[0:1], 48
    s_waitcnt lgkmcnt(0)
    s_mov_b32 s42, 2359296
    s_mov_b32 s43, 0x20000
    s_mov_b32 s46, 2359296
    s_mov_b32 s47, 0x20000
    s_mov_b32 s50, 4608
    s_mov_b32 s51, 0x20000
    s_lshl_b32 s34, s2, 2
    s_add_u32 s34, s34, s22
    s_mul_hi_u32 s54, s34, 119304648
    s_mul_i32 s55, s54, 36
    s_sub_u32 s55, s34, s55
    v_and_b32 v102, 7, v1
    v_lshrrev_b32 v103, 3, v1
    s_lshl_b32 s30, s54, 6
    v_lshl_add_u32 v104, v102, 3, s30
    s_lshl_b32 s30, s55, 3
    v_add_u32 v105, s30, v103
    v_mul_u32_u24 v106, 1152, v104
    v_lshl_add_u32 v106, v105, 2, v106
    v_cmp_eq_u32 vcc, 0, v104
    v_mov_b32 v110, 0x40000000
    v_subrev_u32 v107, 3456, v106
    v_cndmask_b32 v107, v107, v110, vcc
    v_subrev_u32 v108, 2304, v106
    v_cndmask_b32 v108, v108, v110, vcc
    v_subrev_u32 v109, 1152, v106
    v_cndmask_b32 v109, v109, v110, vcc
    v_lshlrev_b32 v110, 4, v105
    buffer_load_dwordx4 v[112:115], v110, s[48:51], 0 offen
    buffer_load_dword v116, v107, s[40:43], 0 offen
    buffer_load_dword v117, v108, s[40:43], 0 offen
    buffer_load_dword v118, v109, s[40:43], 0 offen
    s_mov_b32 s30, 0
    buffer_load_dword v119, v106, s[40:43], s30 offen
    s_mov_b32 s30, 1152
    buffer_load_dword v120, v106, s[40:43], s30 offen
    s_mov_b32 s30, 2304
    buffer_load_dword v121, v106, s[40:43], s30 offen
    s_mov_b32 s30, 3456
    buffer_load_dword v122, v106, s[40:43], s30 offen
    s_mov_b32 s30, 4608
    buffer_load_dword v123, v106, s[40:43], s30 offen
    s_mov_b32 s30, 5760
    buffer_load_dword v124, v106, s[40:43], s30 offen
    s_mov_b32 s30, 6912
    buffer_load_dword v125, v106, s[40:43], s30 offen
    s_mov_b32 s30, 8064
    buffer_load_dword v126, v106, s[40:43], s30 offen
    s_mov_b32 s30, 0
    buffer_load_dword v128, v106, s[44:47], s30 offen
    s_mov_b32 s30, 1152
    buffer_load_dword v129, v106, s[44:47], s30 offen
    s_mov_b32 s30, 2304
    buffer_load_dword v130, v106, s[44:47], s30 offen
    s_mov_b32 s30, 3456
    buffer_load_dword v131, v106, s[44:47], s30 offen
    s_mov_b32 s30, 4608
    buffer_load_dword v132, v106, s[44:47], s30 offen
    s_mov_b32 s30, 5760
    buffer_load_dword v133, v106, s[44:47], s30 offen
    s_mov_b32 s30, 6912
    buffer_load_dword v134, v106, s[44:47], s30 offen
    s_mov_b32 s30, 8064
    buffer_load_dword v135, v106, s[44:47], s30 offen
    s_lshl_b32 s27, s20, 2
    s_add_u32 s27, s27, s21
    s_mul_i32 s28, s27, 36
    s_add_u32 s28, s28, s25
    s_lshl_b32 s28, s28, 10
    v_lshlrev_b32 v9, 4, v1
    v_mov_b32 v10, 0
    s_mov_b32 s29, 0x3f803f80
    s_waitcnt vmcnt(20)
    v_lshl_or_b32 v48, v17, 16, v16
    v_lshl_or_b32 v49, v19, 16, v18
    v_lshl_or_b32 v50, v21, 16, v20
    v_lshl_or_b32 v51, v23, 16, v22
    buffer_store_dwordx4 v[48:51], v9, s[12:15], s28 offen offset:0 sc1
    v_dot2_f32_bf16 v10, v48, s29, v10
    v_dot2_f32_bf16 v10, v49, s29, v10
    v_dot2_f32_bf16 v10, v50, s29, v10
    v_dot2_f32_bf16 v10, v51, s29, v10
    v_lshl_or_b32 v52, v25, 16, v24
    v_lshl_or_b32 v53, v27, 16, v26
    v_lshl_or_b32 v54, v29, 16, v28
    v_lshl_or_b32 v55, v31, 16, v30
    buffer_store_dwordx4 v[52:55], v9, s[12:15], s28 offen offset:1024 sc1
    v_dot2_f32_bf16 v10, v52, s29, v10
    v_dot2_f32_bf16 v10, v53, s29, v10
    v_dot2_f32_bf16 v10, v54, s29, v10
    v_dot2_f32_bf16 v10, v55, s29, v10
    s_cmp_lg_u32 s22, 0
    s_cbranch_scc1 A_WP2
    v_lshl_or_b32 v56, v33, 16, v32
    v_lshl_or_b32 v57, v35, 16, v34
    v_lshl_or_b32 v58, v37, 16, v36
    v_lshl_or_b32 v59, v39, 16, v38
    buffer_store_dwordx4 v[56:59], v9, s[12:15], s28 offen offset:2048 sc1
    v_dot2_f32_bf16 v10, v56, s29, v10
    v_dot2_f32_bf16 v10, v57, s29, v10
    v_dot2_f32_bf16 v10, v58, s29, v10
    v_dot2_f32_bf16 v10, v59, s29, v10
A_WP2:
    s_nop 2
    v_mov_b32 v11, v10
    s_nop 1
    v_permlane32_swap_b32 v10, v11
    s_nop 1
    v_add_f32 v10, v10, v11
    s_lshl_b32 s28, s27, 4
    s_lshl_b32 s29, s23, 2
    s_add_u32 s28, s28, s29
    s_add_u32 s28, s28, s22
    s_lshl_b32 s28, s28, 7
    s_add_u32 s28, s28, 2367488
    v_lshlrev_b32 v12, 2, v3
    s_mov_b32 exec_hi, 0
    buffer_store_dword v10, v12, s[12:15], s28 offen sc1
    s_mov_b32 exec_hi, -1
    s_waitcnt vmcnt(0)
    s_and_b32 s28, s2, 15
    s_lshl_b32 s28, s28, 2
    s_add_u32 s28, s28, s22
    s_lshl_b32 s29, s20, 6
    s_add_u32 s28, s28, s29
    s_lshl_b32 s28, s28, 7
    s_add_u32 s28, s28, 30113792
    v_mov_b32 v10, s60
    v_mov_b32 v11, 0
    s_mov_b64 exec, 1
    buffer_store_dword v10, v11, s[12:15], s28 offen sc1
    s_mov_b64 exec, -1
    s_barrier
    v_lshlrev_b32 v140, 16, v112
    v_and_b32 v141, 0xffff0000, v112
    v_lshlrev_b32 v142, 16, v113
    v_and_b32 v143, 0xffff0000, v113
    v_lshlrev_b32 v144, 16, v114
    v_and_b32 v145, 0xffff0000, v114
    v_lshlrev_b32 v146, 16, v115
    v_and_b32 v147, 0xffff0000, v115
    v_lshlrev_b32 v148, 16, v116
    v_and_b32 v160, 0xffff0000, v116
    v_lshlrev_b32 v149, 16, v117
    v_and_b32 v161, 0xffff0000, v117
    v_lshlrev_b32 v150, 16, v118
    v_and_b32 v162, 0xffff0000, v118
    v_lshlrev_b32 v151, 16, v119
    v_and_b32 v163, 0xffff0000, v119
    v_lshlrev_b32 v152, 16, v120
    v_and_b32 v164, 0xffff0000, v120
    v_lshlrev_b32 v153, 16, v121
    v_and_b32 v165, 0xffff0000, v121
    v_lshlrev_b32 v154, 16, v122
    v_and_b32 v166, 0xffff0000, v122
    v_lshlrev_b32 v155, 16, v123
    v_and_b32 v167, 0xffff0000, v123
    v_lshlrev_b32 v156, 16, v124
    v_and_b32 v168, 0xffff0000, v124
    v_lshlrev_b32 v157, 16, v125
    v_and_b32 v169, 0xffff0000, v125
    v_lshlrev_b32 v158, 16, v126
    v_and_b32 v170, 0xffff0000, v126
    v_lshlrev_b32 v172, 16, v128
    v_and_b32 v180, 0xffff0000, v128
    v_lshlrev_b32 v173, 16, v129
    v_and_b32 v181, 0xffff0000, v129
    v_lshlrev_b32 v174, 16, v130
    v_and_b32 v182, 0xffff0000, v130
    v_lshlrev_b32 v175, 16, v131
    v_and_b32 v183, 0xffff0000, v131
    v_lshlrev_b32 v176, 16, v132
    v_and_b32 v184, 0xffff0000, v132
    v_lshlrev_b32 v177, 16, v133
    v_and_b32 v185, 0xffff0000, v133
    v_lshlrev_b32 v178, 16, v134
    v_and_b32 v186, 0xffff0000, v134
    v_lshlrev_b32 v179, 16, v135
    v_and_b32 v187, 0xffff0000, v135
    v_mul_f32 v188, v148, v143
    v_fmac_f32 v188, v149, v142
    v_fmac_f32 v188, v150, v141
    v_fmac_f32 v188, v151, v140
    v_mul_f32 v172, v188, v172
    v_mul_f32 v189, v149, v143
    v_fmac_f32 v189, v150, v142
    v_fmac_f32 v189, v151, v141
    v_fmac_f32 v189, v152, v140
    v_mul_f32 v173, v189, v173
    v_mul_f32 v188, v150, v143
    v_fmac_f32 v188, v151, v142
    v_fmac_f32 v188, v152, v141
    v_fmac_f32 v188, v153, v140
    v_mul_f32 v174, v188, v174
    v_mul_f32 v189, v151, v143
    v_fmac_f32 v189, v152, v142
    v_fmac_f32 v189, v153, v141
    v_fmac_f32 v189, v154, v140
    v_mul_f32 v175, v189, v175
    v_mul_f32 v188, v152, v143
    v_fmac_f32 v188, v153, v142
    v_fmac_f32 v188, v154, v141
    v_fmac_f32 v188, v155, v140
    v_mul_f32 v176, v188, v176
    v_mul_f32 v189, v153, v143
    v_fmac_f32 v189, v154, v142
    v_fmac_f32 v189, v155, v141
    v_fmac_f32 v189, v156, v140
    v_mul_f32 v177, v189, v177
    v_mul_f32 v188, v154, v143
    v_fmac_f32 v188, v155, v142
    v_fmac_f32 v188, v156, v141
    v_fmac_f32 v188, v157, v140
    v_mul_f32 v178, v188, v178
    v_mul_f32 v189, v155, v143
    v_fmac_f32 v189, v156, v142
    v_fmac_f32 v189, v157, v141
    v_fmac_f32 v189, v158, v140
    v_mul_f32 v179, v189, v179
    v_cvt_pk_bf16_f32 v192, v179, v178
    v_cvt_pk_bf16_f32 v193, v177, v176
    v_cvt_pk_bf16_f32 v194, v175, v174
    v_cvt_pk_bf16_f32 v195, v173, v172
    v_mul_f32 v188, v160, v147
    v_fmac_f32 v188, v161, v146
    v_fmac_f32 v188, v162, v145
    v_fmac_f32 v188, v163, v144
    v_mul_f32 v180, v188, v180
    v_mul_f32 v189, v161, v147
    v_fmac_f32 v189, v162, v146
    v_fmac_f32 v189, v163, v145
    v_fmac_f32 v189, v164, v144
    v_mul_f32 v181, v189, v181
    v_mul_f32 v188, v162, v147
    v_fmac_f32 v188, v163, v146
    v_fmac_f32 v188, v164, v145
    v_fmac_f32 v188, v165, v144
    v_mul_f32 v182, v188, v182
    v_mul_f32 v189, v163, v147
    v_fmac_f32 v189, v164, v146
    v_fmac_f32 v189, v165, v145
    v_fmac_f32 v189, v166, v144
    v_mul_f32 v183, v189, v183
    v_mul_f32 v188, v164, v147
    v_fmac_f32 v188, v165, v146
    v_fmac_f32 v188, v166, v145
    v_fmac_f32 v188, v167, v144
    v_mul_f32 v184, v188, v184
    v_mul_f32 v189, v165, v147
    v_fmac_f32 v189, v166, v146
    v_fmac_f32 v189, v167, v145
    v_fmac_f32 v189, v168, v144
    v_mul_f32 v185, v189, v185
    v_mul_f32 v188, v166, v147
    v_fmac_f32 v188, v167, v146
    v_fmac_f32 v188, v168, v145
    v_fmac_f32 v188, v169, v144
    v_mul_f32 v186, v188, v186
    v_mul_f32 v189, v167, v147
    v_fmac_f32 v189, v168, v146
    v_fmac_f32 v189, v169, v145
    v_fmac_f32 v189, v170, v144
    v_mul_f32 v187, v189, v187
    v_cvt_pk_bf16_f32 v196, v187, v186
    v_cvt_pk_bf16_f32 v197, v185, v184
    v_cvt_pk_bf16_f32 v198, v183, v182
    v_cvt_pk_bf16_f32 v199, v181, v180
    v_sub_u32 v106, 2040, v104
    v_lshlrev_b32 v106, 1, v106
    v_lshl_add_u32 v106, v105, 13, v106
    s_mov_b32 s30, 3358720
    buffer_store_dwordx4 v[192:195], v106, s[12:15], s30 offen sc1
    v_add_u32 v107, 4096, v106
    buffer_store_dwordx4 v[196:199], v107, s[12:15], s30 offen sc1
    s_lshl_b32 s52, s55, 5
    s_add_u32 s52, s52, s54
    s_lshl_b32 s52, s52, 7
    s_add_u32 s52, s52, 30244864
    s_and_b32 s20, s2, 7
    s_lshr_b32 s21, s2, 3
    s_lshr_b32 s23, s20, 1
    s_lshl_b32 s23, s23, 2
    s_lshr_b32 s24, s21, 3
    s_add_u32 s23, s23, s24
    s_and_b32 s24, s20, 1
    s_lshl_b32 s24, s24, 3
    s_and_b32 s25, s21, 7
    s_add_u32 s24, s24, s25
    s_and_b32 s25, s22, 3
    s_mul_i32 s26, s23, 147456
    s_lshl_b32 s28, s24, 2
    s_add_u32 s28, s28, s25
    s_mul_i32 s28, s28, 36864
    s_lshl_b32 s29, s25, 12
    s_and_b32 s27, s24, 7
    s_and_b32 s30, s23, 3
    s_lshl_b32 s30, s30, 1
    s_add_u32 s27, s27, s30
    s_sub_u32 s30, s27, 9
    s_cmp_ge_u32 s27, 9
    s_cselect_b32 s27, s30, s27
    v_and_b32 v1, 63, v0
    v_lshlrev_b32 v248, 4, v1
    v_and_b32 v249, 31, v1
    v_lshrrev_b32 v250, 5, v1
    s_lshl_b32 s34, s24, 13
    s_add_u32 s34, s34, 30113792
    v_lshlrev_b32 v2, 7, v1
    s_mov_b32 s58, 0
A_F0:
    buffer_load_dword v3, v2, s[12:15], s34 offen sc1
    s_waitcnt vmcnt(0)
    v_cmp_eq_u32 vcc, s60, v3
    s_nop 1
    s_cmp_eq_u64 vcc, -1
    s_cbranch_scc1 A_F0_OK
    s_sleep 2
    s_add_u32 s58, s58, 1
    s_cmp_lt_u32 s58, 131072
    s_cbranch_scc1 A_F0
A_F0_OK:
    v_mov_b32 v4, s60
    v_mov_b32 v5, 0
    s_mov_b64 exec, 1
    buffer_store_dword v4, v5, s[12:15], s52 offen sc1
    s_mov_b64 exec, -1
    s_add_u32 s31, s27, 0
    s_sub_u32 s33, s31, 9
    s_cmp_ge_u32 s31, 9
    s_cselect_b32 s31, s33, s31
    s_lshl_b32 s31, s31, 12
    s_add_u32 s31, s31, s28
    buffer_load_dwordx4 v[8:11], v248, s[12:15], s31 offen offset:0 sc1
    buffer_load_dwordx4 v[12:15], v248, s[12:15], s31 offen offset:1024 sc1
    buffer_load_dwordx4 v[16:19], v248, s[12:15], s31 offen offset:2048 sc1
    buffer_load_dwordx4 v[20:23], v248, s[12:15], s31 offen offset:3072 sc1
    s_add_u32 s31, s27, 1
    s_sub_u32 s33, s31, 9
    s_cmp_ge_u32 s31, 9
    s_cselect_b32 s31, s33, s31
    s_lshl_b32 s31, s31, 12
    s_add_u32 s31, s31, s28
    buffer_load_dwordx4 v[24:27], v248, s[12:15], s31 offen offset:0 sc1
    buffer_load_dwordx4 v[28:31], v248, s[12:15], s31 offen offset:1024 sc1
    buffer_load_dwordx4 v[32:35], v248, s[12:15], s31 offen offset:2048 sc1
    buffer_load_dwordx4 v[36:39], v248, s[12:15], s31 offen offset:3072 sc1
    v_bfe_u32 v251, v249, 1, 3
    v_add_u32 v252, 0, v250
    v_xor_b32 v252, v252, v251
    v_lshlrev_b32 v252, 4, v252
    v_lshl_add_u32 v2, v249, 7, v252
    v_add_u32 v2, 2560, v2
    v_add_u32 v252, 2, v250
    v_xor_b32 v252, v252, v251
    v_lshlrev_b32 v252, 4, v252
    v_lshl_add_u32 v3, v249, 7, v252
    v_add_u32 v3, 2560, v3
    v_add_u32 v252, 4, v250
    v_xor_b32 v252, v252, v251
    v_lshlrev_b32 v252, 4, v252
    v_lshl_add_u32 v4, v249, 7, v252
    v_add_u32 v4, 2560, v4
    v_add_u32 v252, 6, v250
    v_xor_b32 v252, v252, v251
    v_lshlrev_b32 v252, 4, v252
    v_lshl_add_u32 v5, v249, 7, v252
    v_add_u32 v5, 2560, v5
    s_setprio 2
    v_mov_b32 v152, 0
    v_mov_b32 v153, 0
    v_mov_b32 v154, 0
    v_mov_b32 v155, 0
    v_mov_b32 v156, 0
    v_mov_b32 v157, 0
    v_mov_b32 v158, 0
    v_mov_b32 v159, 0
    v_mov_b32 v160, 0
    v_mov_b32 v161, 0
    v_mov_b32 v162, 0
    v_mov_b32 v163, 0
    v_mov_b32 v164, 0
    v_mov_b32 v165, 0
    v_mov_b32 v166, 0
    v_mov_b32 v167, 0
    v_mov_b32 v168, 0
    v_mov_b32 v169, 0
    v_mov_b32 v170, 0
    v_mov_b32 v171, 0
    v_mov_b32 v172, 0
    v_mov_b32 v173, 0
    v_mov_b32 v174, 0
    v_mov_b32 v175, 0
    v_mov_b32 v176, 0
    v_mov_b32 v177, 0
    v_mov_b32 v178, 0
    v_mov_b32 v179, 0
    v_mov_b32 v180, 0
    v_mov_b32 v181, 0
    v_mov_b32 v182, 0
    v_mov_b32 v183, 0
    v_mov_b32 v184, 0
    v_mov_b32 v185, 0
    v_mov_b32 v186, 0
    v_mov_b32 v187, 0
    v_mov_b32 v188, 0
    v_mov_b32 v189, 0
    v_mov_b32 v190, 0
    v_mov_b32 v191, 0
    v_mov_b32 v192, 0
    v_mov_b32 v193, 0
    v_mov_b32 v194, 0
    v_mov_b32 v195, 0
    v_mov_b32 v196, 0
    v_mov_b32 v197, 0
    v_mov_b32 v198, 0
    v_mov_b32 v199, 0
    v_mov_b32 v200, 0
    v_mov_b32 v201, 0
    v_mov_b32 v202, 0
    v_mov_b32 v203, 0
    v_mov_b32 v204, 0
    v_mov_b32 v205, 0
    v_mov_b32 v206, 0
    v_mov_b32 v207, 0
    v_mov_b32 v208, 0
    v_mov_b32 v209, 0
    v_mov_b32 v210, 0
    v_mov_b32 v211, 0
    v_mov_b32 v212, 0
    v_mov_b32 v213, 0
    v_mov_b32 v214, 0
    v_mov_b32 v215, 0
    s_cmp_eq_u32 s25, 2
    s_cbranch_scc1 A_KSW
    s_barrier
    ds_read_b128 v[216:219], v2 offset:0
    ds_read_b128 v[220:223], v2 offset:4096
    ds_read_b128 v[224:227], v2 offset:8192
    ds_read_b128 v[228:231], v2 offset:12288
    s_waitcnt vmcnt(7) lgkmcnt(3)
    v_mfma_f32_32x32x16_bf16 v[152:167], v[8:11], v[216:219], v[152:167]
    ds_read_b128 v[232:235], v3 offset:0
    s_waitcnt lgkmcnt(3)
    v_mfma_f32_32x32x16_bf16 v[168:183], v[8:11], v[220:223], v[168:183]
    ds_read_b128 v[236:239], v3 offset:4096
    s_add_u32 s31, s27, 2
    s_sub_u32 s33, s31, 9
    s_cmp_ge_u32 s31, 9
    s_cselect_b32 s31, s33, s31
    s_lshl_b32 s31, s31, 12
    s_add_u32 s31, s31, s28
    buffer_load_dwordx4 v[40:43], v248, s[12:15], s31 offen offset:0 sc1
    s_waitcnt lgkmcnt(3)
    v_mfma_f32_32x32x16_bf16 v[184:199], v[8:11], v[224:227], v[184:199]
    ds_read_b128 v[240:243], v3 offset:8192
    s_waitcnt lgkmcnt(3)
    v_mfma_f32_32x32x16_bf16 v[200:215], v[8:11], v[228:231], v[200:215]
    ds_read_b128 v[244:247], v3 offset:12288
    s_waitcnt vmcnt(7) lgkmcnt(3)
    v_mfma_f32_32x32x16_bf16 v[152:167], v[12:15], v[232:235], v[152:167]
    ds_read_b128 v[216:219], v4 offset:0
    s_waitcnt lgkmcnt(3)
    v_mfma_f32_32x32x16_bf16 v[168:183], v[12:15], v[236:239], v[168:183]
    ds_read_b128 v[220:223], v4 offset:4096
    buffer_load_dwordx4 v[44:47], v248, s[12:15], s31 offen offset:1024 sc1
    s_waitcnt lgkmcnt(3)
    v_mfma_f32_32x32x16_bf16 v[184:199], v[12:15], v[240:243], v[184:199]
    ds_read_b128 v[224:227], v4 offset:8192
    s_waitcnt lgkmcnt(3)
    v_mfma_f32_32x32x16_bf16 v[200:215], v[12:15], v[244:247], v[200:215]
    ds_read_b128 v[228:231], v4 offset:12288
    s_waitcnt vmcnt(7) lgkmcnt(3)
    v_mfma_f32_32x32x16_bf16 v[152:167], v[16:19], v[216:219], v[152:167]
    ds_read_b128 v[232:235], v5 offset:0
    s_waitcnt lgkmcnt(3)
    v_mfma_f32_32x32x16_bf16 v[168:183], v[16:19], v[220:223], v[168:183]
    ds_read_b128 v[236:239], v5 offset:4096
    buffer_load_dwordx4 v[48:51], v248, s[12:15], s31 offen offset:2048 sc1
    s_waitcnt lgkmcnt(3)
    v_mfma_f32_32x32x16_bf16 v[184:199], v[16:19], v[224:227], v[184:199]
    ds_read_b128 v[240:243], v5 offset:8192
    s_waitcnt lgkmcnt(3)
    v_mfma_f32_32x32x16_bf16 v[200:215], v[16:19], v[228:231], v[200:215]
    ds_read_b128 v[244:247], v5 offset:12288
    s_waitcnt vmcnt(7) lgkmcnt(3)
    v_mfma_f32_32x32x16_bf16 v[152:167], v[20:23], v[232:235], v[152:167]
    ds_read_b128 v[216:219], v2 offset:16384
    s_waitcnt lgkmcnt(3)
    v_mfma_f32_32x32x16_bf16 v[168:183], v[20:23], v[236:239], v[168:183]
    ds_read_b128 v[220:223], v2 offset:20480
    buffer_load_dwordx4 v[52:55], v248, s[12:15], s31 offen offset:3072 sc1
    s_waitcnt lgkmcnt(3)
    v_mfma_f32_32x32x16_bf16 v[184:199], v[20:23], v[240:243], v[184:199]
    ds_read_b128 v[224:227], v2 offset:24576
    s_waitcnt lgkmcnt(3)
    v_mfma_f32_32x32x16_bf16 v[200:215], v[20:23], v[244:247], v[200:215]
    ds_read_b128 v[228:231], v2 offset:28672
    s_waitcnt vmcnt(7) lgkmcnt(3)
    v_mfma_f32_32x32x16_bf16 v[152:167], v[24:27], v[216:219], v[152:167]
    ds_read_b128 v[232:235], v3 offset:16384
    s_waitcnt lgkmcnt(3)
    v_mfma_f32_32x32x16_bf16 v[168:183], v[24:27], v[220:223], v[168:183]
    ds_read_b128 v[236:239], v3 offset:20480
    s_add_u32 s31, s27, 3
    s_sub_u32 s33, s31, 9
    s_cmp_ge_u32 s31, 9
    s_cselect_b32 s31, s33, s31
    s_lshl_b32 s31, s31, 12
    s_add_u32 s31, s31, s28
    buffer_load_dwordx4 v[56:59], v248, s[12:15], s31 offen offset:0 sc1
    s_waitcnt lgkmcnt(3)
    v_mfma_f32_32x32x16_bf16 v[184:199], v[24:27], v[224:227], v[184:199]
    ds_read_b128 v[240:243], v3 offset:24576
    s_waitcnt lgkmcnt(3)
    v_mfma_f32_32x32x16_bf16 v[200:215], v[24:27], v[228:231], v[200:215]
    ds_read_b128 v[244:247], v3 offset:28672
    s_waitcnt vmcnt(7) lgkmcnt(3)
    v_mfma_f32_32x32x16_bf16 v[152:167], v[28:31], v[232:235], v[152:167]
    ds_read_b128 v[216:219], v4 offset:16384
    s_waitcnt lgkmcnt(3)
    v_mfma_f32_32x32x16_bf16 v[168:183], v[28:31], v[236:239], v[168:183]
    ds_read_b128 v[220:223], v4 offset:20480
    buffer_load_dwordx4 v[60:63], v248, s[12:15], s31 offen offset:1024 sc1
    s_waitcnt lgkmcnt(3)
    v_mfma_f32_32x32x16_bf16 v[184:199], v[28:31], v[240:243], v[184:199]
    ds_read_b128 v[224:227], v4 offset:24576
    s_waitcnt lgkmcnt(3)
    v_mfma_f32_32x32x16_bf16 v[200:215], v[28:31], v[244:247], v[200:215]
    ds_read_b128 v[228:231], v4 offset:28672
    s_waitcnt vmcnt(7) lgkmcnt(3)
    v_mfma_f32_32x32x16_bf16 v[152:167], v[32:35], v[216:219], v[152:167]
    ds_read_b128 v[232:235], v5 offset:16384
    s_waitcnt lgkmcnt(3)
    v_mfma_f32_32x32x16_bf16 v[168:183], v[32:35], v[220:223], v[168:183]
    ds_read_b128 v[236:239], v5 offset:20480
    buffer_load_dwordx4 v[64:67], v248, s[12:15], s31 offen offset:2048 sc1
    s_waitcnt lgkmcnt(3)
    v_mfma_f32_32x32x16_bf16 v[184:199], v[32:35], v[224:227], v[184:199]
    ds_read_b128 v[240:243], v5 offset:24576
    s_waitcnt lgkmcnt(3)
    v_mfma_f32_32x32x16_bf16 v[200:215], v[32:35], v[228:231], v[200:215]
    ds_read_b128 v[244:247], v5 offset:28672
    s_waitcnt vmcnt(7) lgkmcnt(3)
    v_mfma_f32_32x32x16_bf16 v[152:167], v[36:39], v[232:235], v[152:167]
    ds_read_b128 v[216:219], v2 offset:32768
    s_waitcnt lgkmcnt(3)
    v_mfma_f32_32x32x16_bf16 v[168:183], v[36:39], v[236:239], v[168:183]
    ds_read_b128 v[220:223], v2 offset:36864
    buffer_load_dwordx4 v[68:71], v248, s[12:15], s31 offen offset:3072 sc1
    s_waitcnt lgkmcnt(3)
    v_mfma_f32_32x32x16_bf16 v[184:199], v[36:39], v[240:243], v[184:199]
    ds_read_b128 v[224:227], v2 offset:40960
    s_waitcnt lgkmcnt(3)
    v_mfma_f32_32x32x16_bf16 v[200:215], v[36:39], v[244:247], v[200:215]
    ds_read_b128 v[228:231], v2 offset:45056
    s_waitcnt vmcnt(7) lgkmcnt(3)
    v_mfma_f32_32x32x16_bf16 v[152:167], v[40:43], v[216:219], v[152:167]
    ds_read_b128 v[232:235], v3 offset:32768
    s_waitcnt lgkmcnt(3)
    v_mfma_f32_32x32x16_bf16 v[168:183], v[40:43], v[220:223], v[168:183]
    ds_read_b128 v[236:239], v3 offset:36864
    s_add_u32 s31, s27, 4
    s_sub_u32 s33, s31, 9
    s_cmp_ge_u32 s31, 9
    s_cselect_b32 s31, s33, s31
    s_lshl_b32 s31, s31, 12
    s_add_u32 s31, s31, s28
    buffer_load_dwordx4 v[72:75], v248, s[12:15], s31 offen offset:0 sc1
    s_waitcnt lgkmcnt(3)
    v_mfma_f32_32x32x16_bf16 v[184:199], v[40:43], v[224:227], v[184:199]
    ds_read_b128 v[240:243], v3 offset:40960
    s_waitcnt lgkmcnt(3)
    v_mfma_f32_32x32x16_bf16 v[200:215], v[40:43], v[228:231], v[200:215]
    ds_read_b128 v[244:247], v3 offset:45056
    s_waitcnt vmcnt(7) lgkmcnt(3)
    v_mfma_f32_32x32x16_bf16 v[152:167], v[44:47], v[232:235], v[152:167]
    ds_read_b128 v[216:219], v4 offset:32768
    s_waitcnt lgkmcnt(3)
    v_mfma_f32_32x32x16_bf16 v[168:183], v[44:47], v[236:239], v[168:183]
    ds_read_b128 v[220:223], v4 offset:36864
    buffer_load_dwordx4 v[76:79], v248, s[12:15], s31 offen offset:1024 sc1
    s_waitcnt lgkmcnt(3)
    v_mfma_f32_32x32x16_bf16 v[184:199], v[44:47], v[240:243], v[184:199]
    ds_read_b128 v[224:227], v4 offset:40960
    s_waitcnt lgkmcnt(3)
    v_mfma_f32_32x32x16_bf16 v[200:215], v[44:47], v[244:247], v[200:215]
    ds_read_b128 v[228:231], v4 offset:45056
    s_waitcnt vmcnt(7) lgkmcnt(3)
    v_mfma_f32_32x32x16_bf16 v[152:167], v[48:51], v[216:219], v[152:167]
    ds_read_b128 v[232:235], v5 offset:32768
    s_waitcnt lgkmcnt(3)
    v_mfma_f32_32x32x16_bf16 v[168:183], v[48:51], v[220:223], v[168:183]
    ds_read_b128 v[236:239], v5 offset:36864
    buffer_load_dwordx4 v[80:83], v248, s[12:15], s31 offen offset:2048 sc1
    s_waitcnt lgkmcnt(3)
    v_mfma_f32_32x32x16_bf16 v[184:199], v[48:51], v[224:227], v[184:199]
    ds_read_b128 v[240:243], v5 offset:40960
    s_waitcnt lgkmcnt(3)
    v_mfma_f32_32x32x16_bf16 v[200:215], v[48:51], v[228:231], v[200:215]
    ds_read_b128 v[244:247], v5 offset:45056
    s_waitcnt vmcnt(7) lgkmcnt(3)
    v_mfma_f32_32x32x16_bf16 v[152:167], v[52:55], v[232:235], v[152:167]
    ds_read_b128 v[216:219], v2 offset:49152
    s_waitcnt lgkmcnt(3)
    v_mfma_f32_32x32x16_bf16 v[168:183], v[52:55], v[236:239], v[168:183]
    ds_read_b128 v[220:223], v2 offset:53248
    buffer_load_dwordx4 v[84:87], v248, s[12:15], s31 offen offset:3072 sc1
    s_waitcnt lgkmcnt(3)
    v_mfma_f32_32x32x16_bf16 v[184:199], v[52:55], v[240:243], v[184:199]
    ds_read_b128 v[224:227], v2 offset:57344
    s_waitcnt lgkmcnt(3)
    v_mfma_f32_32x32x16_bf16 v[200:215], v[52:55], v[244:247], v[200:215]
    ds_read_b128 v[228:231], v2 offset:61440
    s_waitcnt vmcnt(7) lgkmcnt(3)
    v_mfma_f32_32x32x16_bf16 v[152:167], v[56:59], v[216:219], v[152:167]
    ds_read_b128 v[232:235], v3 offset:49152
    s_waitcnt lgkmcnt(3)
    v_mfma_f32_32x32x16_bf16 v[168:183], v[56:59], v[220:223], v[168:183]
    ds_read_b128 v[236:239], v3 offset:53248
    s_add_u32 s31, s27, 5
    s_sub_u32 s33, s31, 9
    s_cmp_ge_u32 s31, 9
    s_cselect_b32 s31, s33, s31
    s_lshl_b32 s31, s31, 12
    s_add_u32 s31, s31, s28
    buffer_load_dwordx4 v[88:91], v248, s[12:15], s31 offen offset:0 sc1
    s_waitcnt lgkmcnt(3)
    v_mfma_f32_32x32x16_bf16 v[184:199], v[56:59], v[224:227], v[184:199]
    ds_read_b128 v[240:243], v3 offset:57344
    s_waitcnt lgkmcnt(3)
    v_mfma_f32_32x32x16_bf16 v[200:215], v[56:59], v[228:231], v[200:215]
    ds_read_b128 v[244:247], v3 offset:61440
    s_waitcnt vmcnt(7) lgkmcnt(3)
    v_mfma_f32_32x32x16_bf16 v[152:167], v[60:63], v[232:235], v[152:167]
    ds_read_b128 v[216:219], v4 offset:49152
    s_waitcnt lgkmcnt(3)
    v_mfma_f32_32x32x16_bf16 v[168:183], v[60:63], v[236:239], v[168:183]
    ds_read_b128 v[220:223], v4 offset:53248
    buffer_load_dwordx4 v[92:95], v248, s[12:15], s31 offen offset:1024 sc1
    s_waitcnt lgkmcnt(3)
    v_mfma_f32_32x32x16_bf16 v[184:199], v[60:63], v[240:243], v[184:199]
    ds_read_b128 v[224:227], v4 offset:57344
    s_waitcnt lgkmcnt(3)
    v_mfma_f32_32x32x16_bf16 v[200:215], v[60:63], v[244:247], v[200:215]
    ds_read_b128 v[228:231], v4 offset:61440
    s_waitcnt vmcnt(7) lgkmcnt(3)
    v_mfma_f32_32x32x16_bf16 v[152:167], v[64:67], v[216:219], v[152:167]
    ds_read_b128 v[232:235], v5 offset:49152
    s_waitcnt lgkmcnt(3)
    v_mfma_f32_32x32x16_bf16 v[168:183], v[64:67], v[220:223], v[168:183]
    ds_read_b128 v[236:239], v5 offset:53248
    buffer_load_dwordx4 v[96:99], v248, s[12:15], s31 offen offset:2048 sc1
    s_waitcnt lgkmcnt(3)
    v_mfma_f32_32x32x16_bf16 v[184:199], v[64:67], v[224:227], v[184:199]
    ds_read_b128 v[240:243], v5 offset:57344
    s_waitcnt lgkmcnt(3)
    v_mfma_f32_32x32x16_bf16 v[200:215], v[64:67], v[228:231], v[200:215]
    ds_read_b128 v[244:247], v5 offset:61440
    s_waitcnt vmcnt(7) lgkmcnt(3)
    v_mfma_f32_32x32x16_bf16 v[152:167], v[68:71], v[232:235], v[152:167]
    v_add_u32 v2, 0x10000, v2
    v_add_u32 v3, 0x10000, v3
    v_add_u32 v4, 0x10000, v4
    v_add_u32 v5, 0x10000, v5
    ds_read_b128 v[216:219], v2 offset:0
    s_waitcnt lgkmcnt(3)
    v_mfma_f32_32x32x16_bf16 v[168:183], v[68:71], v[236:239], v[168:183]
    ds_read_b128 v[220:223], v2 offset:4096
    buffer_load_dwordx4 v[100:103], v248, s[12:15], s31 offen offset:3072 sc1
    s_waitcnt lgkmcnt(3)
    v_mfma_f32_32x32x16_bf16 v[184:199], v[68:71], v[240:243], v[184:199]
    ds_read_b128 v[224:227], v2 offset:8192
    s_waitcnt lgkmcnt(3)
    v_mfma_f32_32x32x16_bf16 v[200:215], v[68:71], v[244:247], v[200:215]
    ds_read_b128 v[228:231], v2 offset:12288
    s_waitcnt vmcnt(7) lgkmcnt(3)
    v_mfma_f32_32x32x16_bf16 v[152:167], v[72:75], v[216:219], v[152:167]
    ds_read_b128 v[232:235], v3 offset:0
    s_waitcnt lgkmcnt(3)
    v_mfma_f32_32x32x16_bf16 v[168:183], v[72:75], v[220:223], v[168:183]
    ds_read_b128 v[236:239], v3 offset:4096
    s_add_u32 s31, s27, 6
    s_sub_u32 s33, s31, 9
    s_cmp_ge_u32 s31, 9
    s_cselect_b32 s31, s33, s31
    s_lshl_b32 s31, s31, 12
    s_add_u32 s31, s31, s28
    buffer_load_dwordx4 v[104:107], v248, s[12:15], s31 offen offset:0 sc1
    s_waitcnt lgkmcnt(3)
    v_mfma_f32_32x32x16_bf16 v[184:199], v[72:75], v[224:227], v[184:199]
    ds_read_b128 v[240:243], v3 offset:8192
    s_waitcnt lgkmcnt(3)
    v_mfma_f32_32x32x16_bf16 v[200:215], v[72:75], v[228:231], v[200:215]
    ds_read_b128 v[244:247], v3 offset:12288
    s_waitcnt vmcnt(7) lgkmcnt(3)
    v_mfma_f32_32x32x16_bf16 v[152:167], v[76:79], v[232:235], v[152:167]
    ds_read_b128 v[216:219], v4 offset:0
    s_waitcnt lgkmcnt(3)
    v_mfma_f32_32x32x16_bf16 v[168:183], v[76:79], v[236:239], v[168:183]
    ds_read_b128 v[220:223], v4 offset:4096
    buffer_load_dwordx4 v[108:111], v248, s[12:15], s31 offen offset:1024 sc1
    s_waitcnt lgkmcnt(3)
    v_mfma_f32_32x32x16_bf16 v[184:199], v[76:79], v[240:243], v[184:199]
    ds_read_b128 v[224:227], v4 offset:8192
    s_waitcnt lgkmcnt(3)
    v_mfma_f32_32x32x16_bf16 v[200:215], v[76:79], v[244:247], v[200:215]
    ds_read_b128 v[228:231], v4 offset:12288
    s_waitcnt vmcnt(7) lgkmcnt(3)
    v_mfma_f32_32x32x16_bf16 v[152:167], v[80:83], v[216:219], v[152:167]
    ds_read_b128 v[232:235], v5 offset:0
    s_waitcnt lgkmcnt(3)
    v_mfma_f32_32x32x16_bf16 v[168:183], v[80:83], v[220:223], v[168:183]
    ds_read_b128 v[236:239], v5 offset:4096
    buffer_load_dwordx4 v[112:115], v248, s[12:15], s31 offen offset:2048 sc1
    s_waitcnt lgkmcnt(3)
    v_mfma_f32_32x32x16_bf16 v[184:199], v[80:83], v[224:227], v[184:199]
    ds_read_b128 v[240:243], v5 offset:8192
    s_waitcnt lgkmcnt(3)
    v_mfma_f32_32x32x16_bf16 v[200:215], v[80:83], v[228:231], v[200:215]
    ds_read_b128 v[244:247], v5 offset:12288
    s_waitcnt vmcnt(7) lgkmcnt(3)
    v_mfma_f32_32x32x16_bf16 v[152:167], v[84:87], v[232:235], v[152:167]
    ds_read_b128 v[216:219], v2 offset:16384
    s_waitcnt lgkmcnt(3)
    v_mfma_f32_32x32x16_bf16 v[168:183], v[84:87], v[236:239], v[168:183]
    ds_read_b128 v[220:223], v2 offset:20480
    buffer_load_dwordx4 v[116:119], v248, s[12:15], s31 offen offset:3072 sc1
    s_waitcnt lgkmcnt(3)
    v_mfma_f32_32x32x16_bf16 v[184:199], v[84:87], v[240:243], v[184:199]
    ds_read_b128 v[224:227], v2 offset:24576
    s_waitcnt lgkmcnt(3)
    v_mfma_f32_32x32x16_bf16 v[200:215], v[84:87], v[244:247], v[200:215]
    ds_read_b128 v[228:231], v2 offset:28672
    s_waitcnt vmcnt(7) lgkmcnt(3)
    v_mfma_f32_32x32x16_bf16 v[152:167], v[88:91], v[216:219], v[152:167]
    ds_read_b128 v[232:235], v3 offset:16384
    s_waitcnt lgkmcnt(3)
    v_mfma_f32_32x32x16_bf16 v[168:183], v[88:91], v[220:223], v[168:183]
    ds_read_b128 v[236:239], v3 offset:20480
    s_add_u32 s31, s27, 7
    s_sub_u32 s33, s31, 9
    s_cmp_ge_u32 s31, 9
    s_cselect_b32 s31, s33, s31
    s_lshl_b32 s31, s31, 12
    s_add_u32 s31, s31, s28
    buffer_load_dwordx4 v[120:123], v248, s[12:15], s31 offen offset:0 sc1
    s_waitcnt lgkmcnt(3)
    v_mfma_f32_32x32x16_bf16 v[184:199], v[88:91], v[224:227], v[184:199]
    ds_read_b128 v[240:243], v3 offset:24576
    s_waitcnt lgkmcnt(3)
    v_mfma_f32_32x32x16_bf16 v[200:215], v[88:91], v[228:231], v[200:215]
    ds_read_b128 v[244:247], v3 offset:28672
    s_waitcnt vmcnt(7) lgkmcnt(3)
    v_mfma_f32_32x32x16_bf16 v[152:167], v[92:95], v[232:235], v[152:167]
    ds_read_b128 v[216:219], v4 offset:16384
    s_waitcnt lgkmcnt(3)
    v_mfma_f32_32x32x16_bf16 v[168:183], v[92:95], v[236:239], v[168:183]
    ds_read_b128 v[220:223], v4 offset:20480
    buffer_load_dwordx4 v[124:127], v248, s[12:15], s31 offen offset:1024 sc1
    s_waitcnt lgkmcnt(3)
    v_mfma_f32_32x32x16_bf16 v[184:199], v[92:95], v[240:243], v[184:199]
    ds_read_b128 v[224:227], v4 offset:24576
    s_waitcnt lgkmcnt(3)
    v_mfma_f32_32x32x16_bf16 v[200:215], v[92:95], v[244:247], v[200:215]
    ds_read_b128 v[228:231], v4 offset:28672
    s_waitcnt vmcnt(7) lgkmcnt(3)
    v_mfma_f32_32x32x16_bf16 v[152:167], v[96:99], v[216:219], v[152:167]
    ds_read_b128 v[232:235], v5 offset:16384
    s_waitcnt lgkmcnt(3)
    v_mfma_f32_32x32x16_bf16 v[168:183], v[96:99], v[220:223], v[168:183]
    ds_read_b128 v[236:239], v5 offset:20480
    buffer_load_dwordx4 v[128:131], v248, s[12:15], s31 offen offset:2048 sc1
    s_waitcnt lgkmcnt(3)
    v_mfma_f32_32x32x16_bf16 v[184:199], v[96:99], v[224:227], v[184:199]
    ds_read_b128 v[240:243], v5 offset:24576
    s_waitcnt lgkmcnt(3)
    v_mfma_f32_32x32x16_bf16 v[200:215], v[96:99], v[228:231], v[200:215]
    ds_read_b128 v[244:247], v5 offset:28672
    s_waitcnt vmcnt(7) lgkmcnt(3)
    v_mfma_f32_32x32x16_bf16 v[152:167], v[100:103], v[232:235], v[152:167]
    ds_read_b128 v[216:219], v2 offset:32768
    s_waitcnt lgkmcnt(3)
    v_mfma_f32_32x32x16_bf16 v[168:183], v[100:103], v[236:239], v[168:183]
    ds_read_b128 v[220:223], v2 offset:36864
    buffer_load_dwordx4 v[132:135], v248, s[12:15], s31 offen offset:3072 sc1
    s_waitcnt lgkmcnt(3)
    v_mfma_f32_32x32x16_bf16 v[184:199], v[100:103], v[240:243], v[184:199]
    ds_read_b128 v[224:227], v2 offset:40960
    s_waitcnt lgkmcnt(3)
    v_mfma_f32_32x32x16_bf16 v[200:215], v[100:103], v[244:247], v[200:215]
    ds_read_b128 v[228:231], v2 offset:45056
    s_waitcnt vmcnt(7) lgkmcnt(3)
    v_mfma_f32_32x32x16_bf16 v[152:167], v[104:107], v[216:219], v[152:167]
    ds_read_b128 v[232:235], v3 offset:32768
    s_waitcnt lgkmcnt(3)
    v_mfma_f32_32x32x16_bf16 v[168:183], v[104:107], v[220:223], v[168:183]
    ds_read_b128 v[236:239], v3 offset:36864
    s_add_u32 s31, s27, 8
    s_sub_u32 s33, s31, 9
    s_cmp_ge_u32 s31, 9
    s_cselect_b32 s31, s33, s31
    s_lshl_b32 s31, s31, 12
    s_add_u32 s31, s31, s28
    buffer_load_dwordx4 v[136:139], v248, s[12:15], s31 offen offset:0 sc1
    s_waitcnt lgkmcnt(3)
    v_mfma_f32_32x32x16_bf16 v[184:199], v[104:107], v[224:227], v[184:199]
    ds_read_b128 v[240:243], v3 offset:40960
    s_waitcnt lgkmcnt(3)
    v_mfma_f32_32x32x16_bf16 v[200:215], v[104:107], v[228:231], v[200:215]
    ds_read_b128 v[244:247], v3 offset:45056
    s_waitcnt vmcnt(7) lgkmcnt(3)
    v_mfma_f32_32x32x16_bf16 v[152:167], v[108:111], v[232:235], v[152:167]
    ds_read_b128 v[216:219], v4 offset:32768
    s_waitcnt lgkmcnt(3)
    v_mfma_f32_32x32x16_bf16 v[168:183], v[108:111], v[236:239], v[168:183]
    ds_read_b128 v[220:223], v4 offset:36864
    buffer_load_dwordx4 v[140:143], v248, s[12:15], s31 offen offset:1024 sc1
    s_waitcnt lgkmcnt(3)
    v_mfma_f32_32x32x16_bf16 v[184:199], v[108:111], v[240:243], v[184:199]
    ds_read_b128 v[224:227], v4 offset:40960
    s_waitcnt lgkmcnt(3)
    v_mfma_f32_32x32x16_bf16 v[200:215], v[108:111], v[244:247], v[200:215]
    ds_read_b128 v[228:231], v4 offset:45056
    s_waitcnt vmcnt(7) lgkmcnt(3)
    v_mfma_f32_32x32x16_bf16 v[152:167], v[112:115], v[216:219], v[152:167]
    ds_read_b128 v[232:235], v5 offset:32768
    s_waitcnt lgkmcnt(3)
    v_mfma_f32_32x32x16_bf16 v[168:183], v[112:115], v[220:223], v[168:183]
    ds_read_b128 v[236:239], v5 offset:36864
    buffer_load_dwordx4 v[144:147], v248, s[12:15], s31 offen offset:2048 sc1
    s_waitcnt lgkmcnt(3)
    v_mfma_f32_32x32x16_bf16 v[184:199], v[112:115], v[224:227], v[184:199]
    ds_read_b128 v[240:243], v5 offset:40960
    s_waitcnt lgkmcnt(3)
    v_mfma_f32_32x32x16_bf16 v[200:215], v[112:115], v[228:231], v[200:215]
    ds_read_b128 v[244:247], v5 offset:45056
    s_waitcnt vmcnt(7) lgkmcnt(3)
    v_mfma_f32_32x32x16_bf16 v[152:167], v[116:119], v[232:235], v[152:167]
    ds_read_b128 v[216:219], v2 offset:49152
    s_waitcnt lgkmcnt(3)
    v_mfma_f32_32x32x16_bf16 v[168:183], v[116:119], v[236:239], v[168:183]
    ds_read_b128 v[220:223], v2 offset:53248
    buffer_load_dwordx4 v[148:151], v248, s[12:15], s31 offen offset:3072 sc1
    s_waitcnt lgkmcnt(3)
    v_mfma_f32_32x32x16_bf16 v[184:199], v[116:119], v[240:243], v[184:199]
    ds_read_b128 v[224:227], v2 offset:57344
    s_waitcnt lgkmcnt(3)
    v_mfma_f32_32x32x16_bf16 v[200:215], v[116:119], v[244:247], v[200:215]
    ds_read_b128 v[228:231], v2 offset:61440
    s_waitcnt vmcnt(7) lgkmcnt(3)
    v_mfma_f32_32x32x16_bf16 v[152:167], v[120:123], v[216:219], v[152:167]
    ds_read_b128 v[232:235], v3 offset:49152
    s_waitcnt lgkmcnt(3)
    v_mfma_f32_32x32x16_bf16 v[168:183], v[120:123], v[220:223], v[168:183]
    ds_read_b128 v[236:239], v3 offset:53248
    s_waitcnt lgkmcnt(3)
    v_mfma_f32_32x32x16_bf16 v[184:199], v[120:123], v[224:227], v[184:199]
    ds_read_b128 v[240:243], v3 offset:57344
    s_waitcnt lgkmcnt(3)
    v_mfma_f32_32x32x16_bf16 v[200:215], v[120:123], v[228:231], v[200:215]
    ds_read_b128 v[244:247], v3 offset:61440
    s_waitcnt vmcnt(6) lgkmcnt(3)
    v_mfma_f32_32x32x16_bf16 v[152:167], v[124:127], v[232:235], v[152:167]
    ds_read_b128 v[216:219], v4 offset:49152
    s_waitcnt lgkmcnt(3)
    v_mfma_f32_32x32x16_bf16 v[168:183], v[124:127], v[236:239], v[168:183]
    ds_read_b128 v[220:223], v4 offset:53248
    s_waitcnt lgkmcnt(3)
    v_mfma_f32_32x32x16_bf16 v[184:199], v[124:127], v[240:243], v[184:199]
    ds_read_b128 v[224:227], v4 offset:57344
    s_waitcnt lgkmcnt(3)
    v_mfma_f32_32x32x16_bf16 v[200:215], v[124:127], v[244:247], v[200:215]
    ds_read_b128 v[228:231], v4 offset:61440
    s_waitcnt vmcnt(5) lgkmcnt(3)
    v_mfma_f32_32x32x16_bf16 v[152:167], v[128:131], v[216:219], v[152:167]
    ds_read_b128 v[232:235], v5 offset:49152
    s_waitcnt lgkmcnt(3)
    v_mfma_f32_32x32x16_bf16 v[168:183], v[128:131], v[220:223], v[168:183]
    ds_read_b128 v[236:239], v5 offset:53248
    s_waitcnt lgkmcnt(3)
    v_mfma_f32_32x32x16_bf16 v[184:199], v[128:131], v[224:227], v[184:199]
    ds_read_b128 v[240:243], v5 offset:57344
    s_waitcnt lgkmcnt(3)
    v_mfma_f32_32x32x16_bf16 v[200:215], v[128:131], v[228:231], v[200:215]
    ds_read_b128 v[244:247], v5 offset:61440
    s_waitcnt vmcnt(4) lgkmcnt(3)
    v_mfma_f32_32x32x16_bf16 v[152:167], v[132:135], v[232:235], v[152:167]
    v_add_u32 v2, 0x10000, v2
    v_add_u32 v3, 0x10000, v3
    v_add_u32 v4, 0x10000, v4
    v_add_u32 v5, 0x10000, v5
    ds_read_b128 v[216:219], v2 offset:0
    s_waitcnt lgkmcnt(3)
    v_mfma_f32_32x32x16_bf16 v[168:183], v[132:135], v[236:239], v[168:183]
    ds_read_b128 v[220:223], v2 offset:4096
    s_waitcnt lgkmcnt(3)
    v_mfma_f32_32x32x16_bf16 v[184:199], v[132:135], v[240:243], v[184:199]
    ds_read_b128 v[224:227], v2 offset:8192
    s_waitcnt lgkmcnt(3)
    v_mfma_f32_32x32x16_bf16 v[200:215], v[132:135], v[244:247], v[200:215]
    ds_read_b128 v[228:231], v2 offset:12288
    s_waitcnt vmcnt(3) lgkmcnt(3)
    v_mfma_f32_32x32x16_bf16 v[152:167], v[136:139], v[216:219], v[152:167]
    ds_read_b128 v[232:235], v3 offset:0
    s_waitcnt lgkmcnt(3)
    v_mfma_f32_32x32x16_bf16 v[168:183], v[136:139], v[220:223], v[168:183]
    ds_read_b128 v[236:239], v3 offset:4096
    s_waitcnt lgkmcnt(3)
    v_mfma_f32_32x32x16_bf16 v[184:199], v[136:139], v[224:227], v[184:199]
    ds_read_b128 v[240:243], v3 offset:8192
    s_waitcnt lgkmcnt(3)
    v_mfma_f32_32x32x16_bf16 v[200:215], v[136:139], v[228:231], v[200:215]
    ds_read_b128 v[244:247], v3 offset:12288
    s_waitcnt vmcnt(2) lgkmcnt(3)
    v_mfma_f32_32x32x16_bf16 v[152:167], v[140:143], v[232:235], v[152:167]
    ds_read_b128 v[216:219], v4 offset:0
    s_waitcnt lgkmcnt(3)
    v_mfma_f32_32x32x16_bf16 v[168:183], v[140:143], v[236:239], v[168:183]
    ds_read_b128 v[220:223], v4 offset:4096
    s_waitcnt lgkmcnt(3)
    v_mfma_f32_32x32x16_bf16 v[184:199], v[140:143], v[240:243], v[184:199]
    ds_read_b128 v[224:227], v4 offset:8192
    s_waitcnt lgkmcnt(3)
    v_mfma_f32_32x32x16_bf16 v[200:215], v[140:143], v[244:247], v[200:215]
    ds_read_b128 v[228:231], v4 offset:12288
    s_waitcnt vmcnt(1) lgkmcnt(3)
    v_mfma_f32_32x32x16_bf16 v[152:167], v[144:147], v[216:219], v[152:167]
    ds_read_b128 v[232:235], v5 offset:0
    s_waitcnt lgkmcnt(3)
    v_mfma_f32_32x32x16_bf16 v[168:183], v[144:147], v[220:223], v[168:183]
    ds_read_b128 v[236:239], v5 offset:4096
    s_waitcnt lgkmcnt(3)
    v_mfma_f32_32x32x16_bf16 v[184:199], v[144:147], v[224:227], v[184:199]
    ds_read_b128 v[240:243], v5 offset:8192
    s_waitcnt lgkmcnt(3)
    v_mfma_f32_32x32x16_bf16 v[200:215], v[144:147], v[228:231], v[200:215]
    ds_read_b128 v[244:247], v5 offset:12288
    s_waitcnt vmcnt(0) lgkmcnt(3)
    v_mfma_f32_32x32x16_bf16 v[152:167], v[148:151], v[232:235], v[152:167]
    s_waitcnt lgkmcnt(2)
    v_mfma_f32_32x32x16_bf16 v[168:183], v[148:151], v[236:239], v[168:183]
    s_waitcnt lgkmcnt(1)
    v_mfma_f32_32x32x16_bf16 v[184:199], v[148:151], v[240:243], v[184:199]
    s_waitcnt lgkmcnt(0)
    v_mfma_f32_32x32x16_bf16 v[200:215], v[148:151], v[244:247], v[200:215]
    s_barrier
    s_branch A_EPI
A_KSW:
    s_barrier
    ds_read_b128 v[216:219], v2 offset:0
    ds_read_b128 v[220:223], v2 offset:4096
    ds_read_b128 v[224:227], v2 offset:8192
    ds_read_b128 v[228:231], v2 offset:12288
    s_waitcnt vmcnt(7) lgkmcnt(3)
    v_mfma_f32_32x32x16_bf16 v[152:167], v[216:219], v[8:11], v[152:167]
    ds_read_b128 v[232:235], v3 offset:0
    s_waitcnt lgkmcnt(3)
    v_mfma_f32_32x32x16_bf16 v[168:183], v[220:223], v[8:11], v[168:183]
    ds_read_b128 v[236:239], v3 offset:4096
    s_add_u32 s31, s27, 2
    s_sub_u32 s33, s31, 9
    s_cmp_ge_u32 s31, 9
    s_cselect_b32 s31, s33, s31
    s_lshl_b32 s31, s31, 12
    s_add_u32 s31, s31, s28
    buffer_load_dwordx4 v[40:43], v248, s[12:15], s31 offen offset:0 sc1
    s_waitcnt lgkmcnt(3)
    v_mfma_f32_32x32x16_bf16 v[184:199], v[224:227], v[8:11], v[184:199]
    ds_read_b128 v[240:243], v3 offset:8192
    s_waitcnt lgkmcnt(3)
    v_mfma_f32_32x32x16_bf16 v[200:215], v[228:231], v[8:11], v[200:215]
    ds_read_b128 v[244:247], v3 offset:12288
    s_waitcnt vmcnt(7) lgkmcnt(3)
    v_mfma_f32_32x32x16_bf16 v[152:167], v[232:235], v[12:15], v[152:167]
    ds_read_b128 v[216:219], v4 offset:0
    s_waitcnt lgkmcnt(3)
    v_mfma_f32_32x32x16_bf16 v[168:183], v[236:239], v[12:15], v[168:183]
    ds_read_b128 v[220:223], v4 offset:4096
    buffer_load_dwordx4 v[44:47], v248, s[12:15], s31 offen offset:1024 sc1
    s_waitcnt lgkmcnt(3)
    v_mfma_f32_32x32x16_bf16 v[184:199], v[240:243], v[12:15], v[184:199]
    ds_read_b128 v[224:227], v4 offset:8192
    s_waitcnt lgkmcnt(3)
    v_mfma_f32_32x32x16_bf16 v[200:215], v[244:247], v[12:15], v[200:215]
    ds_read_b128 v[228:231], v4 offset:12288
    s_waitcnt vmcnt(7) lgkmcnt(3)
    v_mfma_f32_32x32x16_bf16 v[152:167], v[216:219], v[16:19], v[152:167]
    ds_read_b128 v[232:235], v5 offset:0
    s_waitcnt lgkmcnt(3)
    v_mfma_f32_32x32x16_bf16 v[168:183], v[220:223], v[16:19], v[168:183]
    ds_read_b128 v[236:239], v5 offset:4096
    buffer_load_dwordx4 v[48:51], v248, s[12:15], s31 offen offset:2048 sc1
    s_waitcnt lgkmcnt(3)
    v_mfma_f32_32x32x16_bf16 v[184:199], v[224:227], v[16:19], v[184:199]
    ds_read_b128 v[240:243], v5 offset:8192
    s_waitcnt lgkmcnt(3)
    v_mfma_f32_32x32x16_bf16 v[200:215], v[228:231], v[16:19], v[200:215]
    ds_read_b128 v[244:247], v5 offset:12288
    s_waitcnt vmcnt(7) lgkmcnt(3)
    v_mfma_f32_32x32x16_bf16 v[152:167], v[232:235], v[20:23], v[152:167]
    ds_read_b128 v[216:219], v2 offset:16384
    s_waitcnt lgkmcnt(3)
    v_mfma_f32_32x32x16_bf16 v[168:183], v[236:239], v[20:23], v[168:183]
    ds_read_b128 v[220:223], v2 offset:20480
    buffer_load_dwordx4 v[52:55], v248, s[12:15], s31 offen offset:3072 sc1
    s_waitcnt lgkmcnt(3)
    v_mfma_f32_32x32x16_bf16 v[184:199], v[240:243], v[20:23], v[184:199]
    ds_read_b128 v[224:227], v2 offset:24576
    s_waitcnt lgkmcnt(3)
    v_mfma_f32_32x32x16_bf16 v[200:215], v[244:247], v[20:23], v[200:215]
    ds_read_b128 v[228:231], v2 offset:28672
    s_waitcnt vmcnt(7) lgkmcnt(3)
    v_mfma_f32_32x32x16_bf16 v[152:167], v[216:219], v[24:27], v[152:167]
    ds_read_b128 v[232:235], v3 offset:16384
    s_waitcnt lgkmcnt(3)
    v_mfma_f32_32x32x16_bf16 v[168:183], v[220:223], v[24:27], v[168:183]
    ds_read_b128 v[236:239], v3 offset:20480
    s_add_u32 s31, s27, 3
    s_sub_u32 s33, s31, 9
    s_cmp_ge_u32 s31, 9
    s_cselect_b32 s31, s33, s31
    s_lshl_b32 s31, s31, 12
    s_add_u32 s31, s31, s28
    buffer_load_dwordx4 v[56:59], v248, s[12:15], s31 offen offset:0 sc1
    s_waitcnt lgkmcnt(3)
    v_mfma_f32_32x32x16_bf16 v[184:199], v[224:227], v[24:27], v[184:199]
    ds_read_b128 v[240:243], v3 offset:24576
    s_waitcnt lgkmcnt(3)
    v_mfma_f32_32x32x16_bf16 v[200:215], v[228:231], v[24:27], v[200:215]
    ds_read_b128 v[244:247], v3 offset:28672
    s_waitcnt vmcnt(7) lgkmcnt(3)
    v_mfma_f32_32x32x16_bf16 v[152:167], v[232:235], v[28:31], v[152:167]
    ds_read_b128 v[216:219], v4 offset:16384
    s_waitcnt lgkmcnt(3)
    v_mfma_f32_32x32x16_bf16 v[168:183], v[236:239], v[28:31], v[168:183]
    ds_read_b128 v[220:223], v4 offset:20480
    buffer_load_dwordx4 v[60:63], v248, s[12:15], s31 offen offset:1024 sc1
    s_waitcnt lgkmcnt(3)
    v_mfma_f32_32x32x16_bf16 v[184:199], v[240:243], v[28:31], v[184:199]
    ds_read_b128 v[224:227], v4 offset:24576
    s_waitcnt lgkmcnt(3)
    v_mfma_f32_32x32x16_bf16 v[200:215], v[244:247], v[28:31], v[200:215]
    ds_read_b128 v[228:231], v4 offset:28672
    s_waitcnt vmcnt(7) lgkmcnt(3)
    v_mfma_f32_32x32x16_bf16 v[152:167], v[216:219], v[32:35], v[152:167]
    ds_read_b128 v[232:235], v5 offset:16384
    s_waitcnt lgkmcnt(3)
    v_mfma_f32_32x32x16_bf16 v[168:183], v[220:223], v[32:35], v[168:183]
    ds_read_b128 v[236:239], v5 offset:20480
    buffer_load_dwordx4 v[64:67], v248, s[12:15], s31 offen offset:2048 sc1
    s_waitcnt lgkmcnt(3)
    v_mfma_f32_32x32x16_bf16 v[184:199], v[224:227], v[32:35], v[184:199]
    ds_read_b128 v[240:243], v5 offset:24576
    s_waitcnt lgkmcnt(3)
    v_mfma_f32_32x32x16_bf16 v[200:215], v[228:231], v[32:35], v[200:215]
    ds_read_b128 v[244:247], v5 offset:28672
    s_waitcnt vmcnt(7) lgkmcnt(3)
    v_mfma_f32_32x32x16_bf16 v[152:167], v[232:235], v[36:39], v[152:167]
    ds_read_b128 v[216:219], v2 offset:32768
    s_waitcnt lgkmcnt(3)
    v_mfma_f32_32x32x16_bf16 v[168:183], v[236:239], v[36:39], v[168:183]
    ds_read_b128 v[220:223], v2 offset:36864
    buffer_load_dwordx4 v[68:71], v248, s[12:15], s31 offen offset:3072 sc1
    s_waitcnt lgkmcnt(3)
    v_mfma_f32_32x32x16_bf16 v[184:199], v[240:243], v[36:39], v[184:199]
    ds_read_b128 v[224:227], v2 offset:40960
    s_waitcnt lgkmcnt(3)
    v_mfma_f32_32x32x16_bf16 v[200:215], v[244:247], v[36:39], v[200:215]
    ds_read_b128 v[228:231], v2 offset:45056
    s_waitcnt vmcnt(7) lgkmcnt(3)
    v_mfma_f32_32x32x16_bf16 v[152:167], v[216:219], v[40:43], v[152:167]
    ds_read_b128 v[232:235], v3 offset:32768
    s_waitcnt lgkmcnt(3)
    v_mfma_f32_32x32x16_bf16 v[168:183], v[220:223], v[40:43], v[168:183]
    ds_read_b128 v[236:239], v3 offset:36864
    s_add_u32 s31, s27, 4
    s_sub_u32 s33, s31, 9
    s_cmp_ge_u32 s31, 9
    s_cselect_b32 s31, s33, s31
    s_lshl_b32 s31, s31, 12
    s_add_u32 s31, s31, s28
    buffer_load_dwordx4 v[72:75], v248, s[12:15], s31 offen offset:0 sc1
    s_waitcnt lgkmcnt(3)
    v_mfma_f32_32x32x16_bf16 v[184:199], v[224:227], v[40:43], v[184:199]
    ds_read_b128 v[240:243], v3 offset:40960
    s_waitcnt lgkmcnt(3)
    v_mfma_f32_32x32x16_bf16 v[200:215], v[228:231], v[40:43], v[200:215]
    ds_read_b128 v[244:247], v3 offset:45056
    s_waitcnt vmcnt(7) lgkmcnt(3)
    v_mfma_f32_32x32x16_bf16 v[152:167], v[232:235], v[44:47], v[152:167]
    ds_read_b128 v[216:219], v4 offset:32768
    s_waitcnt lgkmcnt(3)
    v_mfma_f32_32x32x16_bf16 v[168:183], v[236:239], v[44:47], v[168:183]
    ds_read_b128 v[220:223], v4 offset:36864
    buffer_load_dwordx4 v[76:79], v248, s[12:15], s31 offen offset:1024 sc1
    s_waitcnt lgkmcnt(3)
    v_mfma_f32_32x32x16_bf16 v[184:199], v[240:243], v[44:47], v[184:199]
    ds_read_b128 v[224:227], v4 offset:40960
    s_waitcnt lgkmcnt(3)
    v_mfma_f32_32x32x16_bf16 v[200:215], v[244:247], v[44:47], v[200:215]
    ds_read_b128 v[228:231], v4 offset:45056
    s_waitcnt vmcnt(7) lgkmcnt(3)
    v_mfma_f32_32x32x16_bf16 v[152:167], v[216:219], v[48:51], v[152:167]
    ds_read_b128 v[232:235], v5 offset:32768
    s_waitcnt lgkmcnt(3)
    v_mfma_f32_32x32x16_bf16 v[168:183], v[220:223], v[48:51], v[168:183]
    ds_read_b128 v[236:239], v5 offset:36864
    buffer_load_dwordx4 v[80:83], v248, s[12:15], s31 offen offset:2048 sc1
    s_waitcnt lgkmcnt(3)
    v_mfma_f32_32x32x16_bf16 v[184:199], v[224:227], v[48:51], v[184:199]
    ds_read_b128 v[240:243], v5 offset:40960
    s_waitcnt lgkmcnt(3)
    v_mfma_f32_32x32x16_bf16 v[200:215], v[228:231], v[48:51], v[200:215]
    ds_read_b128 v[244:247], v5 offset:45056
    s_waitcnt vmcnt(7) lgkmcnt(3)
    v_mfma_f32_32x32x16_bf16 v[152:167], v[232:235], v[52:55], v[152:167]
    ds_read_b128 v[216:219], v2 offset:49152
    s_waitcnt lgkmcnt(3)
    v_mfma_f32_32x32x16_bf16 v[168:183], v[236:239], v[52:55], v[168:183]
    ds_read_b128 v[220:223], v2 offset:53248
    buffer_load_dwordx4 v[84:87], v248, s[12:15], s31 offen offset:3072 sc1
    s_waitcnt lgkmcnt(3)
    v_mfma_f32_32x32x16_bf16 v[184:199], v[240:243], v[52:55], v[184:199]
    ds_read_b128 v[224:227], v2 offset:57344
    s_waitcnt lgkmcnt(3)
    v_mfma_f32_32x32x16_bf16 v[200:215], v[244:247], v[52:55], v[200:215]
    ds_read_b128 v[228:231], v2 offset:61440
    s_waitcnt vmcnt(7) lgkmcnt(3)
    v_mfma_f32_32x32x16_bf16 v[152:167], v[216:219], v[56:59], v[152:167]
    ds_read_b128 v[232:235], v3 offset:49152
    s_waitcnt lgkmcnt(3)
    v_mfma_f32_32x32x16_bf16 v[168:183], v[220:223], v[56:59], v[168:183]
    ds_read_b128 v[236:239], v3 offset:53248
    s_add_u32 s31, s27, 5
    s_sub_u32 s33, s31, 9
    s_cmp_ge_u32 s31, 9
    s_cselect_b32 s31, s33, s31
    s_lshl_b32 s31, s31, 12
    s_add_u32 s31, s31, s28
    buffer_load_dwordx4 v[88:91], v248, s[12:15], s31 offen offset:0 sc1
    s_waitcnt lgkmcnt(3)
    v_mfma_f32_32x32x16_bf16 v[184:199], v[224:227], v[56:59], v[184:199]
    ds_read_b128 v[240:243], v3 offset:57344
    s_waitcnt lgkmcnt(3)
    v_mfma_f32_32x32x16_bf16 v[200:215], v[228:231], v[56:59], v[200:215]
    ds_read_b128 v[244:247], v3 offset:61440
    s_waitcnt vmcnt(7) lgkmcnt(3)
    v_mfma_f32_32x32x16_bf16 v[152:167], v[232:235], v[60:63], v[152:167]
    ds_read_b128 v[216:219], v4 offset:49152
    s_waitcnt lgkmcnt(3)
    v_mfma_f32_32x32x16_bf16 v[168:183], v[236:239], v[60:63], v[168:183]
    ds_read_b128 v[220:223], v4 offset:53248
    buffer_load_dwordx4 v[92:95], v248, s[12:15], s31 offen offset:1024 sc1
    s_waitcnt lgkmcnt(3)
    v_mfma_f32_32x32x16_bf16 v[184:199], v[240:243], v[60:63], v[184:199]
    ds_read_b128 v[224:227], v4 offset:57344
    s_waitcnt lgkmcnt(3)
    v_mfma_f32_32x32x16_bf16 v[200:215], v[244:247], v[60:63], v[200:215]
    ds_read_b128 v[228:231], v4 offset:61440
    s_waitcnt vmcnt(7) lgkmcnt(3)
    v_mfma_f32_32x32x16_bf16 v[152:167], v[216:219], v[64:67], v[152:167]
    ds_read_b128 v[232:235], v5 offset:49152
    s_waitcnt lgkmcnt(3)
    v_mfma_f32_32x32x16_bf16 v[168:183], v[220:223], v[64:67], v[168:183]
    ds_read_b128 v[236:239], v5 offset:53248
    buffer_load_dwordx4 v[96:99], v248, s[12:15], s31 offen offset:2048 sc1
    s_waitcnt lgkmcnt(3)
    v_mfma_f32_32x32x16_bf16 v[184:199], v[224:227], v[64:67], v[184:199]
    ds_read_b128 v[240:243], v5 offset:57344
    s_waitcnt lgkmcnt(3)
    v_mfma_f32_32x32x16_bf16 v[200:215], v[228:231], v[64:67], v[200:215]
    ds_read_b128 v[244:247], v5 offset:61440
    s_waitcnt vmcnt(7) lgkmcnt(3)
    v_mfma_f32_32x32x16_bf16 v[152:167], v[232:235], v[68:71], v[152:167]
    v_add_u32 v2, 0x10000, v2
    v_add_u32 v3, 0x10000, v3
    v_add_u32 v4, 0x10000, v4
    v_add_u32 v5, 0x10000, v5
    ds_read_b128 v[216:219], v2 offset:0
    s_waitcnt lgkmcnt(3)
    v_mfma_f32_32x32x16_bf16 v[168:183], v[236:239], v[68:71], v[168:183]
    ds_read_b128 v[220:223], v2 offset:4096
    buffer_load_dwordx4 v[100:103], v248, s[12:15], s31 offen offset:3072 sc1
    s_waitcnt lgkmcnt(3)
    v_mfma_f32_32x32x16_bf16 v[184:199], v[240:243], v[68:71], v[184:199]
    ds_read_b128 v[224:227], v2 offset:8192
    s_waitcnt lgkmcnt(3)
    v_mfma_f32_32x32x16_bf16 v[200:215], v[244:247], v[68:71], v[200:215]
    ds_read_b128 v[228:231], v2 offset:12288
    s_waitcnt vmcnt(7) lgkmcnt(3)
    v_mfma_f32_32x32x16_bf16 v[152:167], v[216:219], v[72:75], v[152:167]
    ds_read_b128 v[232:235], v3 offset:0
    s_waitcnt lgkmcnt(3)
    v_mfma_f32_32x32x16_bf16 v[168:183], v[220:223], v[72:75], v[168:183]
    ds_read_b128 v[236:239], v3 offset:4096
    s_add_u32 s31, s27, 6
    s_sub_u32 s33, s31, 9
    s_cmp_ge_u32 s31, 9
    s_cselect_b32 s31, s33, s31
    s_lshl_b32 s31, s31, 12
    s_add_u32 s31, s31, s28
    buffer_load_dwordx4 v[104:107], v248, s[12:15], s31 offen offset:0 sc1
    s_waitcnt lgkmcnt(3)
    v_mfma_f32_32x32x16_bf16 v[184:199], v[224:227], v[72:75], v[184:199]
    ds_read_b128 v[240:243], v3 offset:8192
    s_waitcnt lgkmcnt(3)
    v_mfma_f32_32x32x16_bf16 v[200:215], v[228:231], v[72:75], v[200:215]
    ds_read_b128 v[244:247], v3 offset:12288
    s_waitcnt vmcnt(7) lgkmcnt(3)
    v_mfma_f32_32x32x16_bf16 v[152:167], v[232:235], v[76:79], v[152:167]
    ds_read_b128 v[216:219], v4 offset:0
    s_waitcnt lgkmcnt(3)
    v_mfma_f32_32x32x16_bf16 v[168:183], v[236:239], v[76:79], v[168:183]
    ds_read_b128 v[220:223], v4 offset:4096
    buffer_load_dwordx4 v[108:111], v248, s[12:15], s31 offen offset:1024 sc1
    s_waitcnt lgkmcnt(3)
    v_mfma_f32_32x32x16_bf16 v[184:199], v[240:243], v[76:79], v[184:199]
    ds_read_b128 v[224:227], v4 offset:8192
    s_waitcnt lgkmcnt(3)
    v_mfma_f32_32x32x16_bf16 v[200:215], v[244:247], v[76:79], v[200:215]
    ds_read_b128 v[228:231], v4 offset:12288
    s_waitcnt vmcnt(7) lgkmcnt(3)
    v_mfma_f32_32x32x16_bf16 v[152:167], v[216:219], v[80:83], v[152:167]
    ds_read_b128 v[232:235], v5 offset:0
    s_waitcnt lgkmcnt(3)
    v_mfma_f32_32x32x16_bf16 v[168:183], v[220:223], v[80:83], v[168:183]
    ds_read_b128 v[236:239], v5 offset:4096
    buffer_load_dwordx4 v[112:115], v248, s[12:15], s31 offen offset:2048 sc1
    s_waitcnt lgkmcnt(3)
    v_mfma_f32_32x32x16_bf16 v[184:199], v[224:227], v[80:83], v[184:199]
    ds_read_b128 v[240:243], v5 offset:8192
    s_waitcnt lgkmcnt(3)
    v_mfma_f32_32x32x16_bf16 v[200:215], v[228:231], v[80:83], v[200:215]
    ds_read_b128 v[244:247], v5 offset:12288
    s_waitcnt vmcnt(7) lgkmcnt(3)
    v_mfma_f32_32x32x16_bf16 v[152:167], v[232:235], v[84:87], v[152:167]
    ds_read_b128 v[216:219], v2 offset:16384
    s_waitcnt lgkmcnt(3)
    v_mfma_f32_32x32x16_bf16 v[168:183], v[236:239], v[84:87], v[168:183]
    ds_read_b128 v[220:223], v2 offset:20480
    buffer_load_dwordx4 v[116:119], v248, s[12:15], s31 offen offset:3072 sc1
    s_waitcnt lgkmcnt(3)
    v_mfma_f32_32x32x16_bf16 v[184:199], v[240:243], v[84:87], v[184:199]
    ds_read_b128 v[224:227], v2 offset:24576
    s_waitcnt lgkmcnt(3)
    v_mfma_f32_32x32x16_bf16 v[200:215], v[244:247], v[84:87], v[200:215]
    ds_read_b128 v[228:231], v2 offset:28672
    s_waitcnt vmcnt(7) lgkmcnt(3)
    v_mfma_f32_32x32x16_bf16 v[152:167], v[216:219], v[88:91], v[152:167]
    ds_read_b128 v[232:235], v3 offset:16384
    s_waitcnt lgkmcnt(3)
    v_mfma_f32_32x32x16_bf16 v[168:183], v[220:223], v[88:91], v[168:183]
    ds_read_b128 v[236:239], v3 offset:20480
    s_add_u32 s31, s27, 7
    s_sub_u32 s33, s31, 9
    s_cmp_ge_u32 s31, 9
    s_cselect_b32 s31, s33, s31
    s_lshl_b32 s31, s31, 12
    s_add_u32 s31, s31, s28
    buffer_load_dwordx4 v[120:123], v248, s[12:15], s31 offen offset:0 sc1
    s_waitcnt lgkmcnt(3)
    v_mfma_f32_32x32x16_bf16 v[184:199], v[224:227], v[88:91], v[184:199]
    ds_read_b128 v[240:243], v3 offset:24576
    s_waitcnt lgkmcnt(3)
    v_mfma_f32_32x32x16_bf16 v[200:215], v[228:231], v[88:91], v[200:215]
    ds_read_b128 v[244:247], v3 offset:28672
    s_waitcnt vmcnt(7) lgkmcnt(3)
    v_mfma_f32_32x32x16_bf16 v[152:167], v[232:235], v[92:95], v[152:167]
    ds_read_b128 v[216:219], v4 offset:16384
    s_waitcnt lgkmcnt(3)
    v_mfma_f32_32x32x16_bf16 v[168:183], v[236:239], v[92:95], v[168:183]
    ds_read_b128 v[220:223], v4 offset:20480
    buffer_load_dwordx4 v[124:127], v248, s[12:15], s31 offen offset:1024 sc1
    s_waitcnt lgkmcnt(3)
    v_mfma_f32_32x32x16_bf16 v[184:199], v[240:243], v[92:95], v[184:199]
    ds_read_b128 v[224:227], v4 offset:24576
    s_waitcnt lgkmcnt(3)
    v_mfma_f32_32x32x16_bf16 v[200:215], v[244:247], v[92:95], v[200:215]
    ds_read_b128 v[228:231], v4 offset:28672
    s_waitcnt vmcnt(7) lgkmcnt(3)
    v_mfma_f32_32x32x16_bf16 v[152:167], v[216:219], v[96:99], v[152:167]
    ds_read_b128 v[232:235], v5 offset:16384
    s_waitcnt lgkmcnt(3)
    v_mfma_f32_32x32x16_bf16 v[168:183], v[220:223], v[96:99], v[168:183]
    ds_read_b128 v[236:239], v5 offset:20480
    buffer_load_dwordx4 v[128:131], v248, s[12:15], s31 offen offset:2048 sc1
    s_waitcnt lgkmcnt(3)
    v_mfma_f32_32x32x16_bf16 v[184:199], v[224:227], v[96:99], v[184:199]
    ds_read_b128 v[240:243], v5 offset:24576
    s_waitcnt lgkmcnt(3)
    v_mfma_f32_32x32x16_bf16 v[200:215], v[228:231], v[96:99], v[200:215]
    ds_read_b128 v[244:247], v5 offset:28672
    s_waitcnt vmcnt(7) lgkmcnt(3)
    v_mfma_f32_32x32x16_bf16 v[152:167], v[232:235], v[100:103], v[152:167]
    ds_read_b128 v[216:219], v2 offset:32768
    s_waitcnt lgkmcnt(3)
    v_mfma_f32_32x32x16_bf16 v[168:183], v[236:239], v[100:103], v[168:183]
    ds_read_b128 v[220:223], v2 offset:36864
    buffer_load_dwordx4 v[132:135], v248, s[12:15], s31 offen offset:3072 sc1
    s_waitcnt lgkmcnt(3)
    v_mfma_f32_32x32x16_bf16 v[184:199], v[240:243], v[100:103], v[184:199]
    ds_read_b128 v[224:227], v2 offset:40960
    s_waitcnt lgkmcnt(3)
    v_mfma_f32_32x32x16_bf16 v[200:215], v[244:247], v[100:103], v[200:215]
    ds_read_b128 v[228:231], v2 offset:45056
    s_waitcnt vmcnt(7) lgkmcnt(3)
    v_mfma_f32_32x32x16_bf16 v[152:167], v[216:219], v[104:107], v[152:167]
    ds_read_b128 v[232:235], v3 offset:32768
    s_waitcnt lgkmcnt(3)
    v_mfma_f32_32x32x16_bf16 v[168:183], v[220:223], v[104:107], v[168:183]
    ds_read_b128 v[236:239], v3 offset:36864
    s_add_u32 s31, s27, 8
    s_sub_u32 s33, s31, 9
    s_cmp_ge_u32 s31, 9
    s_cselect_b32 s31, s33, s31
    s_lshl_b32 s31, s31, 12
    s_add_u32 s31, s31, s28
    buffer_load_dwordx4 v[136:139], v248, s[12:15], s31 offen offset:0 sc1
    s_waitcnt lgkmcnt(3)
    v_mfma_f32_32x32x16_bf16 v[184:199], v[224:227], v[104:107], v[184:199]
    ds_read_b128 v[240:243], v3 offset:40960
    s_waitcnt lgkmcnt(3)
    v_mfma_f32_32x32x16_bf16 v[200:215], v[228:231], v[104:107], v[200:215]
    ds_read_b128 v[244:247], v3 offset:45056
    s_waitcnt vmcnt(7) lgkmcnt(3)
    v_mfma_f32_32x32x16_bf16 v[152:167], v[232:235], v[108:111], v[152:167]
    ds_read_b128 v[216:219], v4 offset:32768
    s_waitcnt lgkmcnt(3)
    v_mfma_f32_32x32x16_bf16 v[168:183], v[236:239], v[108:111], v[168:183]
    ds_read_b128 v[220:223], v4 offset:36864
    buffer_load_dwordx4 v[140:143], v248, s[12:15], s31 offen offset:1024 sc1
    s_waitcnt lgkmcnt(3)
    v_mfma_f32_32x32x16_bf16 v[184:199], v[240:243], v[108:111], v[184:199]
    ds_read_b128 v[224:227], v4 offset:40960
    s_waitcnt lgkmcnt(3)
    v_mfma_f32_32x32x16_bf16 v[200:215], v[244:247], v[108:111], v[200:215]
    ds_read_b128 v[228:231], v4 offset:45056
    s_waitcnt vmcnt(7) lgkmcnt(3)
    v_mfma_f32_32x32x16_bf16 v[152:167], v[216:219], v[112:115], v[152:167]
    ds_read_b128 v[232:235], v5 offset:32768
    s_waitcnt lgkmcnt(3)
    v_mfma_f32_32x32x16_bf16 v[168:183], v[220:223], v[112:115], v[168:183]
    ds_read_b128 v[236:239], v5 offset:36864
    buffer_load_dwordx4 v[144:147], v248, s[12:15], s31 offen offset:2048 sc1
    s_waitcnt lgkmcnt(3)
    v_mfma_f32_32x32x16_bf16 v[184:199], v[224:227], v[112:115], v[184:199]
    ds_read_b128 v[240:243], v5 offset:40960
    s_waitcnt lgkmcnt(3)
    v_mfma_f32_32x32x16_bf16 v[200:215], v[228:231], v[112:115], v[200:215]
    ds_read_b128 v[244:247], v5 offset:45056
    s_waitcnt vmcnt(7) lgkmcnt(3)
    v_mfma_f32_32x32x16_bf16 v[152:167], v[232:235], v[116:119], v[152:167]
    ds_read_b128 v[216:219], v2 offset:49152
    s_waitcnt lgkmcnt(3)
    v_mfma_f32_32x32x16_bf16 v[168:183], v[236:239], v[116:119], v[168:183]
    ds_read_b128 v[220:223], v2 offset:53248
    buffer_load_dwordx4 v[148:151], v248, s[12:15], s31 offen offset:3072 sc1
    s_waitcnt lgkmcnt(3)
    v_mfma_f32_32x32x16_bf16 v[184:199], v[240:243], v[116:119], v[184:199]
    ds_read_b128 v[224:227], v2 offset:57344
    s_waitcnt lgkmcnt(3)
    v_mfma_f32_32x32x16_bf16 v[200:215], v[244:247], v[116:119], v[200:215]
    ds_read_b128 v[228:231], v2 offset:61440
    s_waitcnt vmcnt(7) lgkmcnt(3)
    v_mfma_f32_32x32x16_bf16 v[152:167], v[216:219], v[120:123], v[152:167]
    ds_read_b128 v[232:235], v3 offset:49152
    s_waitcnt lgkmcnt(3)
    v_mfma_f32_32x32x16_bf16 v[168:183], v[220:223], v[120:123], v[168:183]
    ds_read_b128 v[236:239], v3 offset:53248
    s_waitcnt lgkmcnt(3)
    v_mfma_f32_32x32x16_bf16 v[184:199], v[224:227], v[120:123], v[184:199]
    ds_read_b128 v[240:243], v3 offset:57344
    s_waitcnt lgkmcnt(3)
    v_mfma_f32_32x32x16_bf16 v[200:215], v[228:231], v[120:123], v[200:215]
    ds_read_b128 v[244:247], v3 offset:61440
    s_waitcnt vmcnt(6) lgkmcnt(3)
    v_mfma_f32_32x32x16_bf16 v[152:167], v[232:235], v[124:127], v[152:167]
    ds_read_b128 v[216:219], v4 offset:49152
    s_waitcnt lgkmcnt(3)
    v_mfma_f32_32x32x16_bf16 v[168:183], v[236:239], v[124:127], v[168:183]
    ds_read_b128 v[220:223], v4 offset:53248
    s_waitcnt lgkmcnt(3)
    v_mfma_f32_32x32x16_bf16 v[184:199], v[240:243], v[124:127], v[184:199]
    ds_read_b128 v[224:227], v4 offset:57344
    s_waitcnt lgkmcnt(3)
    v_mfma_f32_32x32x16_bf16 v[200:215], v[244:247], v[124:127], v[200:215]
    ds_read_b128 v[228:231], v4 offset:61440
    s_waitcnt vmcnt(5) lgkmcnt(3)
    v_mfma_f32_32x32x16_bf16 v[152:167], v[216:219], v[128:131], v[152:167]
    ds_read_b128 v[232:235], v5 offset:49152
    s_waitcnt lgkmcnt(3)
    v_mfma_f32_32x32x16_bf16 v[168:183], v[220:223], v[128:131], v[168:183]
    ds_read_b128 v[236:239], v5 offset:53248
    s_waitcnt lgkmcnt(3)
    v_mfma_f32_32x32x16_bf16 v[184:199], v[224:227], v[128:131], v[184:199]
    ds_read_b128 v[240:243], v5 offset:57344
    s_waitcnt lgkmcnt(3)
    v_mfma_f32_32x32x16_bf16 v[200:215], v[228:231], v[128:131], v[200:215]
    ds_read_b128 v[244:247], v5 offset:61440
    s_waitcnt vmcnt(4) lgkmcnt(3)
    v_mfma_f32_32x32x16_bf16 v[152:167], v[232:235], v[132:135], v[152:167]
    v_add_u32 v2, 0x10000, v2
    v_add_u32 v3, 0x10000, v3
    v_add_u32 v4, 0x10000, v4
    v_add_u32 v5, 0x10000, v5
    ds_read_b128 v[216:219], v2 offset:0
    s_waitcnt lgkmcnt(3)
    v_mfma_f32_32x32x16_bf16 v[168:183], v[236:239], v[132:135], v[168:183]
    ds_read_b128 v[220:223], v2 offset:4096
    s_waitcnt lgkmcnt(3)
    v_mfma_f32_32x32x16_bf16 v[184:199], v[240:243], v[132:135], v[184:199]
    ds_read_b128 v[224:227], v2 offset:8192
    s_waitcnt lgkmcnt(3)
    v_mfma_f32_32x32x16_bf16 v[200:215], v[244:247], v[132:135], v[200:215]
    ds_read_b128 v[228:231], v2 offset:12288
    s_waitcnt vmcnt(3) lgkmcnt(3)
    v_mfma_f32_32x32x16_bf16 v[152:167], v[216:219], v[136:139], v[152:167]
    ds_read_b128 v[232:235], v3 offset:0
    s_waitcnt lgkmcnt(3)
    v_mfma_f32_32x32x16_bf16 v[168:183], v[220:223], v[136:139], v[168:183]
    ds_read_b128 v[236:239], v3 offset:4096
    s_waitcnt lgkmcnt(3)
    v_mfma_f32_32x32x16_bf16 v[184:199], v[224:227], v[136:139], v[184:199]
    ds_read_b128 v[240:243], v3 offset:8192
    s_waitcnt lgkmcnt(3)
    v_mfma_f32_32x32x16_bf16 v[200:215], v[228:231], v[136:139], v[200:215]
    ds_read_b128 v[244:247], v3 offset:12288
    s_waitcnt vmcnt(2) lgkmcnt(3)
    v_mfma_f32_32x32x16_bf16 v[152:167], v[232:235], v[140:143], v[152:167]
    ds_read_b128 v[216:219], v4 offset:0
    s_waitcnt lgkmcnt(3)
    v_mfma_f32_32x32x16_bf16 v[168:183], v[236:239], v[140:143], v[168:183]
    ds_read_b128 v[220:223], v4 offset:4096
    s_waitcnt lgkmcnt(3)
    v_mfma_f32_32x32x16_bf16 v[184:199], v[240:243], v[140:143], v[184:199]
    ds_read_b128 v[224:227], v4 offset:8192
    s_waitcnt lgkmcnt(3)
    v_mfma_f32_32x32x16_bf16 v[200:215], v[244:247], v[140:143], v[200:215]
    ds_read_b128 v[228:231], v4 offset:12288
    s_waitcnt vmcnt(1) lgkmcnt(3)
    v_mfma_f32_32x32x16_bf16 v[152:167], v[216:219], v[144:147], v[152:167]
    ds_read_b128 v[232:235], v5 offset:0
    s_waitcnt lgkmcnt(3)
    v_mfma_f32_32x32x16_bf16 v[168:183], v[220:223], v[144:147], v[168:183]
    ds_read_b128 v[236:239], v5 offset:4096
    s_waitcnt lgkmcnt(3)
    v_mfma_f32_32x32x16_bf16 v[184:199], v[224:227], v[144:147], v[184:199]
    ds_read_b128 v[240:243], v5 offset:8192
    s_waitcnt lgkmcnt(3)
    v_mfma_f32_32x32x16_bf16 v[200:215], v[228:231], v[144:147], v[200:215]
    ds_read_b128 v[244:247], v5 offset:12288
    s_waitcnt vmcnt(0) lgkmcnt(3)
    v_mfma_f32_32x32x16_bf16 v[152:167], v[232:235], v[148:151], v[152:167]
    s_waitcnt lgkmcnt(2)
    v_mfma_f32_32x32x16_bf16 v[168:183], v[236:239], v[148:151], v[168:183]
    s_waitcnt lgkmcnt(1)
    v_mfma_f32_32x32x16_bf16 v[184:199], v[240:243], v[148:151], v[184:199]
    s_waitcnt lgkmcnt(0)
    v_mfma_f32_32x32x16_bf16 v[200:215], v[244:247], v[148:151], v[200:215]
    s_barrier
A_EPI:
    s_setprio 0
    s_lshl_b32 s30, s25, 7
    v_lshl_add_u32 v80, v250, 4, s30
    v_lshlrev_b32 v81, 2, v249
    v_add_u32 v82, s30, v81
    ds_read_b128 v[8:11], v80 offset:2048
    ds_read_b128 v[12:15], v80 offset:2080
    ds_read_b128 v[16:19], v80 offset:2112
    ds_read_b128 v[20:23], v80 offset:2144
    ds_read_b32 v84, v82 offset:2048
    ds_read_b32 v72, v81 offset:0
    ds_read_b32 v76, v81 offset:512
    ds_read_b32 v73, v81 offset:128
    ds_read_b32 v77, v81 offset:640
    ds_read_b32 v74, v81 offset:256
    ds_read_b32 v78, v81 offset:768
    ds_read_b32 v75, v81 offset:384
    ds_read_b32 v79, v81 offset:896
    s_lshr_b32 s35, s23, 1
    s_mul_i32 s35, s35, 19456
    s_mul_i32 s38, s24, 311296
    s_add_u32 s38, s38, s35
    s_add_u32 s38, s38, 12795904
    s_and_b32 s36, s23, 1
    s_lshl_b32 s37, s36, 2
    s_mul_i32 s39, s37, 2304
    s_add_u32 s39, s39, s38
    s_waitcnt lgkmcnt(0)
    s_cmp_eq_u32 s25, 2
    s_cbranch_scc1 A_E2
    s_cmp_eq_u32 s25, 3
    s_cbranch_scc1 A_E3
    s_lshl_b32 s40, s24, 17
    s_lshl_b32 s41, s23, 12
    s_add_u32 s40, s40, s41
    s_add_u32 s40, s40, 8077312
    s_add_u32 s41, s39, 1024
    s_cmp_eq_u32 s25, 0
    s_cselect_b32 s42, 0x3eae1a93, 1.0
    s_cselect_b32 s43, s40, s41
    s_mov_b32 s40, 2304
    s_cselect_b32 s44, 1024, s40
    s_mov_b32 s40, 155648
    s_cselect_b32 s45, 65536, s40
    v_mul_f32 v80, s42, v76
    v_fma_f32 v152, -v72, v8, v152
    v_fma_f32 v153, -v72, v9, v153
    v_fma_f32 v154, -v72, v10, v154
    v_fma_f32 v155, -v72, v11, v155
    v_fma_f32 v156, -v72, v12, v156
    v_fma_f32 v157, -v72, v13, v157
    v_fma_f32 v158, -v72, v14, v158
    v_fma_f32 v159, -v72, v15, v159
    v_fma_f32 v160, -v72, v16, v160
    v_fma_f32 v161, -v72, v17, v161
    v_fma_f32 v162, -v72, v18, v162
    v_fma_f32 v163, -v72, v19, v163
    v_fma_f32 v164, -v72, v20, v164
    v_fma_f32 v165, -v72, v21, v165
    v_fma_f32 v166, -v72, v22, v166
    v_fma_f32 v167, -v72, v23, v167
    v_mul_f32 v152, v80, v152
    v_mul_f32 v153, v80, v153
    v_mul_f32 v154, v80, v154
    v_mul_f32 v155, v80, v155
    v_mul_f32 v156, v80, v156
    v_mul_f32 v157, v80, v157
    v_mul_f32 v158, v80, v158
    v_mul_f32 v159, v80, v159
    v_mul_f32 v160, v80, v160
    v_mul_f32 v161, v80, v161
    v_mul_f32 v162, v80, v162
    v_mul_f32 v163, v80, v163
    v_mul_f32 v164, v80, v164
    v_mul_f32 v165, v80, v165
    v_mul_f32 v166, v80, v166
    v_mul_f32 v167, v80, v167
    v_cvt_pk_bf16_f32 v96, v152, v153
    v_cvt_pk_bf16_f32 v97, v154, v155
    v_cvt_pk_bf16_f32 v98, v156, v157
    v_cvt_pk_bf16_f32 v99, v158, v159
    s_mov_b32 s46, s43
    buffer_store_dwordx4 v[96:99], v248, s[12:15], s46 offen sc1
    v_cvt_pk_bf16_f32 v100, v160, v161
    v_cvt_pk_bf16_f32 v101, v162, v163
    v_cvt_pk_bf16_f32 v102, v164, v165
    v_cvt_pk_bf16_f32 v103, v166, v167
    s_add_u32 s46, s43, s45
    buffer_store_dwordx4 v[100:103], v248, s[12:15], s46 offen sc1
    s_add_u32 s43, s43, s44
    v_mul_f32 v80, s42, v77
    v_fma_f32 v168, -v73, v8, v168
    v_fma_f32 v169, -v73, v9, v169
    v_fma_f32 v170, -v73, v10, v170
    v_fma_f32 v171, -v73, v11, v171
    v_fma_f32 v172, -v73, v12, v172
    v_fma_f32 v173, -v73, v13, v173
    v_fma_f32 v174, -v73, v14, v174
    v_fma_f32 v175, -v73, v15, v175
    v_fma_f32 v176, -v73, v16, v176
    v_fma_f32 v177, -v73, v17, v177
    v_fma_f32 v178, -v73, v18, v178
    v_fma_f32 v179, -v73, v19, v179
    v_fma_f32 v180, -v73, v20, v180
    v_fma_f32 v181, -v73, v21, v181
    v_fma_f32 v182, -v73, v22, v182
    v_fma_f32 v183, -v73, v23, v183
    v_mul_f32 v168, v80, v168
    v_mul_f32 v169, v80, v169
    v_mul_f32 v170, v80, v170
    v_mul_f32 v171, v80, v171
    v_mul_f32 v172, v80, v172
    v_mul_f32 v173, v80, v173
    v_mul_f32 v174, v80, v174
    v_mul_f32 v175, v80, v175
    v_mul_f32 v176, v80, v176
    v_mul_f32 v177, v80, v177
    v_mul_f32 v178, v80, v178
    v_mul_f32 v179, v80, v179
    v_mul_f32 v180, v80, v180
    v_mul_f32 v181, v80, v181
    v_mul_f32 v182, v80, v182
    v_mul_f32 v183, v80, v183
    v_cvt_pk_bf16_f32 v104, v168, v169
    v_cvt_pk_bf16_f32 v105, v170, v171
    v_cvt_pk_bf16_f32 v106, v172, v173
    v_cvt_pk_bf16_f32 v107, v174, v175
    s_mov_b32 s46, s43
    buffer_store_dwordx4 v[104:107], v248, s[12:15], s46 offen sc1
    v_cvt_pk_bf16_f32 v108, v176, v177
    v_cvt_pk_bf16_f32 v109, v178, v179
    v_cvt_pk_bf16_f32 v110, v180, v181
    v_cvt_pk_bf16_f32 v111, v182, v183
    s_add_u32 s46, s43, s45
    buffer_store_dwordx4 v[108:111], v248, s[12:15], s46 offen sc1
    s_add_u32 s43, s43, s44
    v_mul_f32 v80, s42, v78
    v_fma_f32 v184, -v74, v8, v184
    v_fma_f32 v185, -v74, v9, v185
    v_fma_f32 v186, -v74, v10, v186
    v_fma_f32 v187, -v74, v11, v187
    v_fma_f32 v188, -v74, v12, v188
    v_fma_f32 v189, -v74, v13, v189
    v_fma_f32 v190, -v74, v14, v190
    v_fma_f32 v191, -v74, v15, v191
    v_fma_f32 v192, -v74, v16, v192
    v_fma_f32 v193, -v74, v17, v193
    v_fma_f32 v194, -v74, v18, v194
    v_fma_f32 v195, -v74, v19, v195
    v_fma_f32 v196, -v74, v20, v196
    v_fma_f32 v197, -v74, v21, v197
    v_fma_f32 v198, -v74, v22, v198
    v_fma_f32 v199, -v74, v23, v199
    v_mul_f32 v184, v80, v184
    v_mul_f32 v185, v80, v185
    v_mul_f32 v186, v80, v186
    v_mul_f32 v187, v80, v187
    v_mul_f32 v188, v80, v188
    v_mul_f32 v189, v80, v189
    v_mul_f32 v190, v80, v190
    v_mul_f32 v191, v80, v191
    v_mul_f32 v192, v80, v192
    v_mul_f32 v193, v80, v193
    v_mul_f32 v194, v80, v194
    v_mul_f32 v195, v80, v195
    v_mul_f32 v196, v80, v196
    v_mul_f32 v197, v80, v197
    v_mul_f32 v198, v80, v198
    v_mul_f32 v199, v80, v199
    v_cvt_pk_bf16_f32 v112, v184, v185
    v_cvt_pk_bf16_f32 v113, v186, v187
    v_cvt_pk_bf16_f32 v114, v188, v189
    v_cvt_pk_bf16_f32 v115, v190, v191
    s_mov_b32 s46, s43
    buffer_store_dwordx4 v[112:115], v248, s[12:15], s46 offen sc1
    v_cvt_pk_bf16_f32 v116, v192, v193
    v_cvt_pk_bf16_f32 v117, v194, v195
    v_cvt_pk_bf16_f32 v118, v196, v197
    v_cvt_pk_bf16_f32 v119, v198, v199
    s_add_u32 s46, s43, s45
    buffer_store_dwordx4 v[116:119], v248, s[12:15], s46 offen sc1
    s_add_u32 s43, s43, s44
    v_mul_f32 v80, s42, v79
    v_fma_f32 v200, -v75, v8, v200
    v_fma_f32 v201, -v75, v9, v201
    v_fma_f32 v202, -v75, v10, v202
    v_fma_f32 v203, -v75, v11, v203
    v_fma_f32 v204, -v75, v12, v204
    v_fma_f32 v205, -v75, v13, v205
    v_fma_f32 v206, -v75, v14, v206
    v_fma_f32 v207, -v75, v15, v207
    v_fma_f32 v208, -v75, v16, v208
    v_fma_f32 v209, -v75, v17, v209
    v_fma_f32 v210, -v75, v18, v210
    v_fma_f32 v211, -v75, v19, v211
    v_fma_f32 v212, -v75, v20, v212
    v_fma_f32 v213, -v75, v21, v213
    v_fma_f32 v214, -v75, v22, v214
    v_fma_f32 v215, -v75, v23, v215
    v_mul_f32 v200, v80, v200
    v_mul_f32 v201, v80, v201
    v_mul_f32 v202, v80, v202
    v_mul_f32 v203, v80, v203
    v_mul_f32 v204, v80, v204
    v_mul_f32 v205, v80, v205
    v_mul_f32 v206, v80, v206
    v_mul_f32 v207, v80, v207
    v_mul_f32 v208, v80, v208
    v_mul_f32 v209, v80, v209
    v_mul_f32 v210, v80, v210
    v_mul_f32 v211, v80, v211
    v_mul_f32 v212, v80, v212
    v_mul_f32 v213, v80, v213
    v_mul_f32 v214, v80, v214
    v_mul_f32 v215, v80, v215
    v_cvt_pk_bf16_f32 v120, v200, v201
    v_cvt_pk_bf16_f32 v121, v202, v203
    v_cvt_pk_bf16_f32 v122, v204, v205
    v_cvt_pk_bf16_f32 v123, v206, v207
    s_mov_b32 s46, s43
    buffer_store_dwordx4 v[120:123], v248, s[12:15], s46 offen sc1
    v_cvt_pk_bf16_f32 v124, v208, v209
    v_cvt_pk_bf16_f32 v125, v210, v211
    v_cvt_pk_bf16_f32 v126, v212, v213
    v_cvt_pk_bf16_f32 v127, v214, v215
    s_add_u32 s46, s43, s45
    buffer_store_dwordx4 v[124:127], v248, s[12:15], s46 offen sc1
    s_add_u32 s43, s43, s44
    s_branch A_FIN
A_E3:
    v_cmp_eq_u32 vcc, 0, v250
    s_lshl_b32 s40, s24, 14
    s_lshl_b32 s41, s23, 9
    s_add_u32 s40, s40, s41
    s_add_u32 s40, s40, 12271616
    s_lshl_b32 s41, s36, 9
    s_add_u32 s41, s41, s38
    v_mov_b32 v80, 0x3eae1a93
    v_mov_b32 v81, s41
    v_mov_b32 v82, s40
    v_mov_b32 v83, 155648
    v_mov_b32 v85, 8192
    v_cndmask_b32 v80, 1.0, v80, vcc
    v_cndmask_b32 v81, v81, v82, vcc
    v_cndmask_b32 v83, v83, v85, vcc
    v_lshl_add_u32 v81, v249, 2, v81
    v_add_u32 v82, v81, v83
    v_bfe_u32 v85, v249, 2, 1
    v_bfe_u32 v86, v249, 3, 1
    v_and_b32 v87, 0x13, v249
    v_lshl_add_u32 v87, v85, 3, v87
    v_lshl_add_u32 v87, v86, 2, v87
    v_lshlrev_b32 v87, 1, v87
    v_fma_f32 v152, -v72, v8, v152
    v_fma_f32 v153, -v72, v9, v153
    v_fma_f32 v154, -v72, v10, v154
    v_fma_f32 v155, -v72, v11, v155
    v_fma_f32 v156, -v72, v12, v156
    v_fma_f32 v157, -v72, v13, v157
    v_fma_f32 v158, -v72, v14, v158
    v_fma_f32 v159, -v72, v15, v159
    v_mul_f32 v88, v80, v76
    v_mul_f32 v152, v88, v152
    v_mul_f32 v153, v88, v153
    v_mul_f32 v154, v88, v154
    v_mul_f32 v155, v88, v155
    v_mul_f32 v156, v76, v156
    v_mul_f32 v157, v76, v157
    v_mul_f32 v158, v76, v158
    v_mul_f32 v159, v76, v159
    v_cvt_pk_bf16_f32 v96, v152, v153
    v_cvt_pk_bf16_f32 v97, v154, v155
    v_cvt_pk_bf16_f32 v98, v156, v157
    v_cvt_pk_bf16_f32 v99, v158, v159
    buffer_store_dword v96, v81, s[12:15], 0 offen offset:0 sc1
    buffer_store_dword v97, v82, s[12:15], 0 offen offset:0 sc1
    s_mov_b32 exec_hi, 0
    ds_write_b16 v87, v98 offset:1024
    ds_write_b16_d16_hi v87, v98 offset:1280
    ds_write_b16 v87, v99 offset:1536
    ds_write_b16_d16_hi v87, v99 offset:1792
    s_mov_b32 exec_hi, -1
    v_fma_f32 v168, -v73, v8, v168
    v_fma_f32 v169, -v73, v9, v169
    v_fma_f32 v170, -v73, v10, v170
    v_fma_f32 v171, -v73, v11, v171
    v_fma_f32 v172, -v73, v12, v172
    v_fma_f32 v173, -v73, v13, v173
    v_fma_f32 v174, -v73, v14, v174
    v_fma_f32 v175, -v73, v15, v175
    v_mul_f32 v88, v80, v77
    v_mul_f32 v168, v88, v168
    v_mul_f32 v169, v88, v169
    v_mul_f32 v170, v88, v170
    v_mul_f32 v171, v88, v171
    v_mul_f32 v172, v77, v172
    v_mul_f32 v173, v77, v173
    v_mul_f32 v174, v77, v174
    v_mul_f32 v175, v77, v175
    v_cvt_pk_bf16_f32 v100, v168, v169
    v_cvt_pk_bf16_f32 v101, v170, v171
    v_cvt_pk_bf16_f32 v102, v172, v173
    v_cvt_pk_bf16_f32 v103, v174, v175
    buffer_store_dword v100, v81, s[12:15], 0 offen offset:128 sc1
    buffer_store_dword v101, v82, s[12:15], 0 offen offset:128 sc1
    s_mov_b32 exec_hi, 0
    ds_write_b16 v87, v102 offset:1088
    ds_write_b16_d16_hi v87, v102 offset:1344
    ds_write_b16 v87, v103 offset:1600
    ds_write_b16_d16_hi v87, v103 offset:1856
    s_mov_b32 exec_hi, -1
    v_fma_f32 v184, -v74, v8, v184
    v_fma_f32 v185, -v74, v9, v185
    v_fma_f32 v186, -v74, v10, v186
    v_fma_f32 v187, -v74, v11, v187
    v_fma_f32 v188, -v74, v12, v188
    v_fma_f32 v189, -v74, v13, v189
    v_fma_f32 v190, -v74, v14, v190
    v_fma_f32 v191, -v74, v15, v191
    v_mul_f32 v88, v80, v78
    v_mul_f32 v184, v88, v184
    v_mul_f32 v185, v88, v185
    v_mul_f32 v186, v88, v186
    v_mul_f32 v187, v88, v187
    v_mul_f32 v188, v78, v188
    v_mul_f32 v189, v78, v189
    v_mul_f32 v190, v78, v190
    v_mul_f32 v191, v78, v191
    v_cvt_pk_bf16_f32 v104, v184, v185
    v_cvt_pk_bf16_f32 v105, v186, v187
    v_cvt_pk_bf16_f32 v106, v188, v189
    v_cvt_pk_bf16_f32 v107, v190, v191
    buffer_store_dword v104, v81, s[12:15], 0 offen offset:256 sc1
    buffer_store_dword v105, v82, s[12:15], 0 offen offset:256 sc1
    s_mov_b32 exec_hi, 0
    ds_write_b16 v87, v106 offset:1152
    ds_write_b16_d16_hi v87, v106 offset:1408
    ds_write_b16 v87, v107 offset:1664
    ds_write_b16_d16_hi v87, v107 offset:1920
    s_mov_b32 exec_hi, -1
    v_fma_f32 v200, -v75, v8, v200
    v_fma_f32 v201, -v75, v9, v201
    v_fma_f32 v202, -v75, v10, v202
    v_fma_f32 v203, -v75, v11, v203
    v_fma_f32 v204, -v75, v12, v204
    v_fma_f32 v205, -v75, v13, v205
    v_fma_f32 v206, -v75, v14, v206
    v_fma_f32 v207, -v75, v15, v207
    v_mul_f32 v88, v80, v79
    v_mul_f32 v200, v88, v200
    v_mul_f32 v201, v88, v201
    v_mul_f32 v202, v88, v202
    v_mul_f32 v203, v88, v203
    v_mul_f32 v204, v79, v204
    v_mul_f32 v205, v79, v205
    v_mul_f32 v206, v79, v206
    v_mul_f32 v207, v79, v207
    v_cvt_pk_bf16_f32 v108, v200, v201
    v_cvt_pk_bf16_f32 v109, v202, v203
    v_cvt_pk_bf16_f32 v110, v204, v205
    v_cvt_pk_bf16_f32 v111, v206, v207
    buffer_store_dword v108, v81, s[12:15], 0 offen offset:384 sc1
    buffer_store_dword v109, v82, s[12:15], 0 offen offset:384 sc1
    s_mov_b32 exec_hi, 0
    ds_write_b16 v87, v110 offset:1216
    ds_write_b16_d16_hi v87, v110 offset:1472
    ds_write_b16 v87, v111 offset:1728
    ds_write_b16_d16_hi v87, v111 offset:1984
    s_mov_b32 exec_hi, -1
    s_waitcnt lgkmcnt(0)
    ds_read_b128 v[112:115], v248 offset:1024
    v_lshrrev_b32 v85, 5, v1
    v_mul_u32_u24 v85, 155648, v85
    v_bfe_u32 v86, v1, 2, 2
    v_mul_u32_u24 v86, 2304, v86
    v_add_u32 v85, v85, v86
    v_bfe_u32 v86, v1, 1, 1
    v_mul_u32_u24 v86, 640, v86
    v_add_u32 v85, v85, v86
    v_and_b32 v86, 1, v1
    v_mul_u32_u24 v86, 320, v86
    v_add_u32 v85, v85, v86
    v_bfe_u32 v86, v1, 4, 1
    v_lshl_add_u32 v85, v86, 4, v85
    s_add_u32 s41, s39, 2304
    v_cmp_eq_u32 vcc, 0, v86
    v_mov_b32 v87, 0x3f803f80
    s_waitcnt lgkmcnt(0)
    buffer_store_dwordx4 v[112:115], v85, s[12:15], s41 offen sc1
    v_cndmask_b32 v116, 0, v87, vcc
    v_cndmask_b32 v117, 0, v87, vcc
    v_cndmask_b32 v118, 0, v87, vcc
    v_cndmask_b32 v119, 0, v87, vcc
    buffer_store_dwordx4 v[116:119], v85, s[12:15], s41 offen offset:32 sc1
    s_branch A_FIN
A_E2:
    v_lshlrev_b32 v80, 4, v250
    v_lshrrev_b32 v81, 4, v249
    v_mul_u32_u24 v81, 155648, v81
    v_mul_u32_u24 v82, 320, v250
    v_and_b32 v83, 15, v249
    v_lshl_add_u32 v82, v83, 4, v82
    v_add_u32 v81, v81, v82
    ds_read_b128 v[8:11], v80 offset:0
    ds_read_b128 v[24:27], v80 offset:512
    ds_read_b128 v[12:15], v80 offset:32
    ds_read_b128 v[28:31], v80 offset:544
    ds_read_b128 v[16:19], v80 offset:64
    ds_read_b128 v[32:35], v80 offset:576
    ds_read_b128 v[20:23], v80 offset:96
    ds_read_b128 v[36:39], v80 offset:608
    ds_read_b128 v[40:43], v80 offset:128
    ds_read_b128 v[56:59], v80 offset:640
    ds_read_b128 v[44:47], v80 offset:160
    ds_read_b128 v[60:63], v80 offset:672
    ds_read_b128 v[48:51], v80 offset:192
    ds_read_b128 v[64:67], v80 offset:704
    ds_read_b128 v[52:55], v80 offset:224
    ds_read_b128 v[68:71], v80 offset:736
    s_waitcnt lgkmcnt(8)
    v_fma_f32 v152, -v8, v84, v152
    v_fma_f32 v153, -v9, v84, v153
    v_fma_f32 v154, -v10, v84, v154
    v_fma_f32 v155, -v11, v84, v155
    v_fma_f32 v156, -v12, v84, v156
    v_fma_f32 v157, -v13, v84, v157
    v_fma_f32 v158, -v14, v84, v158
    v_fma_f32 v159, -v15, v84, v159
    v_fma_f32 v160, -v16, v84, v160
    v_fma_f32 v161, -v17, v84, v161
    v_fma_f32 v162, -v18, v84, v162
    v_fma_f32 v163, -v19, v84, v163
    v_fma_f32 v164, -v20, v84, v164
    v_fma_f32 v165, -v21, v84, v165
    v_fma_f32 v166, -v22, v84, v166
    v_fma_f32 v167, -v23, v84, v167
    v_mul_f32 v152, v24, v152
    v_mul_f32 v153, v25, v153
    v_mul_f32 v154, v26, v154
    v_mul_f32 v155, v27, v155
    v_mul_f32 v156, v28, v156
    v_mul_f32 v157, v29, v157
    v_mul_f32 v158, v30, v158
    v_mul_f32 v159, v31, v159
    v_mul_f32 v160, v32, v160
    v_mul_f32 v161, v33, v161
    v_mul_f32 v162, v34, v162
    v_mul_f32 v163, v35, v163
    v_mul_f32 v164, v36, v164
    v_mul_f32 v165, v37, v165
    v_mul_f32 v166, v38, v166
    v_mul_f32 v167, v39, v167
    v_cvt_pk_bf16_f32 v96, v152, v153
    v_cvt_pk_bf16_f32 v97, v154, v155
    v_cvt_pk_bf16_f32 v98, v156, v157
    v_cvt_pk_bf16_f32 v99, v158, v159
    s_add_u32 s46, s39, 2048
    buffer_store_dwordx4 v[96:99], v81, s[12:15], s46 offen sc1
    v_cvt_pk_bf16_f32 v100, v160, v161
    v_cvt_pk_bf16_f32 v101, v162, v163
    v_cvt_pk_bf16_f32 v102, v164, v165
    v_cvt_pk_bf16_f32 v103, v166, v167
    s_add_u32 s46, s39, 2688
    buffer_store_dwordx4 v[100:103], v81, s[12:15], s46 offen sc1
    ds_read_b128 v[8:11], v80 offset:256
    ds_read_b128 v[24:27], v80 offset:768
    ds_read_b128 v[12:15], v80 offset:288
    ds_read_b128 v[28:31], v80 offset:800
    ds_read_b128 v[16:19], v80 offset:320
    ds_read_b128 v[32:35], v80 offset:832
    ds_read_b128 v[20:23], v80 offset:352
    ds_read_b128 v[36:39], v80 offset:864
    s_waitcnt lgkmcnt(8)
    v_fma_f32 v168, -v40, v84, v168
    v_fma_f32 v169, -v41, v84, v169
    v_fma_f32 v170, -v42, v84, v170
    v_fma_f32 v171, -v43, v84, v171
    v_fma_f32 v172, -v44, v84, v172
    v_fma_f32 v173, -v45, v84, v173
    v_fma_f32 v174, -v46, v84, v174
    v_fma_f32 v175, -v47, v84, v175
    v_fma_f32 v176, -v48, v84, v176
    v_fma_f32 v177, -v49, v84, v177
    v_fma_f32 v178, -v50, v84, v178
    v_fma_f32 v179, -v51, v84, v179
    v_fma_f32 v180, -v52, v84, v180
    v_fma_f32 v181, -v53, v84, v181
    v_fma_f32 v182, -v54, v84, v182
    v_fma_f32 v183, -v55, v84, v183
    v_mul_f32 v168, v56, v168
    v_mul_f32 v169, v57, v169
    v_mul_f32 v170, v58, v170
    v_mul_f32 v171, v59, v171
    v_mul_f32 v172, v60, v172
    v_mul_f32 v173, v61, v173
    v_mul_f32 v174, v62, v174
    v_mul_f32 v175, v63, v175
    v_mul_f32 v176, v64, v176
    v_mul_f32 v177, v65, v177
    v_mul_f32 v178, v66, v178
    v_mul_f32 v179, v67, v179
    v_mul_f32 v180, v68, v180
    v_mul_f32 v181, v69, v181
    v_mul_f32 v182, v70, v182
    v_mul_f32 v183, v71, v183
    v_cvt_pk_bf16_f32 v104, v168, v169
    v_cvt_pk_bf16_f32 v105, v170, v171
    v_cvt_pk_bf16_f32 v106, v172, v173
    v_cvt_pk_bf16_f32 v107, v174, v175
    s_add_u32 s46, s39, 4352
    buffer_store_dwordx4 v[104:107], v81, s[12:15], s46 offen sc1
    v_cvt_pk_bf16_f32 v108, v176, v177
    v_cvt_pk_bf16_f32 v109, v178, v179
    v_cvt_pk_bf16_f32 v110, v180, v181
    v_cvt_pk_bf16_f32 v111, v182, v183
    s_add_u32 s46, s39, 4992
    buffer_store_dwordx4 v[108:111], v81, s[12:15], s46 offen sc1
    ds_read_b128 v[40:43], v80 offset:384
    ds_read_b128 v[56:59], v80 offset:896
    ds_read_b128 v[44:47], v80 offset:416
    ds_read_b128 v[60:63], v80 offset:928
    ds_read_b128 v[48:51], v80 offset:448
    ds_read_b128 v[64:67], v80 offset:960
    ds_read_b128 v[52:55], v80 offset:480
    ds_read_b128 v[68:71], v80 offset:992
    s_waitcnt lgkmcnt(8)
    v_fma_f32 v184, -v8, v84, v184
    v_fma_f32 v185, -v9, v84, v185
    v_fma_f32 v186, -v10, v84, v186
    v_fma_f32 v187, -v11, v84, v187
    v_fma_f32 v188, -v12, v84, v188
    v_fma_f32 v189, -v13, v84, v189
    v_fma_f32 v190, -v14, v84, v190
    v_fma_f32 v191, -v15, v84, v191
    v_fma_f32 v192, -v16, v84, v192
    v_fma_f32 v193, -v17, v84, v193
    v_fma_f32 v194, -v18, v84, v194
    v_fma_f32 v195, -v19, v84, v195
    v_fma_f32 v196, -v20, v84, v196
    v_fma_f32 v197, -v21, v84, v197
    v_fma_f32 v198, -v22, v84, v198
    v_fma_f32 v199, -v23, v84, v199
    v_mul_f32 v184, v24, v184
    v_mul_f32 v185, v25, v185
    v_mul_f32 v186, v26, v186
    v_mul_f32 v187, v27, v187
    v_mul_f32 v188, v28, v188
    v_mul_f32 v189, v29, v189
    v_mul_f32 v190, v30, v190
    v_mul_f32 v191, v31, v191
    v_mul_f32 v192, v32, v192
    v_mul_f32 v193, v33, v193
    v_mul_f32 v194, v34, v194
    v_mul_f32 v195, v35, v195
    v_mul_f32 v196, v36, v196
    v_mul_f32 v197, v37, v197
    v_mul_f32 v198, v38, v198
    v_mul_f32 v199, v39, v199
    v_cvt_pk_bf16_f32 v112, v184, v185
    v_cvt_pk_bf16_f32 v113, v186, v187
    v_cvt_pk_bf16_f32 v114, v188, v189
    v_cvt_pk_bf16_f32 v115, v190, v191
    s_add_u32 s46, s39, 6656
    buffer_store_dwordx4 v[112:115], v81, s[12:15], s46 offen sc1
    v_cvt_pk_bf16_f32 v116, v192, v193
    v_cvt_pk_bf16_f32 v117, v194, v195
    v_cvt_pk_bf16_f32 v118, v196, v197
    v_cvt_pk_bf16_f32 v119, v198, v199
    s_add_u32 s46, s39, 7296
    buffer_store_dwordx4 v[116:119], v81, s[12:15], s46 offen sc1
    s_waitcnt lgkmcnt(0)
    v_fma_f32 v200, -v40, v84, v200
    v_fma_f32 v201, -v41, v84, v201
    v_fma_f32 v202, -v42, v84, v202
    v_fma_f32 v203, -v43, v84, v203
    v_fma_f32 v204, -v44, v84, v204
    v_fma_f32 v205, -v45, v84, v205
    v_fma_f32 v206, -v46, v84, v206
    v_fma_f32 v207, -v47, v84, v207
    v_fma_f32 v208, -v48, v84, v208
    v_fma_f32 v209, -v49, v84, v209
    v_fma_f32 v210, -v50, v84, v210
    v_fma_f32 v211, -v51, v84, v211
    v_fma_f32 v212, -v52, v84, v212
    v_fma_f32 v213, -v53, v84, v213
    v_fma_f32 v214, -v54, v84, v214
    v_fma_f32 v215, -v55, v84, v215
    v_mul_f32 v200, v56, v200
    v_mul_f32 v201, v57, v201
    v_mul_f32 v202, v58, v202
    v_mul_f32 v203, v59, v203
    v_mul_f32 v204, v60, v204
    v_mul_f32 v205, v61, v205
    v_mul_f32 v206, v62, v206
    v_mul_f32 v207, v63, v207
    v_mul_f32 v208, v64, v208
    v_mul_f32 v209, v65, v209
    v_mul_f32 v210, v66, v210
    v_mul_f32 v211, v67, v211
    v_mul_f32 v212, v68, v212
    v_mul_f32 v213, v69, v213
    v_mul_f32 v214, v70, v214
    v_mul_f32 v215, v71, v215
    v_cvt_pk_bf16_f32 v120, v200, v201
    v_cvt_pk_bf16_f32 v121, v202, v203
    v_cvt_pk_bf16_f32 v122, v204, v205
    v_cvt_pk_bf16_f32 v123, v206, v207
    s_add_u32 s46, s39, 8960
    buffer_store_dwordx4 v[120:123], v81, s[12:15], s46 offen sc1
    v_cvt_pk_bf16_f32 v124, v208, v209
    v_cvt_pk_bf16_f32 v125, v210, v211
    v_cvt_pk_bf16_f32 v126, v212, v213
    v_cvt_pk_bf16_f32 v127, v214, v215
    s_add_u32 s46, s39, 9600
    buffer_store_dwordx4 v[124:127], v81, s[12:15], s46 offen sc1
A_FIN:
    s_lshl_b32 s30, s24, 6
    s_lshl_b32 s31, s23, 2
    s_add_u32 s30, s30, s31
    s_add_u32 s30, s30, s25
    s_lshl_b32 s30, s30, 7
    s_add_u32 s53, s30, 30392320
    s_branch A_CONV
A_HELP:
    s_mov_b32 s8, s4
    s_mov_b32 s9, s5
    s_mov_b32 s10, 0x240000
    s_mov_b32 s11, 0x20000
    v_lshrrev_b32 v251, 3, v1
    s_lshl_b32 s30, s25, 5
    v_add_u32 v251, s30, v251
    v_mul_u32_u24 v251, 1152, v251
    v_lshrrev_b32 v252, 4, v1
    v_and_b32 v253, 7, v1
    v_xor_b32 v253, v253, v252
    v_lshl_add_u32 v8, v253, 4, v251
    v_xor_b32 v253, 4, v253
    v_lshl_add_u32 v9, v253, 4, v251
    s_cmp_eq_u32 s25, 1
    s_cselect_b32 s53, 1, 0
    s_cmp_lt_u32 s2, 128
    s_cselect_b32 s53, s53, 0
    s_cmp_lg_u32 s25, 0
    s_cbranch_scc1 A_NST0
    s_mov_b32 s36, s4
    s_mov_b32 s37, s5
    s_mov_b32 s38, 0x240000
    s_mov_b32 s39, 0x20000
    s_lshl_b32 s20, s2, 3
    v_lshrrev_b32 v141, 3, v1
    v_add_u32 v141, s20, v141
    v_and_b32 v142, 7, v1
    v_mul_u32_u24 v143, 1152, v141
    v_lshl_add_u32 v143, v142, 4, v143
    buffer_load_dwordx4 v[100:103], v143, s[36:39], 0 offen offset:0
    buffer_load_dwordx4 v[104:107], v143, s[36:39], 0 offen offset:128
    buffer_load_dwordx4 v[108:111], v143, s[36:39], 0 offen offset:256
    buffer_load_dwordx4 v[112:115], v143, s[36:39], 0 offen offset:384
    buffer_load_dwordx4 v[116:119], v143, s[36:39], 0 offen offset:512
    buffer_load_dwordx4 v[120:123], v143, s[36:39], 0 offen offset:640
    buffer_load_dwordx4 v[124:127], v143, s[36:39], 0 offen offset:768
    buffer_load_dwordx4 v[128:131], v143, s[36:39], 0 offen offset:896
    buffer_load_dwordx4 v[132:135], v143, s[36:39], 0 offen offset:1024
    s_waitcnt vmcnt(0)
    v_mov_b32 v136, 0
    v_mov_b32 v138, 0
    s_mov_b32 s56, 0x3f803f80
    v_dot2_f32_bf16 v136, v100, s56, v136
    v_dot2_f32_bf16 v138, v100, v100, v138
    v_dot2_f32_bf16 v136, v101, s56, v136
    v_dot2_f32_bf16 v138, v101, v101, v138
    v_dot2_f32_bf16 v136, v102, s56, v136
    v_dot2_f32_bf16 v138, v102, v102, v138
    v_dot2_f32_bf16 v136, v103, s56, v136
    v_dot2_f32_bf16 v138, v103, v103, v138
    v_dot2_f32_bf16 v136, v104, s56, v136
    v_dot2_f32_bf16 v138, v104, v104, v138
    v_dot2_f32_bf16 v136, v105, s56, v136
    v_dot2_f32_bf16 v138, v105, v105, v138
    v_dot2_f32_bf16 v136, v106, s56, v136
    v_dot2_f32_bf16 v138, v106, v106, v138
    v_dot2_f32_bf16 v136, v107, s56, v136
    v_dot2_f32_bf16 v138, v107, v107, v138
    v_dot2_f32_bf16 v136, v108, s56, v136
    v_dot2_f32_bf16 v138, v108, v108, v138
    v_dot2_f32_bf16 v136, v109, s56, v136
    v_dot2_f32_bf16 v138, v109, v109, v138
    v_dot2_f32_bf16 v136, v110, s56, v136
    v_dot2_f32_bf16 v138, v110, v110, v138
    v_dot2_f32_bf16 v136, v111, s56, v136
    v_dot2_f32_bf16 v138, v111, v111, v138
    v_dot2_f32_bf16 v136, v112, s56, v136
    v_dot2_f32_bf16 v138, v112, v112, v138
    v_dot2_f32_bf16 v136, v113, s56, v136
    v_dot2_f32_bf16 v138, v113, v113, v138
    v_dot2_f32_bf16 v136, v114, s56, v136
    v_dot2_f32_bf16 v138, v114, v114, v138
    v_dot2_f32_bf16 v136, v115, s56, v136
    v_dot2_f32_bf16 v138, v115, v115, v138
    v_dot2_f32_bf16 v136, v116, s56, v136
    v_dot2_f32_bf16 v138, v116, v116, v138
    v_dot2_f32_bf16 v136, v117, s56, v136
    v_dot2_f32_bf16 v138, v117, v117, v138
    v_dot2_f32_bf16 v136, v118, s56, v136
    v_dot2_f32_bf16 v138, v118, v118, v138
    v_dot2_f32_bf16 v136, v119, s56, v136
    v_dot2_f32_bf16 v138, v119, v119, v138
    v_dot2_f32_bf16 v136, v120, s56, v136
    v_dot2_f32_bf16 v138, v120, v120, v138
    v_dot2_f32_bf16 v136, v121, s56, v136
    v_dot2_f32_bf16 v138, v121, v121, v138
    v_dot2_f32_bf16 v136, v122, s56, v136
    v_dot2_f32_bf16 v138, v122, v122, v138
    v_dot2_f32_bf16 v136, v123, s56, v136
    v_dot2_f32_bf16 v138, v123, v123, v138
    v_dot2_f32_bf16 v136, v124, s56, v136
    v_dot2_f32_bf16 v138, v124, v124, v138
    v_dot2_f32_bf16 v136, v125, s56, v136
    v_dot2_f32_bf16 v138, v125, v125, v138
    v_dot2_f32_bf16 v136, v126, s56, v136
    v_dot2_f32_bf16 v138, v126, v126, v138
    v_dot2_f32_bf16 v136, v127, s56, v136
    v_dot2_f32_bf16 v138, v127, v127, v138
    v_dot2_f32_bf16 v136, v128, s56, v136
    v_dot2_f32_bf16 v138, v128, v128, v138
    v_dot2_f32_bf16 v136, v129, s56, v136
    v_dot2_f32_bf16 v138, v129, v129, v138
    v_dot2_f32_bf16 v136, v130, s56, v136
    v_dot2_f32_bf16 v138, v130, v130, v138
    v_dot2_f32_bf16 v136, v131, s56, v136
    v_dot2_f32_bf16 v138, v131, v131, v138
    v_dot2_f32_bf16 v136, v132, s56, v136
    v_dot2_f32_bf16 v138, v132, v132, v138
    v_dot2_f32_bf16 v136, v133, s56, v136
    v_dot2_f32_bf16 v138, v133, v133, v138
    v_dot2_f32_bf16 v136, v134, s56, v136
    v_dot2_f32_bf16 v138, v134, v134, v138
    v_dot2_f32_bf16 v136, v135, s56, v136
    v_dot2_f32_bf16 v138, v135, v135, v138
    s_nop 2
    v_add_f32_dpp v136, v136, v136 quad_perm:[1,0,3,2] row_mask:0xf bank_mask:0xf
    s_nop 1
    v_add_f32_dpp v136, v136, v136 quad_perm:[2,3,0,1] row_mask:0xf bank_mask:0xf
    s_nop 1
    v_add_f32_dpp v136, v136, v136 row_half_mirror row_mask:0xf bank_mask:0xf
    s_nop 2
    v_add_f32_dpp v138, v138, v138 quad_perm:[1,0,3,2] row_mask:0xf bank_mask:0xf
    s_nop 1
    v_add_f32_dpp v138, v138, v138 quad_perm:[2,3,0,1] row_mask:0xf bank_mask:0xf
    s_nop 1
    v_add_f32_dpp v138, v138, v138 row_half_mirror row_mask:0xf bank_mask:0xf
    v_mov_b32 v137, s60
    v_mov_b32 v139, s60
    v_lshlrev_b32 v140, 4, v141
    v_cmp_eq_u32 vcc, 0, v142
    s_mov_b32 s20, 3162112
    s_and_saveexec_b64 s[30:31], vcc
    buffer_store_dwordx4 v[136:139], v140, s[12:15], s20 offen sc1
    s_mov_b64 exec, -1
A_NST0:
    s_cmp_eq_u32 s53, 0
    s_cbranch_scc1 A_NX0
    s_load_dwordx2 s[40:41], s[0:1], 32
    s_load_dwordx2 s[44:45], s[0:1], 40
    s_load_dwordx2 s[48:49], s[0:1], 48
    s_waitcnt lgkmcnt(0)
    s_mov_b32 s42, 2359296
    s_mov_b32 s43, 0x20000
    s_mov_b32 s46, 2359296
    s_mov_b32 s47, 0x20000
    s_mov_b32 s50, 4608
    s_mov_b32 s51, 0x20000
    s_add_u32 s34, s2, 1024
    s_mul_hi_u32 s54, s34, 119304648
    s_mul_i32 s55, s54, 36
    s_sub_u32 s55, s34, s55
    v_and_b32 v102, 7, v1
    v_lshrrev_b32 v103, 3, v1
    s_lshl_b32 s30, s54, 6
    v_lshl_add_u32 v104, v102, 3, s30
    s_lshl_b32 s30, s55, 3
    v_add_u32 v105, s30, v103
    v_mul_u32_u24 v106, 1152, v104
    v_lshl_add_u32 v106, v105, 2, v106
    v_cmp_eq_u32 vcc, 0, v104
    v_mov_b32 v110, 0x40000000
    v_subrev_u32 v107, 3456, v106
    v_cndmask_b32 v107, v107, v110, vcc
    v_subrev_u32 v108, 2304, v106
    v_cndmask_b32 v108, v108, v110, vcc
    v_subrev_u32 v109, 1152, v106
    v_cndmask_b32 v109, v109, v110, vcc
    v_lshlrev_b32 v110, 4, v105
    buffer_load_dwordx4 v[112:115], v110, s[48:51], 0 offen
    buffer_load_dword v116, v107, s[40:43], 0 offen
    buffer_load_dword v117, v108, s[40:43], 0 offen
    buffer_load_dword v118, v109, s[40:43], 0 offen
    s_mov_b32 s30, 0
    buffer_load_dword v119, v106, s[40:43], s30 offen
    s_mov_b32 s30, 1152
    buffer_load_dword v120, v106, s[40:43], s30 offen
    s_mov_b32 s30, 2304
    buffer_load_dword v121, v106, s[40:43], s30 offen
    s_mov_b32 s30, 3456
    buffer_load_dword v122, v106, s[40:43], s30 offen
    s_mov_b32 s30, 4608
    buffer_load_dword v123, v106, s[40:43], s30 offen
    s_mov_b32 s30, 5760
    buffer_load_dword v124, v106, s[40:43], s30 offen
    s_mov_b32 s30, 6912
    buffer_load_dword v125, v106, s[40:43], s30 offen
    s_mov_b32 s30, 8064
    buffer_load_dword v126, v106, s[40:43], s30 offen
    s_mov_b32 s30, 0
    buffer_load_dword v128, v106, s[44:47], s30 offen
    s_mov_b32 s30, 1152
    buffer_load_dword v129, v106, s[44:47], s30 offen
    s_mov_b32 s30, 2304
    buffer_load_dword v130, v106, s[44:47], s30 offen
    s_mov_b32 s30, 3456
    buffer_load_dword v131, v106, s[44:47], s30 offen
    s_mov_b32 s30, 4608
    buffer_load_dword v132, v106, s[44:47], s30 offen
    s_mov_b32 s30, 5760
    buffer_load_dword v133, v106, s[44:47], s30 offen
    s_mov_b32 s30, 6912
    buffer_load_dword v134, v106, s[44:47], s30 offen
    s_mov_b32 s30, 8064
    buffer_load_dword v135, v106, s[44:47], s30 offen
A_NX0:
    s_barrier
    s_add_u32 s32, s27, 0
    s_sub_u32 s33, s32, 9
    s_cmp_ge_u32 s32, 9
    s_cselect_b32 s32, s33, s32
    s_lshl_b32 s32, s32, 7
    s_add_u32 s32, s32, s26
    s_add_u32 m0, s29, 2560
    s_add_u32 s31, s32, 0
    buffer_load_dwordx4 v8, s[8:11], s31 offen lds
    s_add_u32 m0, s29, 3584
    s_add_u32 s31, s32, 9216
    buffer_load_dwordx4 v9, s[8:11], s31 offen lds
    s_add_u32 m0, s29, 4608
    s_add_u32 s31, s32, 18432
    buffer_load_dwordx4 v8, s[8:11], s31 offen lds
    s_add_u32 m0, s29, 5632
    s_add_u32 s31, s32, 27648
    buffer_load_dwordx4 v9, s[8:11], s31 offen lds
    s_add_u32 s32, s27, 1
    s_sub_u32 s33, s32, 9
    s_cmp_ge_u32 s32, 9
    s_cselect_b32 s32, s33, s32
    s_lshl_b32 s32, s32, 7
    s_add_u32 s32, s32, s26
    s_add_u32 m0, s29, 18944
    s_add_u32 s31, s32, 0
    buffer_load_dwordx4 v8, s[8:11], s31 offen lds
    s_add_u32 m0, s29, 19968
    s_add_u32 s31, s32, 9216
    buffer_load_dwordx4 v9, s[8:11], s31 offen lds
    s_add_u32 m0, s29, 20992
    s_add_u32 s31, s32, 18432
    buffer_load_dwordx4 v8, s[8:11], s31 offen lds
    s_add_u32 m0, s29, 22016
    s_add_u32 s31, s32, 27648
    buffer_load_dwordx4 v9, s[8:11], s31 offen lds
    s_add_u32 s32, s27, 2
    s_sub_u32 s33, s32, 9
    s_cmp_ge_u32 s32, 9
    s_cselect_b32 s32, s33, s32
    s_lshl_b32 s32, s32, 7
    s_add_u32 s32, s32, s26
    s_add_u32 m0, s29, 35328
    s_add_u32 s31, s32, 0
    buffer_load_dwordx4 v8, s[8:11], s31 offen lds
    s_add_u32 m0, s29, 36352
    s_add_u32 s31, s32, 9216
    buffer_load_dwordx4 v9, s[8:11], s31 offen lds
    s_add_u32 m0, s29, 37376
    s_add_u32 s31, s32, 18432
    buffer_load_dwordx4 v8, s[8:11], s31 offen lds
    s_add_u32 m0, s29, 38400
    s_add_u32 s31, s32, 27648
    buffer_load_dwordx4 v9, s[8:11], s31 offen lds
    s_add_u32 s32, s27, 3
    s_sub_u32 s33, s32, 9
    s_cmp_ge_u32 s32, 9
    s_cselect_b32 s32, s33, s32
    s_lshl_b32 s32, s32, 7
    s_add_u32 s32, s32, s26
    s_add_u32 m0, s29, 51712
    s_add_u32 s31, s32, 0
    buffer_load_dwordx4 v8, s[8:11], s31 offen lds
    s_add_u32 m0, s29, 52736
    s_add_u32 s31, s32, 9216
    buffer_load_dwordx4 v9, s[8:11], s31 offen lds
    s_add_u32 m0, s29, 53760
    s_add_u32 s31, s32, 18432
    buffer_load_dwordx4 v8, s[8:11], s31 offen lds
    s_add_u32 m0, s29, 54784
    s_add_u32 s31, s32, 27648
    buffer_load_dwordx4 v9, s[8:11], s31 offen lds
    s_add_u32 s32, s27, 4
    s_sub_u32 s33, s32, 9
    s_cmp_ge_u32 s32, 9
    s_cselect_b32 s32, s33, s32
    s_lshl_b32 s32, s32, 7
    s_add_u32 s32, s32, s26
    s_add_u32 m0, s29, 68096
    s_add_u32 s31, s32, 0
    buffer_load_dwordx4 v8, s[8:11], s31 offen lds
    s_add_u32 m0, s29, 69120
    s_add_u32 s31, s32, 9216
    buffer_load_dwordx4 v9, s[8:11], s31 offen lds
    s_add_u32 m0, s29, 70144
    s_add_u32 s31, s32, 18432
    buffer_load_dwordx4 v8, s[8:11], s31 offen lds
    s_add_u32 m0, s29, 71168
    s_add_u32 s31, s32, 27648
    buffer_load_dwordx4 v9, s[8:11], s31 offen lds
    s_add_u32 s32, s27, 5
    s_sub_u32 s33, s32, 9
    s_cmp_ge_u32 s32, 9
    s_cselect_b32 s32, s33, s32
    s_lshl_b32 s32, s32, 7
    s_add_u32 s32, s32, s26
    s_add_u32 m0, s29, 84480
    s_add_u32 s31, s32, 0
    buffer_load_dwordx4 v8, s[8:11], s31 offen lds
    s_add_u32 m0, s29, 85504
    s_add_u32 s31, s32, 9216
    buffer_load_dwordx4 v9, s[8:11], s31 offen lds
    s_add_u32 m0, s29, 86528
    s_add_u32 s31, s32, 18432
    buffer_load_dwordx4 v8, s[8:11], s31 offen lds
    s_add_u32 m0, s29, 87552
    s_add_u32 s31, s32, 27648
    buffer_load_dwordx4 v9, s[8:11], s31 offen lds
    s_add_u32 s32, s27, 6
    s_sub_u32 s33, s32, 9
    s_cmp_ge_u32 s32, 9
    s_cselect_b32 s32, s33, s32
    s_lshl_b32 s32, s32, 7
    s_add_u32 s32, s32, s26
    s_add_u32 m0, s29, 100864
    s_add_u32 s31, s32, 0
    buffer_load_dwordx4 v8, s[8:11], s31 offen lds
    s_add_u32 m0, s29, 101888
    s_add_u32 s31, s32, 9216
    buffer_load_dwordx4 v9, s[8:11], s31 offen lds
    s_add_u32 m0, s29, 102912
    s_add_u32 s31, s32, 18432
    buffer_load_dwordx4 v8, s[8:11], s31 offen lds
    s_add_u32 m0, s29, 103936
    s_add_u32 s31, s32, 27648
    buffer_load_dwordx4 v9, s[8:11], s31 offen lds
    s_add_u32 s32, s27, 7
    s_sub_u32 s33, s32, 9
    s_cmp_ge_u32 s32, 9
    s_cselect_b32 s32, s33, s32
    s_lshl_b32 s32, s32, 7
    s_add_u32 s32, s32, s26
    s_add_u32 m0, s29, 117248
    s_add_u32 s31, s32, 0
    buffer_load_dwordx4 v8, s[8:11], s31 offen lds
    s_add_u32 m0, s29, 118272
    s_add_u32 s31, s32, 9216
    buffer_load_dwordx4 v9, s[8:11], s31 offen lds
    s_add_u32 m0, s29, 119296
    s_add_u32 s31, s32, 18432
    buffer_load_dwordx4 v8, s[8:11], s31 offen lds
    s_add_u32 m0, s29, 120320
    s_add_u32 s31, s32, 27648
    buffer_load_dwordx4 v9, s[8:11], s31 offen lds
    s_add_u32 s32, s27, 8
    s_sub_u32 s33, s32, 9
    s_cmp_ge_u32 s32, 9
    s_cselect_b32 s32, s33, s32
    s_lshl_b32 s32, s32, 7
    s_add_u32 s32, s32, s26
    s_add_u32 m0, s29, 133632
    s_add_u32 s31, s32, 0
    buffer_load_dwordx4 v8, s[8:11], s31 offen lds
    s_add_u32 m0, s29, 134656
    s_add_u32 s31, s32, 9216
    buffer_load_dwordx4 v9, s[8:11], s31 offen lds
    s_add_u32 m0, s29, 135680
    s_add_u32 s31, s32, 18432
    buffer_load_dwordx4 v8, s[8:11], s31 offen lds
    s_add_u32 m0, s29, 136704
    s_add_u32 s31, s32, 27648
    buffer_load_dwordx4 v9, s[8:11], s31 offen lds
    s_cmp_eq_u32 s53, 0
    s_cbranch_scc1 A_NX1
    s_waitcnt vmcnt(36)
    v_lshlrev_b32 v140, 16, v112
    v_and_b32 v141, 0xffff0000, v112
    v_lshlrev_b32 v142, 16, v113
    v_and_b32 v143, 0xffff0000, v113
    v_lshlrev_b32 v144, 16, v114
    v_and_b32 v145, 0xffff0000, v114
    v_lshlrev_b32 v146, 16, v115
    v_and_b32 v147, 0xffff0000, v115
    v_lshlrev_b32 v148, 16, v116
    v_and_b32 v160, 0xffff0000, v116
    v_lshlrev_b32 v149, 16, v117
    v_and_b32 v161, 0xffff0000, v117
    v_lshlrev_b32 v150, 16, v118
    v_and_b32 v162, 0xffff0000, v118
    v_lshlrev_b32 v151, 16, v119
    v_and_b32 v163, 0xffff0000, v119
    v_lshlrev_b32 v152, 16, v120
    v_and_b32 v164, 0xffff0000, v120
    v_lshlrev_b32 v153, 16, v121
    v_and_b32 v165, 0xffff0000, v121
    v_lshlrev_b32 v154, 16, v122
    v_and_b32 v166, 0xffff0000, v122
    v_lshlrev_b32 v155, 16, v123
    v_and_b32 v167, 0xffff0000, v123
    v_lshlrev_b32 v156, 16, v124
    v_and_b32 v168, 0xffff0000, v124
    v_lshlrev_b32 v157, 16, v125
    v_and_b32 v169, 0xffff0000, v125
    v_lshlrev_b32 v158, 16, v126
    v_and_b32 v170, 0xffff0000, v126
    v_lshlrev_b32 v172, 16, v128
    v_and_b32 v180, 0xffff0000, v128
    v_lshlrev_b32 v173, 16, v129
    v_and_b32 v181, 0xffff0000, v129
    v_lshlrev_b32 v174, 16, v130
    v_and_b32 v182, 0xffff0000, v130
    v_lshlrev_b32 v175, 16, v131
    v_and_b32 v183, 0xffff0000, v131
    v_lshlrev_b32 v176, 16, v132
    v_and_b32 v184, 0xffff0000, v132
    v_lshlrev_b32 v177, 16, v133
    v_and_b32 v185, 0xffff0000, v133
    v_lshlrev_b32 v178, 16, v134
    v_and_b32 v186, 0xffff0000, v134
    v_lshlrev_b32 v179, 16, v135
    v_and_b32 v187, 0xffff0000, v135
    v_mul_f32 v188, v148, v143
    v_fmac_f32 v188, v149, v142
    v_fmac_f32 v188, v150, v141
    v_fmac_f32 v188, v151, v140
    v_mul_f32 v172, v188, v172
    v_mul_f32 v189, v149, v143
    v_fmac_f32 v189, v150, v142
    v_fmac_f32 v189, v151, v141
    v_fmac_f32 v189, v152, v140
    v_mul_f32 v173, v189, v173
    v_mul_f32 v188, v150, v143
    v_fmac_f32 v188, v151, v142
    v_fmac_f32 v188, v152, v141
    v_fmac_f32 v188, v153, v140
    v_mul_f32 v174, v188, v174
    v_mul_f32 v189, v151, v143
    v_fmac_f32 v189, v152, v142
    v_fmac_f32 v189, v153, v141
    v_fmac_f32 v189, v154, v140
    v_mul_f32 v175, v189, v175
    v_mul_f32 v188, v152, v143
    v_fmac_f32 v188, v153, v142
    v_fmac_f32 v188, v154, v141
    v_fmac_f32 v188, v155, v140
    v_mul_f32 v176, v188, v176
    v_mul_f32 v189, v153, v143
    v_fmac_f32 v189, v154, v142
    v_fmac_f32 v189, v155, v141
    v_fmac_f32 v189, v156, v140
    v_mul_f32 v177, v189, v177
    v_mul_f32 v188, v154, v143
    v_fmac_f32 v188, v155, v142
    v_fmac_f32 v188, v156, v141
    v_fmac_f32 v188, v157, v140
    v_mul_f32 v178, v188, v178
    v_mul_f32 v189, v155, v143
    v_fmac_f32 v189, v156, v142
    v_fmac_f32 v189, v157, v141
    v_fmac_f32 v189, v158, v140
    v_mul_f32 v179, v189, v179
    v_cvt_pk_bf16_f32 v192, v179, v178
    v_cvt_pk_bf16_f32 v193, v177, v176
    v_cvt_pk_bf16_f32 v194, v175, v174
    v_cvt_pk_bf16_f32 v195, v173, v172
    v_mul_f32 v188, v160, v147
    v_fmac_f32 v188, v161, v146
    v_fmac_f32 v188, v162, v145
    v_fmac_f32 v188, v163, v144
    v_mul_f32 v180, v188, v180
    v_mul_f32 v189, v161, v147
    v_fmac_f32 v189, v162, v146
    v_fmac_f32 v189, v163, v145
    v_fmac_f32 v189, v164, v144
    v_mul_f32 v181, v189, v181
    v_mul_f32 v188, v162, v147
    v_fmac_f32 v188, v163, v146
    v_fmac_f32 v188, v164, v145
    v_fmac_f32 v188, v165, v144
    v_mul_f32 v182, v188, v182
    v_mul_f32 v189, v163, v147
    v_fmac_f32 v189, v164, v146
    v_fmac_f32 v189, v165, v145
    v_fmac_f32 v189, v166, v144
    v_mul_f32 v183, v189, v183
    v_mul_f32 v188, v164, v147
    v_fmac_f32 v188, v165, v146
    v_fmac_f32 v188, v166, v145
    v_fmac_f32 v188, v167, v144
    v_mul_f32 v184, v188, v184
    v_mul_f32 v189, v165, v147
    v_fmac_f32 v189, v166, v146
    v_fmac_f32 v189, v167, v145
    v_fmac_f32 v189, v168, v144
    v_mul_f32 v185, v189, v185
    v_mul_f32 v188, v166, v147
    v_fmac_f32 v188, v167, v146
    v_fmac_f32 v188, v168, v145
    v_fmac_f32 v188, v169, v144
    v_mul_f32 v186, v188, v186
    v_mul_f32 v189, v167, v147
    v_fmac_f32 v189, v168, v146
    v_fmac_f32 v189, v169, v145
    v_fmac_f32 v189, v170, v144
    v_mul_f32 v187, v189, v187
    v_cvt_pk_bf16_f32 v196, v187, v186
    v_cvt_pk_bf16_f32 v197, v185, v184
    v_cvt_pk_bf16_f32 v198, v183, v182
    v_cvt_pk_bf16_f32 v199, v181, v180
    v_sub_u32 v106, 2040, v104
    v_lshlrev_b32 v106, 1, v106
    v_lshl_add_u32 v106, v105, 13, v106
    s_mov_b32 s30, 3358720
    buffer_store_dwordx4 v[192:195], v106, s[12:15], s30 offen sc1
    v_add_u32 v107, 4096, v106
    buffer_store_dwordx4 v[196:199], v107, s[12:15], s30 offen sc1
    s_lshl_b32 s52, s55, 5
    s_add_u32 s52, s52, s54
    s_lshl_b32 s52, s52, 7
    s_add_u32 s52, s52, 30244864
    s_waitcnt vmcnt(0)
    v_mov_b32 v10, s60
    v_mov_b32 v11, 0
    s_mov_b64 exec, 1
    buffer_store_dword v10, v11, s[12:15], s52 offen sc1
    s_mov_b64 exec, -1
A_NX1:
    s_waitcnt vmcnt(0)
    s_barrier
    s_and_b32 s20, s2, 7
    s_lshr_b32 s21, s2, 3
    s_lshr_b32 s23, s20, 1
    s_lshl_b32 s23, s23, 2
    s_lshr_b32 s24, s21, 3
    s_add_u32 s23, s23, s24
    s_and_b32 s24, s20, 1
    s_lshl_b32 s24, s24, 3
    s_and_b32 s25, s21, 7
    s_add_u32 s24, s24, s25
    s_and_b32 s25, s22, 3
    s_mul_i32 s26, s23, 147456
    s_lshl_b32 s28, s24, 2
    s_add_u32 s28, s28, s25
    s_mul_i32 s28, s28, 36864
    s_lshl_b32 s29, s25, 12
    s_and_b32 s27, s24, 7
    s_and_b32 s30, s23, 3
    s_lshl_b32 s30, s30, 1
    s_add_u32 s27, s27, s30
    s_sub_u32 s30, s27, 9
    s_cmp_ge_u32 s27, 9
    s_cselect_b32 s27, s30, s27
    v_and_b32 v1, 63, v0
    v_lshlrev_b32 v248, 4, v1
    v_and_b32 v249, 31, v1
    v_lshrrev_b32 v250, 5, v1
    s_lshl_b32 s30, s24, 2
    s_add_u32 s30, s30, s25
    s_lshl_b32 s30, s30, 11
    s_add_u32 s30, s30, 2367488
    v_lshlrev_b32 v28, 2, v249
    buffer_load_dword v32, v28, s[12:15], s30 offen offset:0 sc1
    buffer_load_dword v33, v28, s[12:15], s30 offen offset:128 sc1
    buffer_load_dword v34, v28, s[12:15], s30 offen offset:256 sc1
    buffer_load_dword v35, v28, s[12:15], s30 offen offset:384 sc1
    buffer_load_dword v36, v28, s[12:15], s30 offen offset:512 sc1
    buffer_load_dword v37, v28, s[12:15], s30 offen offset:640 sc1
    buffer_load_dword v38, v28, s[12:15], s30 offen offset:768 sc1
    buffer_load_dword v39, v28, s[12:15], s30 offen offset:896 sc1
    buffer_load_dword v40, v28, s[12:15], s30 offen offset:1024 sc1
    buffer_load_dword v41, v28, s[12:15], s30 offen offset:1152 sc1
    buffer_load_dword v42, v28, s[12:15], s30 offen offset:1280 sc1
    buffer_load_dword v43, v28, s[12:15], s30 offen offset:1408 sc1
    buffer_load_dword v44, v28, s[12:15], s30 offen offset:1536 sc1
    buffer_load_dword v45, v28, s[12:15], s30 offen offset:1664 sc1
    buffer_load_dword v46, v28, s[12:15], s30 offen offset:1792 sc1
    buffer_load_dword v47, v28, s[12:15], s30 offen offset:1920 sc1
    s_lshl_b32 s34, s23, 7
    s_lshl_b32 s35, s25, 5
    s_add_u32 s34, s34, s35
    s_lshl_b32 s34, s34, 4
    s_add_u32 s34, s34, 3162112
    v_lshlrev_b32 v29, 4, v249
    s_mov_b32 s58, 0
A_ST:
    buffer_load_dwordx4 v[16:19], v29, s[12:15], s34 offen sc1
    s_waitcnt vmcnt(0)
    v_cmp_eq_u32 vcc, s60, v17
    v_cmp_eq_u32 s[56:57], s60, v19
    s_nop 1
    s_and_b64 vcc, vcc, s[56:57]
    s_nop 1
    s_cmp_eq_u64 vcc, -1
    s_cbranch_scc1 A_ST_OK
    s_sleep 2
    s_add_u32 s58, s58, 1
    s_cmp_lt_u32 s58, 131072
    s_cbranch_scc1 A_ST
A_ST_OK:
    v_add_f32 v32, v32, v33
    v_add_f32 v32, v32, v34
    v_add_f32 v32, v32, v35
    v_add_f32 v32, v32, v36
    v_add_f32 v32, v32, v37
    v_add_f32 v32, v32, v38
    v_add_f32 v32, v32, v39
    v_add_f32 v32, v32, v40
    v_add_f32 v32, v32, v41
    v_add_f32 v32, v32, v42
    v_add_f32 v32, v32, v43
    v_add_f32 v32, v32, v44
    v_add_f32 v32, v32, v45
    v_add_f32 v32, v32, v46
    v_add_f32 v32, v32, v47
    v_mov_b32 v240, v32
    v_mul_f32 v16, 0x3ae38e39, v16
    v_mul_f32 v18, 0x3ae38e39, v18
    v_fma_f32 v18, -v16, v16, v18
    v_max_f32 v18, 0, v18
    v_add_f32 v18, 0x3727c5ac, v18
    v_rsq_f32 v18, v18
    s_lshl_b32 s30, s25, 7
    v_lshl_add_u32 v251, v249, 2, s30
    ds_write_b32 v251, v16 offset:0
    ds_write_b32 v251, v18 offset:512
    ds_write_b32 v251, v240 offset:2048
    s_waitcnt lgkmcnt(0)
    s_load_dwordx2 s[16:17], s[0:1], 56
    s_lshr_b32 s30, s2, 3
    s_lshr_b32 s31, s2, 6
    s_add_u32 s31, s31, 32
    v_and_b32 v2, 31, v1
    v_lshlrev_b32 v2, 7, v2
    v_mov_b32 v3, s30
    v_mov_b32 v4, s31
    v_cmp_gt_u32 vcc, 32, v1
    s_waitcnt lgkmcnt(0)
    s_mov_b32 s34, 30244864
    v_cndmask_b32 v3, v4, v3, vcc
    v_lshl_add_u32 v2, v3, 12, v2
    s_mov_b32 s18, 2359296
    s_mov_b32 s19, 0x20000
    v_lshlrev_b32 v3, 4, v1
    s_lshr_b32 s42, s25, 1
    s_lshl_b32 s43, s2, 1
    s_add_u32 s43, s43, s42
    s_lshl_b32 s43, s43, 12
    s_mul_i32 s42, s42, 21248
    s_add_u32 s42, s42, 2560
    s_and_b32 s47, s25, 1
    s_lshl_b32 s47, s47, 11
    s_add_u32 s48, s47, 0
    s_add_u32 s44, s42, s48
    s_add_u32 s40, s43, s48
    s_add_u32 s49, s47, 1024
    s_add_u32 s45, s42, s49
    s_add_u32 s41, s43, s49
    s_lshl_b32 s50, s25, 10
    s_add_u32 s46, s50, 45056
    s_lshr_b32 s43, s2, 2
    s_add_u32 s43, s43, 512
    s_lshl_b32 s43, s43, 12
    s_add_u32 s42, s43, s50
    s_mov_b32 s58, 0
A_CFT:
    buffer_load_dword v5, v2, s[12:15], s34 offen sc1
    s_waitcnt vmcnt(0)
    v_cmp_eq_u32 vcc, s60, v5
    s_nop 1
    s_cmp_eq_u64 vcc, -1
    s_cbranch_scc1 A_CFT_OK
    s_sleep 2
    s_add_u32 s58, s58, 1
    s_cmp_lt_u32 s58, 131072
    s_cbranch_scc1 A_CFT
A_CFT_OK:
    buffer_load_dwordx4 v[16:19], v3, s[16:19], s40 offen
    buffer_load_dwordx2 v[20:21], v3, s[16:19], s40 offen offset:16
    s_add_u32 s38, s40, 3358720
    buffer_load_dwordx4 v[64:67], v3, s[12:15], s38 offen sc1
    buffer_load_dwordx4 v[24:27], v3, s[16:19], s41 offen
    buffer_load_dwordx2 v[28:29], v3, s[16:19], s41 offen offset:16
    s_add_u32 s38, s41, 3358720
    buffer_load_dwordx4 v[68:71], v3, s[12:15], s38 offen sc1
    buffer_load_dwordx4 v[32:35], v3, s[16:19], s42 offen
    buffer_load_dwordx2 v[36:37], v3, s[16:19], s42 offen offset:16
    s_add_u32 s38, s42, 3358720
    buffer_load_dwordx4 v[72:75], v3, s[12:15], s38 offen sc1
    s_barrier
    s_waitcnt vmcnt(0)
    v_add_u32 v6, s44, v3
    v_add_u32 v7, 16640, v6
    ds_write_b128 v7, v[64:67]
    ds_write_b128 v6, v[16:19] offset:32
    v_alignbit_b32 v40, v17, v16, 16
    v_alignbit_b32 v41, v18, v17, 16
    v_alignbit_b32 v42, v19, v18, 16
    v_alignbit_b32 v43, v20, v19, 16
    ds_write_b128 v6, v[40:43] offset:4192
    v_mov_b32 v44, v41
    v_mov_b32 v45, v42
    v_mov_b32 v46, v43
    v_alignbit_b32 v47, v21, v20, 16
    ds_write_b128 v6, v[44:47] offset:12512
    v_mov_b32 v48, v17
    v_mov_b32 v49, v18
    v_mov_b32 v50, v19
    v_mov_b32 v51, v20
    ds_write_b128 v6, v[48:51] offset:8352
    s_cmp_lg_u32 s48, 0
    s_cbranch_scc1 A_CNH0
    v_mov_b32 v8, 0
    v_mov_b32 v9, 0
    v_mov_b32 v10, 0
    v_mov_b32 v11, 0
    v_lshlrev_b32 v55, 16, v16
    v_mov_b32 v52, 0
    v_mov_b32 v53, 0
    v_mov_b32 v54, 0
    v_mov_b32 v56, 0
    v_mov_b32 v57, 0
    v_mov_b32 v58, 0
    v_mov_b32 v60, 0
    v_mov_b32 v61, 0
    v_mov_b32 v59, v16
    v_mov_b32 v62, v55
    v_mov_b32 v63, v40
    v_cmp_gt_u32 vcc, 30, v1
    s_and_saveexec_b64 s[56:57], vcc
    ds_write_b128 v6, v[8:11] offset:20736
    s_mov_b64 exec, 1
    ds_write_b128 v6, v[8:11] offset:0
    ds_write_b128 v6, v[8:11] offset:4160
    ds_write_b128 v6, v[8:11] offset:8320
    ds_write_b128 v6, v[8:11] offset:12480
    ds_write_b128 v6, v[8:11] offset:16
    ds_write_b128 v6, v[52:55] offset:4176
    ds_write_b128 v6, v[56:59] offset:8336
    ds_write_b128 v6, v[60:63] offset:12496
    s_mov_b64 exec, -1
A_CNH0:
    v_add_u32 v6, s45, v3
    v_add_u32 v7, 16640, v6
    ds_write_b128 v7, v[68:71]
    ds_write_b128 v6, v[24:27] offset:32
    v_alignbit_b32 v40, v25, v24, 16
    v_alignbit_b32 v41, v26, v25, 16
    v_alignbit_b32 v42, v27, v26, 16
    v_alignbit_b32 v43, v28, v27, 16
    ds_write_b128 v6, v[40:43] offset:4192
    v_mov_b32 v44, v41
    v_mov_b32 v45, v42
    v_mov_b32 v46, v43
    v_alignbit_b32 v47, v29, v28, 16
    ds_write_b128 v6, v[44:47] offset:12512
    v_mov_b32 v48, v25
    v_mov_b32 v49, v26
    v_mov_b32 v50, v27
    v_mov_b32 v51, v28
    ds_write_b128 v6, v[48:51] offset:8352
    s_cmp_lg_u32 s49, 0
    s_cbranch_scc1 A_CNH1
    v_mov_b32 v8, 0
    v_mov_b32 v9, 0
    v_mov_b32 v10, 0
    v_mov_b32 v11, 0
    v_lshlrev_b32 v55, 16, v24
    v_mov_b32 v52, 0
    v_mov_b32 v53, 0
    v_mov_b32 v54, 0
    v_mov_b32 v56, 0
    v_mov_b32 v57, 0
    v_mov_b32 v58, 0
    v_mov_b32 v60, 0
    v_mov_b32 v61, 0
    v_mov_b32 v59, v24
    v_mov_b32 v62, v55
    v_mov_b32 v63, v40
    v_cmp_gt_u32 vcc, 30, v1
    s_and_saveexec_b64 s[56:57], vcc
    ds_write_b128 v6, v[8:11] offset:20736
    s_mov_b64 exec, 1
    ds_write_b128 v6, v[8:11] offset:0
    ds_write_b128 v6, v[8:11] offset:4160
    ds_write_b128 v6, v[8:11] offset:8320
    ds_write_b128 v6, v[8:11] offset:12480
    ds_write_b128 v6, v[8:11] offset:16
    ds_write_b128 v6, v[52:55] offset:4176
    ds_write_b128 v6, v[56:59] offset:8336
    ds_write_b128 v6, v[60:63] offset:12496
    s_mov_b64 exec, -1
A_CNH1:
    v_add_u32 v6, s46, v3
    v_add_u32 v7, 16640, v6
    ds_write_b128 v7, v[72:75]
    ds_write_b128 v6, v[32:35] offset:32
    v_alignbit_b32 v40, v33, v32, 16
    v_alignbit_b32 v41, v34, v33, 16
    v_alignbit_b32 v42, v35, v34, 16
    v_alignbit_b32 v43, v36, v35, 16
    ds_write_b128 v6, v[40:43] offset:4192
    v_mov_b32 v44, v41
    v_mov_b32 v45, v42
    v_mov_b32 v46, v43
    v_alignbit_b32 v47, v37, v36, 16
    ds_write_b128 v6, v[44:47] offset:12512
    v_mov_b32 v48, v33
    v_mov_b32 v49, v34
    v_mov_b32 v50, v35
    v_mov_b32 v51, v36
    ds_write_b128 v6, v[48:51] offset:8352
    s_cmp_lg_u32 s50, 0
    s_cbranch_scc1 A_CNH2
    v_mov_b32 v8, 0
    v_mov_b32 v9, 0
    v_mov_b32 v10, 0
    v_mov_b32 v11, 0
    v_lshlrev_b32 v55, 16, v32
    v_mov_b32 v52, 0
    v_mov_b32 v53, 0
    v_mov_b32 v54, 0
    v_mov_b32 v56, 0
    v_mov_b32 v57, 0
    v_mov_b32 v58, 0
    v_mov_b32 v60, 0
    v_mov_b32 v61, 0
    v_mov_b32 v59, v32
    v_mov_b32 v62, v55
    v_mov_b32 v63, v40
    v_cmp_gt_u32 vcc, 30, v1
    s_and_saveexec_b64 s[56:57], vcc
    ds_write_b128 v6, v[8:11] offset:20736
    s_mov_b64 exec, 1
    ds_write_b128 v6, v[8:11] offset:0
    ds_write_b128 v6, v[8:11] offset:4160
    ds_write_b128 v6, v[8:11] offset:8320
    ds_write_b128 v6, v[8:11] offset:12480
    ds_write_b128 v6, v[8:11] offset:16
    ds_write_b128 v6, v[52:55] offset:4176
    ds_write_b128 v6, v[56:59] offset:8336
    ds_write_b128 v6, v[60:63] offset:12496
    s_mov_b64 exec, -1
A_CNH2:
    s_waitcnt lgkmcnt(0)
A_CONV:
    s_load_dwordx2 s[16:17], s[0:1], 64
    s_waitcnt lgkmcnt(0)
    s_mov_b32 s18, 1152
    s_mov_b32 s19, 0x20000
    s_lshr_b32 s40, s22, 2
    s_bfe_u32 s41, s22, 0x10001
    s_and_b32 s42, s22, 1
    s_lshl_b32 s43, s2, 1
    s_add_u32 s43, s43, s40
    s_mul_i32 s34, s40, 21248
    s_add_u32 s34, s34, 2560
    s_lshl_b32 s35, s43, 1
    v_mov_b32 v28, s35
    buffer_load_ushort v29, v28, s[16:19], 0 offen
    v_and_b32 v2, 15, v1
    v_lshrrev_b32 v3, 4, v1
    v_add_u32 v4, 1, v2
    v_and_b32 v5, 3, v4
    v_sub_u32 v4, v4, v5
    v_lshl_add_u32 v4, v3, 3, v4
    v_lshlrev_b32 v4, 1, v4
    v_mul_u32_u24 v5, 4160, v5
    s_lshl_b32 s35, s42, 6
    s_add_u32 s36, s34, s35
    v_add3_u32 v24, v4, v5, s36
    v_lshlrev_b32 v4, 5, v2
    v_lshlrev_b32 v5, 4, v3
    v_sub_u32 v25, v5, v4
    s_add_u32 s36, s36, 17120
    v_add_u32 v25, s36, v25
    v_lshlrev_b32 v5, 3, v3
    v_add_u32 v27, v4, v5
    s_add_u32 s36, s34, 17144
    v_sub_u32 v26, s36, v27
    v_mov_b32 v8, 0
    v_mov_b32 v9, 0
    v_mov_b32 v10, 0
    v_mov_b32 v11, 0
    v_mov_b32 v12, 0
    v_mov_b32 v13, 0
    v_mov_b32 v14, 0
    v_mov_b32 v15, 0
    v_mov_b32 v16, 0
    v_mov_b32 v17, 0
    v_mov_b32 v18, 0
    v_mov_b32 v19, 0
    v_mov_b32 v20, 0
    v_mov_b32 v21, 0
    v_mov_b32 v22, 0
    v_mov_b32 v23, 0
    s_lshr_b32 s49, s2, 2
    s_add_u32 s49, s49, 512
    s_and_b32 s48, s2, 3
    s_mov_b32 s34, 45056
    s_lshl_b32 s35, s49, 1
    v_mov_b32 v28, s35
    buffer_load_ushort v30, v28, s[16:19], 0 offen
    v_and_b32 v2, 15, v1
    v_lshrrev_b32 v3, 4, v1
    v_add_u32 v4, 1, v2
    v_and_b32 v5, 3, v4
    v_sub_u32 v4, v4, v5
    v_lshl_add_u32 v4, v3, 3, v4
    v_lshlrev_b32 v4, 1, v4
    v_mul_u32_u24 v5, 4160, v5
    s_lshl_b32 s35, s22, 6
    s_add_u32 s36, s34, s35
    v_add3_u32 v176, v4, v5, s36
    v_lshlrev_b32 v4, 5, v2
    v_lshlrev_b32 v5, 4, v3
    v_sub_u32 v177, v5, v4
    s_add_u32 s36, s36, 17120
    v_add_u32 v177, s36, v177
    v_lshlrev_b32 v5, 3, v3
    v_add_u32 v179, v4, v5
    s_add_u32 s36, s34, 17144
    v_sub_u32 v178, s36, v179
    v_mov_b32 v160, 0
    v_mov_b32 v161, 0
    v_mov_b32 v162, 0
    v_mov_b32 v163, 0
    v_mov_b32 v164, 0
    v_mov_b32 v165, 0
    v_mov_b32 v166, 0
    v_mov_b32 v167, 0
    s_barrier
    s_cmp_eq_u32 s41, 0
    s_cbranch_scc0 A_CG2H1
    ds_read_b128 v[32:35], v25 offset:3584
    ds_read_b64 v[64:65], v24 offset:0
    ds_read_b64 v[66:67], v24 offset:8
    ds_read_b128 v[36:39], v25 offset:3072
    ds_read_b64 v[68:69], v24 offset:512
    ds_read_b64 v[70:71], v24 offset:520
    ds_read_b128 v[40:43], v25 offset:2560
    ds_read_b64 v[72:73], v24 offset:1024
    ds_read_b64 v[74:75], v24 offset:1032
    ds_read_b128 v[44:47], v25 offset:2048
    ds_read_b64 v[76:77], v24 offset:1536
    ds_read_b64 v[78:79], v24 offset:1544
    ds_read_b128 v[48:51], v25 offset:1536
    ds_read_b64 v[80:81], v24 offset:2048
    ds_read_b64 v[82:83], v24 offset:2056
    ds_read_b128 v[52:55], v25 offset:1024
    ds_read_b64 v[84:85], v24 offset:2560
    ds_read_b64 v[86:87], v24 offset:2568
    ds_read_b128 v[56:59], v25 offset:512
    ds_read_b64 v[88:89], v24 offset:3072
    ds_read_b64 v[90:91], v24 offset:3080
    ds_read_b128 v[60:63], v25 offset:0
    ds_read_b64 v[92:93], v24 offset:3584
    ds_read_b64 v[94:95], v24 offset:3592
    s_waitcnt lgkmcnt(0)
    v_mfma_f32_16x16x32_bf16 v[8:11], v[64:67], v[32:35], v[8:11]
    ds_read_b128 v[96:99], v25 offset:3712
    ds_read_b64 v[128:129], v24 offset:128
    v_mfma_f32_16x16x32_bf16 v[12:15], v[64:67], v[44:47], v[12:15]
    ds_read_b64 v[130:131], v24 offset:136
    ds_read_b128 v[100:103], v25 offset:3200
    v_mfma_f32_16x16x32_bf16 v[16:19], v[64:67], v[48:51], v[16:19]
    ds_read_b64 v[132:133], v24 offset:640
    ds_read_b64 v[134:135], v24 offset:648
    v_mfma_f32_16x16x32_bf16 v[20:23], v[64:67], v[60:63], v[20:23]
    ds_read_b128 v[104:107], v25 offset:2688
    ds_read_b64 v[136:137], v24 offset:1152
    v_mfma_f32_16x16x32_bf16 v[12:15], v[68:71], v[40:43], v[12:15]
    ds_read_b64 v[138:139], v24 offset:1160
    ds_read_b128 v[108:111], v25 offset:2176
    v_mfma_f32_16x16x32_bf16 v[16:19], v[68:71], v[44:47], v[16:19]
    ds_read_b64 v[140:141], v24 offset:1664
    ds_read_b64 v[142:143], v24 offset:1672
    v_mfma_f32_16x16x32_bf16 v[20:23], v[68:71], v[56:59], v[20:23]
    ds_read_b128 v[112:115], v25 offset:1664
    ds_read_b64 v[144:145], v24 offset:2176
    v_mfma_f32_16x16x32_bf16 v[12:15], v[72:75], v[36:39], v[12:15]
    ds_read_b64 v[146:147], v24 offset:2184
    ds_read_b128 v[116:119], v25 offset:1152
    v_mfma_f32_16x16x32_bf16 v[16:19], v[72:75], v[40:43], v[16:19]
    ds_read_b64 v[148:149], v24 offset:2688
    ds_read_b64 v[150:151], v24 offset:2696
    v_mfma_f32_16x16x32_bf16 v[20:23], v[72:75], v[52:55], v[20:23]
    ds_read_b128 v[120:123], v25 offset:640
    ds_read_b64 v[152:153], v24 offset:3200
    v_mfma_f32_16x16x32_bf16 v[12:15], v[76:79], v[32:35], v[12:15]
    ds_read_b64 v[154:155], v24 offset:3208
    ds_read_b128 v[124:127], v25 offset:128
    v_mfma_f32_16x16x32_bf16 v[16:19], v[76:79], v[36:39], v[16:19]
    ds_read_b64 v[156:157], v24 offset:3712
    ds_read_b64 v[158:159], v24 offset:3720
    v_mfma_f32_16x16x32_bf16 v[20:23], v[76:79], v[48:51], v[20:23]
    v_mfma_f32_16x16x32_bf16 v[16:19], v[80:83], v[32:35], v[16:19]
    v_mfma_f32_16x16x32_bf16 v[20:23], v[80:83], v[44:47], v[20:23]
    v_mfma_f32_16x16x32_bf16 v[20:23], v[84:87], v[40:43], v[20:23]
    v_mfma_f32_16x16x32_bf16 v[20:23], v[88:91], v[36:39], v[20:23]
    v_mfma_f32_16x16x32_bf16 v[20:23], v[92:95], v[32:35], v[20:23]
    s_cmp_ge_u32 s22, 4
    s_cbranch_scc1 A_CNF0
    s_waitcnt vmcnt(0)
    v_mov_b32 v180, s60
    v_mov_b32 v181, 0
    s_mov_b64 exec, 1
    buffer_store_dword v180, v181, s[12:15], s53 offen sc1
    s_mov_b64 exec, -1
    s_cmp_ge_u32 s22, 3
    s_cbranch_scc1 A_CNF0
    s_cmp_ge_u32 s2, 216
    s_cbranch_scc1 A_CNF0
    s_load_dwordx2 s[8:9], s[0:1], 16
    s_and_b32 s20, s2, 7
    s_mul_i32 s20, s20, 81
    s_lshr_b32 s21, s2, 3
    s_mul_i32 s21, s21, 3
    s_add_u32 s20, s20, s21
    s_add_u32 s20, s20, s22
    s_mul_hi_u32 s23, s20, 119304648
    s_mul_i32 s21, s23, 36
    s_sub_u32 s21, s20, s21
    v_and_b32 v208, 15, v1
    v_lshrrev_b32 v209, 4, v1
    s_lshl_b32 s24, s21, 4
    v_add_u32 v210, s24, v208
    v_lshlrev_b32 v210, 1, v210
    s_mul_i32 s59, s21, 18
    s_add_u32 s59, s59, s23
    s_lshl_b32 s59, s59, 10
    s_add_u32 s59, s59, 2498560
    s_waitcnt lgkmcnt(0)
    s_mov_b32 s10, 663552
    s_mov_b32 s11, 0x20000
    s_cmp_ge_u32 s23, 16
    s_cbranch_scc1 A_CO0EXT
    v_lshrrev_b32 v211, 1, v209
    v_mul_u32_u24 v211, 18, v211
    v_and_b32 v212, 1, v209
    v_lshl_add_u32 v211, v212, 2, v211
    v_mul_u32_u24 v211, 1152, v211
    v_add_u32 v211, v211, v210
    s_mul_i32 s25, s23, 41472
    s_add_u32 s26, s25, 0
    buffer_load_ushort v200, v211, s[8:11], s26 offen
    s_add_u32 s26, s25, 1152
    buffer_load_ushort v201, v211, s[8:11], s26 offen
    s_add_u32 s26, s25, 2304
    buffer_load_ushort v202, v211, s[8:11], s26 offen
    s_add_u32 s26, s25, 3456
    buffer_load_ushort v203, v211, s[8:11], s26 offen
    s_add_u32 s26, s25, 9216
    buffer_load_ushort v204, v211, s[8:11], s26 offen
    s_add_u32 s26, s25, 10368
    buffer_load_ushort v205, v211, s[8:11], s26 offen
    s_add_u32 s26, s25, 11520
    buffer_load_ushort v206, v211, s[8:11], s26 offen
    s_add_u32 s26, s25, 12672
    buffer_load_ushort v207, v211, s[8:11], s26 offen
    s_branch A_CO0ST
A_CO0EXT:
    v_mul_u32_u24 v211, 82944, v209
    v_add_u32 v211, v211, v210
    s_sub_u32 s25, s23, 16
    s_mul_i32 s25, s25, 331776
    s_add_u32 s26, s25, 18432
    buffer_load_ushort v200, v211, s[8:11], s26 offen
    s_add_u32 s26, s25, 19584
    buffer_load_ushort v201, v211, s[8:11], s26 offen
    s_add_u32 s26, s25, 39168
    buffer_load_ushort v202, v211, s[8:11], s26 offen
    s_add_u32 s26, s25, 40320
    buffer_load_ushort v203, v211, s[8:11], s26 offen
    s_add_u32 s26, s25, 59904
    buffer_load_ushort v204, v211, s[8:11], s26 offen
    s_add_u32 s26, s25, 61056
    buffer_load_ushort v205, v211, s[8:11], s26 offen
    s_add_u32 s26, s25, 80640
    buffer_load_ushort v206, v211, s[8:11], s26 offen
    s_add_u32 s26, s25, 81792
    buffer_load_ushort v207, v211, s[8:11], s26 offen
A_CO0ST:
A_CNF0:
    s_waitcnt lgkmcnt(0)
    v_mfma_f32_16x16x32_bf16 v[8:11], v[128:131], v[96:99], v[8:11]
    ds_read_b128 v[32:35], v25 offset:3840
    ds_read_b64 v[64:65], v24 offset:256
    v_mfma_f32_16x16x32_bf16 v[12:15], v[128:131], v[108:111], v[12:15]
    ds_read_b64 v[66:67], v24 offset:264
    ds_read_b128 v[36:39], v25 offset:3328
    v_mfma_f32_16x16x32_bf16 v[16:19], v[128:131], v[112:115], v[16:19]
    ds_read_b64 v[68:69], v24 offset:768
    ds_read_b64 v[70:71], v24 offset:776
    v_mfma_f32_16x16x32_bf16 v[20:23], v[128:131], v[124:127], v[20:23]
    ds_read_b128 v[40:43], v25 offset:2816
    ds_read_b64 v[72:73], v24 offset:1280
    v_mfma_f32_16x16x32_bf16 v[12:15], v[132:135], v[104:107], v[12:15]
    ds_read_b64 v[74:75], v24 offset:1288
    ds_read_b128 v[44:47], v25 offset:2304
    v_mfma_f32_16x16x32_bf16 v[16:19], v[132:135], v[108:111], v[16:19]
    ds_read_b64 v[76:77], v24 offset:1792
    ds_read_b64 v[78:79], v24 offset:1800
    v_mfma_f32_16x16x32_bf16 v[20:23], v[132:135], v[120:123], v[20:23]
    ds_read_b128 v[48:51], v25 offset:1792
    ds_read_b64 v[80:81], v24 offset:2304
    v_mfma_f32_16x16x32_bf16 v[12:15], v[136:139], v[100:103], v[12:15]
    ds_read_b64 v[82:83], v24 offset:2312
    ds_read_b128 v[52:55], v25 offset:1280
    v_mfma_f32_16x16x32_bf16 v[16:19], v[136:139], v[104:107], v[16:19]
    ds_read_b64 v[84:85], v24 offset:2816
    ds_read_b64 v[86:87], v24 offset:2824
    v_mfma_f32_16x16x32_bf16 v[20:23], v[136:139], v[116:119], v[20:23]
    ds_read_b128 v[56:59], v25 offset:768
    ds_read_b64 v[88:89], v24 offset:3328
    v_mfma_f32_16x16x32_bf16 v[12:15], v[140:143], v[96:99], v[12:15]
    ds_read_b64 v[90:91], v24 offset:3336
    ds_read_b128 v[60:63], v25 offset:256
    v_mfma_f32_16x16x32_bf16 v[16:19], v[140:143], v[100:103], v[16:19]
    ds_read_b64 v[92:93], v24 offset:3840
    ds_read_b64 v[94:95], v24 offset:3848
    v_mfma_f32_16x16x32_bf16 v[20:23], v[140:143], v[112:115], v[20:23]
    v_mfma_f32_16x16x32_bf16 v[16:19], v[144:147], v[96:99], v[16:19]
    v_mfma_f32_16x16x32_bf16 v[20:23], v[144:147], v[108:111], v[20:23]
    v_mfma_f32_16x16x32_bf16 v[20:23], v[148:151], v[104:107], v[20:23]
    v_mfma_f32_16x16x32_bf16 v[20:23], v[152:155], v[100:103], v[20:23]
    v_mfma_f32_16x16x32_bf16 v[20:23], v[156:159], v[96:99], v[20:23]
    s_waitcnt lgkmcnt(0)
    v_mfma_f32_16x16x32_bf16 v[8:11], v[64:67], v[32:35], v[8:11]
    ds_read_b128 v[96:99], v25 offset:3968
    ds_read_b64 v[128:129], v24 offset:384
    v_mfma_f32_16x16x32_bf16 v[12:15], v[64:67], v[44:47], v[12:15]
    ds_read_b64 v[130:131], v24 offset:392
    ds_read_b128 v[100:103], v25 offset:3456
    v_mfma_f32_16x16x32_bf16 v[16:19], v[64:67], v[48:51], v[16:19]
    ds_read_b64 v[132:133], v24 offset:896
    ds_read_b64 v[134:135], v24 offset:904
    v_mfma_f32_16x16x32_bf16 v[20:23], v[64:67], v[60:63], v[20:23]
    ds_read_b128 v[104:107], v25 offset:2944
    ds_read_b64 v[136:137], v24 offset:1408
    v_mfma_f32_16x16x32_bf16 v[12:15], v[68:71], v[40:43], v[12:15]
    ds_read_b64 v[138:139], v24 offset:1416
    ds_read_b128 v[108:111], v25 offset:2432
    v_mfma_f32_16x16x32_bf16 v[16:19], v[68:71], v[44:47], v[16:19]
    ds_read_b64 v[140:141], v24 offset:1920
    ds_read_b64 v[142:143], v24 offset:1928
    v_mfma_f32_16x16x32_bf16 v[20:23], v[68:71], v[56:59], v[20:23]
    ds_read_b128 v[112:115], v25 offset:1920
    ds_read_b64 v[144:145], v24 offset:2432
    v_mfma_f32_16x16x32_bf16 v[12:15], v[72:75], v[36:39], v[12:15]
    ds_read_b64 v[146:147], v24 offset:2440
    ds_read_b128 v[116:119], v25 offset:1408
    v_mfma_f32_16x16x32_bf16 v[16:19], v[72:75], v[40:43], v[16:19]
    ds_read_b64 v[148:149], v24 offset:2944
    ds_read_b64 v[150:151], v24 offset:2952
    v_mfma_f32_16x16x32_bf16 v[20:23], v[72:75], v[52:55], v[20:23]
    ds_read_b128 v[120:123], v25 offset:896
    ds_read_b64 v[152:153], v24 offset:3456
    v_mfma_f32_16x16x32_bf16 v[12:15], v[76:79], v[32:35], v[12:15]
    ds_read_b64 v[154:155], v24 offset:3464
    ds_read_b128 v[124:127], v25 offset:384
    v_mfma_f32_16x16x32_bf16 v[16:19], v[76:79], v[36:39], v[16:19]
    ds_read_b64 v[156:157], v24 offset:3968
    ds_read_b64 v[158:159], v24 offset:3976
    v_mfma_f32_16x16x32_bf16 v[20:23], v[76:79], v[48:51], v[20:23]
    v_mfma_f32_16x16x32_bf16 v[16:19], v[80:83], v[32:35], v[16:19]
    v_mfma_f32_16x16x32_bf16 v[20:23], v[80:83], v[44:47], v[20:23]
    v_mfma_f32_16x16x32_bf16 v[20:23], v[84:87], v[40:43], v[20:23]
    v_mfma_f32_16x16x32_bf16 v[20:23], v[88:91], v[36:39], v[20:23]
    v_mfma_f32_16x16x32_bf16 v[20:23], v[92:95], v[32:35], v[20:23]
    s_waitcnt lgkmcnt(0)
    v_mfma_f32_16x16x32_bf16 v[8:11], v[128:131], v[96:99], v[8:11]
    ds_read_b128 v[32:35], v177 offset:3584
    ds_read_b64 v[64:65], v176 offset:0
    v_mfma_f32_16x16x32_bf16 v[12:15], v[128:131], v[108:111], v[12:15]
    ds_read_b64 v[66:67], v176 offset:8
    ds_read_b128 v[36:39], v177 offset:3072
    v_mfma_f32_16x16x32_bf16 v[16:19], v[128:131], v[112:115], v[16:19]
    ds_read_b64 v[68:69], v176 offset:512
    ds_read_b64 v[70:71], v176 offset:520
    v_mfma_f32_16x16x32_bf16 v[20:23], v[128:131], v[124:127], v[20:23]
    ds_read_b128 v[40:43], v177 offset:2560
    ds_read_b64 v[72:73], v176 offset:1024
    v_mfma_f32_16x16x32_bf16 v[12:15], v[132:135], v[104:107], v[12:15]
    ds_read_b64 v[74:75], v176 offset:1032
    ds_read_b128 v[44:47], v177 offset:2048
    v_mfma_f32_16x16x32_bf16 v[16:19], v[132:135], v[108:111], v[16:19]
    ds_read_b64 v[76:77], v176 offset:1536
    ds_read_b64 v[78:79], v176 offset:1544
    v_mfma_f32_16x16x32_bf16 v[20:23], v[132:135], v[120:123], v[20:23]
    ds_read_b128 v[48:51], v177 offset:1536
    ds_read_b64 v[80:81], v176 offset:2048
    v_mfma_f32_16x16x32_bf16 v[12:15], v[136:139], v[100:103], v[12:15]
    ds_read_b64 v[82:83], v176 offset:2056
    ds_read_b128 v[52:55], v177 offset:1024
    v_mfma_f32_16x16x32_bf16 v[16:19], v[136:139], v[104:107], v[16:19]
    ds_read_b64 v[84:85], v176 offset:2560
    ds_read_b64 v[86:87], v176 offset:2568
    v_mfma_f32_16x16x32_bf16 v[20:23], v[136:139], v[116:119], v[20:23]
    ds_read_b128 v[56:59], v177 offset:512
    ds_read_b64 v[88:89], v176 offset:3072
    v_mfma_f32_16x16x32_bf16 v[12:15], v[140:143], v[96:99], v[12:15]
    ds_read_b64 v[90:91], v176 offset:3080
    ds_read_b128 v[60:63], v177 offset:0
    v_mfma_f32_16x16x32_bf16 v[16:19], v[140:143], v[100:103], v[16:19]
    ds_read_b64 v[92:93], v176 offset:3584
    ds_read_b64 v[94:95], v176 offset:3592
    v_mfma_f32_16x16x32_bf16 v[20:23], v[140:143], v[112:115], v[20:23]
    v_mfma_f32_16x16x32_bf16 v[16:19], v[144:147], v[96:99], v[16:19]
    v_mfma_f32_16x16x32_bf16 v[20:23], v[144:147], v[108:111], v[20:23]
    v_mfma_f32_16x16x32_bf16 v[20:23], v[148:151], v[104:107], v[20:23]
    v_mfma_f32_16x16x32_bf16 v[20:23], v[152:155], v[100:103], v[20:23]
    v_mfma_f32_16x16x32_bf16 v[20:23], v[156:159], v[96:99], v[20:23]
    s_branch A_CG2HD
A_CG2H1:
    ds_read_b128 v[32:35], v25 offset:3584
    ds_read_b64 v[64:65], v24 offset:0
    ds_read_b64 v[66:67], v24 offset:8
    ds_read_b128 v[36:39], v25 offset:3072
    ds_read_b64 v[68:69], v24 offset:512
    ds_read_b64 v[70:71], v24 offset:520
    ds_read_b128 v[40:43], v25 offset:2560
    ds_read_b64 v[72:73], v24 offset:1024
    ds_read_b64 v[74:75], v24 offset:1032
    ds_read_b128 v[44:47], v25 offset:2048
    ds_read_b64 v[76:77], v24 offset:1536
    ds_read_b64 v[78:79], v24 offset:1544
    ds_read_b128 v[48:51], v25 offset:1536
    ds_read_b64 v[80:81], v24 offset:2048
    ds_read_b64 v[82:83], v24 offset:2056
    ds_read_b128 v[52:55], v25 offset:1024
    ds_read_b64 v[84:85], v24 offset:2560
    ds_read_b64 v[86:87], v24 offset:2568
    ds_read_b128 v[56:59], v25 offset:512
    ds_read_b64 v[88:89], v24 offset:3072
    ds_read_b64 v[90:91], v24 offset:3080
    s_waitcnt lgkmcnt(0)
    v_mfma_f32_16x16x32_bf16 v[8:11], v[64:67], v[36:39], v[8:11]
    ds_read_b128 v[96:99], v25 offset:3712
    ds_read_b64 v[128:129], v24 offset:128
    v_mfma_f32_16x16x32_bf16 v[12:15], v[64:67], v[40:43], v[12:15]
    ds_read_b64 v[130:131], v24 offset:136
    ds_read_b128 v[100:103], v25 offset:3200
    v_mfma_f32_16x16x32_bf16 v[16:19], v[64:67], v[52:55], v[16:19]
    ds_read_b64 v[132:133], v24 offset:640
    ds_read_b64 v[134:135], v24 offset:648
    v_mfma_f32_16x16x32_bf16 v[20:23], v[64:67], v[56:59], v[20:23]
    ds_read_b128 v[104:107], v25 offset:2688
    ds_read_b64 v[136:137], v24 offset:1152
    v_mfma_f32_16x16x32_bf16 v[8:11], v[68:71], v[32:35], v[8:11]
    ds_read_b64 v[138:139], v24 offset:1160
    ds_read_b128 v[108:111], v25 offset:2176
    v_mfma_f32_16x16x32_bf16 v[12:15], v[68:71], v[36:39], v[12:15]
    ds_read_b64 v[140:141], v24 offset:1664
    ds_read_b64 v[142:143], v24 offset:1672
    v_mfma_f32_16x16x32_bf16 v[16:19], v[68:71], v[48:51], v[16:19]
    ds_read_b128 v[112:115], v25 offset:1664
    ds_read_b64 v[144:145], v24 offset:2176
    v_mfma_f32_16x16x32_bf16 v[20:23], v[68:71], v[52:55], v[20:23]
    ds_read_b64 v[146:147], v24 offset:2184
    ds_read_b128 v[116:119], v25 offset:1152
    v_mfma_f32_16x16x32_bf16 v[12:15], v[72:75], v[32:35], v[12:15]
    ds_read_b64 v[148:149], v24 offset:2688
    ds_read_b64 v[150:151], v24 offset:2696
    v_mfma_f32_16x16x32_bf16 v[16:19], v[72:75], v[44:47], v[16:19]
    ds_read_b128 v[120:123], v25 offset:640
    ds_read_b64 v[152:153], v24 offset:3200
    v_mfma_f32_16x16x32_bf16 v[20:23], v[72:75], v[48:51], v[20:23]
    ds_read_b64 v[154:155], v24 offset:3208
    v_mfma_f32_16x16x32_bf16 v[16:19], v[76:79], v[40:43], v[16:19]
    v_mfma_f32_16x16x32_bf16 v[20:23], v[76:79], v[44:47], v[20:23]
    v_mfma_f32_16x16x32_bf16 v[16:19], v[80:83], v[36:39], v[16:19]
    v_mfma_f32_16x16x32_bf16 v[20:23], v[80:83], v[40:43], v[20:23]
    v_mfma_f32_16x16x32_bf16 v[16:19], v[84:87], v[32:35], v[16:19]
    v_mfma_f32_16x16x32_bf16 v[20:23], v[84:87], v[36:39], v[20:23]
    v_mfma_f32_16x16x32_bf16 v[20:23], v[88:91], v[32:35], v[20:23]
    s_cmp_ge_u32 s22, 4
    s_cbranch_scc1 A_CNF1
    s_waitcnt vmcnt(0)
    v_mov_b32 v180, s60
    v_mov_b32 v181, 0
    s_mov_b64 exec, 1
    buffer_store_dword v180, v181, s[12:15], s53 offen sc1
    s_mov_b64 exec, -1
    s_cmp_ge_u32 s22, 3
    s_cbranch_scc1 A_CNF1
    s_cmp_ge_u32 s2, 216
    s_cbranch_scc1 A_CNF1
    s_load_dwordx2 s[8:9], s[0:1], 16
    s_and_b32 s20, s2, 7
    s_mul_i32 s20, s20, 81
    s_lshr_b32 s21, s2, 3
    s_mul_i32 s21, s21, 3
    s_add_u32 s20, s20, s21
    s_add_u32 s20, s20, s22
    s_mul_hi_u32 s23, s20, 119304648
    s_mul_i32 s21, s23, 36
    s_sub_u32 s21, s20, s21
    v_and_b32 v208, 15, v1
    v_lshrrev_b32 v209, 4, v1
    s_lshl_b32 s24, s21, 4
    v_add_u32 v210, s24, v208
    v_lshlrev_b32 v210, 1, v210
    s_mul_i32 s59, s21, 18
    s_add_u32 s59, s59, s23
    s_lshl_b32 s59, s59, 10
    s_add_u32 s59, s59, 2498560
    s_waitcnt lgkmcnt(0)
    s_mov_b32 s10, 663552
    s_mov_b32 s11, 0x20000
    s_cmp_ge_u32 s23, 16
    s_cbranch_scc1 A_CO1EXT
    v_lshrrev_b32 v211, 1, v209
    v_mul_u32_u24 v211, 18, v211
    v_and_b32 v212, 1, v209
    v_lshl_add_u32 v211, v212, 2, v211
    v_mul_u32_u24 v211, 1152, v211
    v_add_u32 v211, v211, v210
    s_mul_i32 s25, s23, 41472
    s_add_u32 s26, s25, 0
    buffer_load_ushort v200, v211, s[8:11], s26 offen
    s_add_u32 s26, s25, 1152
    buffer_load_ushort v201, v211, s[8:11], s26 offen
    s_add_u32 s26, s25, 2304
    buffer_load_ushort v202, v211, s[8:11], s26 offen
    s_add_u32 s26, s25, 3456
    buffer_load_ushort v203, v211, s[8:11], s26 offen
    s_add_u32 s26, s25, 9216
    buffer_load_ushort v204, v211, s[8:11], s26 offen
    s_add_u32 s26, s25, 10368
    buffer_load_ushort v205, v211, s[8:11], s26 offen
    s_add_u32 s26, s25, 11520
    buffer_load_ushort v206, v211, s[8:11], s26 offen
    s_add_u32 s26, s25, 12672
    buffer_load_ushort v207, v211, s[8:11], s26 offen
    s_branch A_CO1ST
A_CO1EXT:
    v_mul_u32_u24 v211, 82944, v209
    v_add_u32 v211, v211, v210
    s_sub_u32 s25, s23, 16
    s_mul_i32 s25, s25, 331776
    s_add_u32 s26, s25, 18432
    buffer_load_ushort v200, v211, s[8:11], s26 offen
    s_add_u32 s26, s25, 19584
    buffer_load_ushort v201, v211, s[8:11], s26 offen
    s_add_u32 s26, s25, 39168
    buffer_load_ushort v202, v211, s[8:11], s26 offen
    s_add_u32 s26, s25, 40320
    buffer_load_ushort v203, v211, s[8:11], s26 offen
    s_add_u32 s26, s25, 59904
    buffer_load_ushort v204, v211, s[8:11], s26 offen
    s_add_u32 s26, s25, 61056
    buffer_load_ushort v205, v211, s[8:11], s26 offen
    s_add_u32 s26, s25, 80640
    buffer_load_ushort v206, v211, s[8:11], s26 offen
    s_add_u32 s26, s25, 81792
    buffer_load_ushort v207, v211, s[8:11], s26 offen
A_CO1ST:
A_CNF1:
    s_waitcnt lgkmcnt(0)
    v_mfma_f32_16x16x32_bf16 v[8:11], v[128:131], v[100:103], v[8:11]
    ds_read_b128 v[32:35], v25 offset:3840
    ds_read_b64 v[64:65], v24 offset:256
    v_mfma_f32_16x16x32_bf16 v[12:15], v[128:131], v[104:107], v[12:15]
    ds_read_b64 v[66:67], v24 offset:264
    ds_read_b128 v[36:39], v25 offset:3328
    v_mfma_f32_16x16x32_bf16 v[16:19], v[128:131], v[116:119], v[16:19]
    ds_read_b64 v[68:69], v24 offset:768
    ds_read_b64 v[70:71], v24 offset:776
    v_mfma_f32_16x16x32_bf16 v[20:23], v[128:131], v[120:123], v[20:23]
    ds_read_b128 v[40:43], v25 offset:2816
    ds_read_b64 v[72:73], v24 offset:1280
    v_mfma_f32_16x16x32_bf16 v[8:11], v[132:135], v[96:99], v[8:11]
    ds_read_b64 v[74:75], v24 offset:1288
    ds_read_b128 v[44:47], v25 offset:2304
    v_mfma_f32_16x16x32_bf16 v[12:15], v[132:135], v[100:103], v[12:15]
    ds_read_b64 v[76:77], v24 offset:1792
    ds_read_b64 v[78:79], v24 offset:1800
    v_mfma_f32_16x16x32_bf16 v[16:19], v[132:135], v[112:115], v[16:19]
    ds_read_b128 v[48:51], v25 offset:1792
    ds_read_b64 v[80:81], v24 offset:2304
    v_mfma_f32_16x16x32_bf16 v[20:23], v[132:135], v[116:119], v[20:23]
    ds_read_b64 v[82:83], v24 offset:2312
    ds_read_b128 v[52:55], v25 offset:1280
    v_mfma_f32_16x16x32_bf16 v[12:15], v[136:139], v[96:99], v[12:15]
    ds_read_b64 v[84:85], v24 offset:2816
    ds_read_b64 v[86:87], v24 offset:2824
    v_mfma_f32_16x16x32_bf16 v[16:19], v[136:139], v[108:111], v[16:19]
    ds_read_b128 v[56:59], v25 offset:768
    ds_read_b64 v[88:89], v24 offset:3328
    v_mfma_f32_16x16x32_bf16 v[20:23], v[136:139], v[112:115], v[20:23]
    ds_read_b64 v[90:91], v24 offset:3336
    v_mfma_f32_16x16x32_bf16 v[16:19], v[140:143], v[104:107], v[16:19]
    v_mfma_f32_16x16x32_bf16 v[20:23], v[140:143], v[108:111], v[20:23]
    v_mfma_f32_16x16x32_bf16 v[16:19], v[144:147], v[100:103], v[16:19]
    v_mfma_f32_16x16x32_bf16 v[20:23], v[144:147], v[104:107], v[20:23]
    v_mfma_f32_16x16x32_bf16 v[16:19], v[148:151], v[96:99], v[16:19]
    v_mfma_f32_16x16x32_bf16 v[20:23], v[148:151], v[100:103], v[20:23]
    v_mfma_f32_16x16x32_bf16 v[20:23], v[152:155], v[96:99], v[20:23]
    s_waitcnt lgkmcnt(0)
    v_mfma_f32_16x16x32_bf16 v[8:11], v[64:67], v[36:39], v[8:11]
    ds_read_b128 v[96:99], v25 offset:3968
    ds_read_b64 v[128:129], v24 offset:384
    v_mfma_f32_16x16x32_bf16 v[12:15], v[64:67], v[40:43], v[12:15]
    ds_read_b64 v[130:131], v24 offset:392
    ds_read_b128 v[100:103], v25 offset:3456
    v_mfma_f32_16x16x32_bf16 v[16:19], v[64:67], v[52:55], v[16:19]
    ds_read_b64 v[132:133], v24 offset:896
    ds_read_b64 v[134:135], v24 offset:904
    v_mfma_f32_16x16x32_bf16 v[20:23], v[64:67], v[56:59], v[20:23]
    ds_read_b128 v[104:107], v25 offset:2944
    ds_read_b64 v[136:137], v24 offset:1408
    v_mfma_f32_16x16x32_bf16 v[8:11], v[68:71], v[32:35], v[8:11]
    ds_read_b64 v[138:139], v24 offset:1416
    ds_read_b128 v[108:111], v25 offset:2432
    v_mfma_f32_16x16x32_bf16 v[12:15], v[68:71], v[36:39], v[12:15]
    ds_read_b64 v[140:141], v24 offset:1920
    ds_read_b64 v[142:143], v24 offset:1928
    v_mfma_f32_16x16x32_bf16 v[16:19], v[68:71], v[48:51], v[16:19]
    ds_read_b128 v[112:115], v25 offset:1920
    ds_read_b64 v[144:145], v24 offset:2432
    v_mfma_f32_16x16x32_bf16 v[20:23], v[68:71], v[52:55], v[20:23]
    ds_read_b64 v[146:147], v24 offset:2440
    ds_read_b128 v[116:119], v25 offset:1408
    v_mfma_f32_16x16x32_bf16 v[12:15], v[72:75], v[32:35], v[12:15]
    ds_read_b64 v[148:149], v24 offset:2944
    ds_read_b64 v[150:151], v24 offset:2952
    v_mfma_f32_16x16x32_bf16 v[16:19], v[72:75], v[44:47], v[16:19]
    ds_read_b128 v[120:123], v25 offset:896
    ds_read_b64 v[152:153], v24 offset:3456
    v_mfma_f32_16x16x32_bf16 v[20:23], v[72:75], v[48:51], v[20:23]
    ds_read_b64 v[154:155], v24 offset:3464
    v_mfma_f32_16x16x32_bf16 v[16:19], v[76:79], v[40:43], v[16:19]
    v_mfma_f32_16x16x32_bf16 v[20:23], v[76:79], v[44:47], v[20:23]
    v_mfma_f32_16x16x32_bf16 v[16:19], v[80:83], v[36:39], v[16:19]
    v_mfma_f32_16x16x32_bf16 v[20:23], v[80:83], v[40:43], v[20:23]
    v_mfma_f32_16x16x32_bf16 v[16:19], v[84:87], v[32:35], v[16:19]
    v_mfma_f32_16x16x32_bf16 v[20:23], v[84:87], v[36:39], v[20:23]
    v_mfma_f32_16x16x32_bf16 v[20:23], v[88:91], v[32:35], v[20:23]
    s_waitcnt lgkmcnt(0)
    v_mfma_f32_16x16x32_bf16 v[8:11], v[128:131], v[100:103], v[8:11]
    ds_read_b128 v[32:35], v177 offset:3584
    ds_read_b64 v[64:65], v176 offset:0
    v_mfma_f32_16x16x32_bf16 v[12:15], v[128:131], v[104:107], v[12:15]
    ds_read_b64 v[66:67], v176 offset:8
    ds_read_b128 v[36:39], v177 offset:3072
    v_mfma_f32_16x16x32_bf16 v[16:19], v[128:131], v[116:119], v[16:19]
    ds_read_b64 v[68:69], v176 offset:512
    ds_read_b64 v[70:71], v176 offset:520
    v_mfma_f32_16x16x32_bf16 v[20:23], v[128:131], v[120:123], v[20:23]
    ds_read_b128 v[40:43], v177 offset:2560
    ds_read_b64 v[72:73], v176 offset:1024
    v_mfma_f32_16x16x32_bf16 v[8:11], v[132:135], v[96:99], v[8:11]
    ds_read_b64 v[74:75], v176 offset:1032
    ds_read_b128 v[44:47], v177 offset:2048
    v_mfma_f32_16x16x32_bf16 v[12:15], v[132:135], v[100:103], v[12:15]
    ds_read_b64 v[76:77], v176 offset:1536
    ds_read_b64 v[78:79], v176 offset:1544
    v_mfma_f32_16x16x32_bf16 v[16:19], v[132:135], v[112:115], v[16:19]
    ds_read_b128 v[48:51], v177 offset:1536
    ds_read_b64 v[80:81], v176 offset:2048
    v_mfma_f32_16x16x32_bf16 v[20:23], v[132:135], v[116:119], v[20:23]
    ds_read_b64 v[82:83], v176 offset:2056
    ds_read_b128 v[52:55], v177 offset:1024
    v_mfma_f32_16x16x32_bf16 v[12:15], v[136:139], v[96:99], v[12:15]
    ds_read_b64 v[84:85], v176 offset:2560
    ds_read_b64 v[86:87], v176 offset:2568
    v_mfma_f32_16x16x32_bf16 v[16:19], v[136:139], v[108:111], v[16:19]
    ds_read_b128 v[56:59], v177 offset:512
    ds_read_b64 v[88:89], v176 offset:3072
    v_mfma_f32_16x16x32_bf16 v[20:23], v[136:139], v[112:115], v[20:23]
    ds_read_b64 v[90:91], v176 offset:3080
    ds_read_b128 v[60:63], v177 offset:0
    v_mfma_f32_16x16x32_bf16 v[16:19], v[140:143], v[104:107], v[16:19]
    ds_read_b64 v[92:93], v176 offset:3584
    ds_read_b64 v[94:95], v176 offset:3592
    v_mfma_f32_16x16x32_bf16 v[20:23], v[140:143], v[108:111], v[20:23]
    v_mfma_f32_16x16x32_bf16 v[16:19], v[144:147], v[100:103], v[16:19]
    v_mfma_f32_16x16x32_bf16 v[20:23], v[144:147], v[104:107], v[20:23]
    v_mfma_f32_16x16x32_bf16 v[16:19], v[148:151], v[96:99], v[16:19]
    v_mfma_f32_16x16x32_bf16 v[20:23], v[148:151], v[100:103], v[20:23]
    v_mfma_f32_16x16x32_bf16 v[20:23], v[152:155], v[96:99], v[20:23]
A_CG2HD:
    s_waitcnt lgkmcnt(0)
    s_cmp_eq_u32 s48, 0
    s_cbranch_scc0 A_CQ1
    v_mfma_f32_16x16x32_bf16 v[160:163], v[64:67], v[32:35], v[160:163]
    v_mfma_f32_16x16x32_bf16 v[164:167], v[64:67], v[60:63], v[164:167]
    v_mfma_f32_16x16x32_bf16 v[164:167], v[68:71], v[56:59], v[164:167]
    v_mfma_f32_16x16x32_bf16 v[164:167], v[72:75], v[52:55], v[164:167]
    v_mfma_f32_16x16x32_bf16 v[164:167], v[76:79], v[48:51], v[164:167]
    v_mfma_f32_16x16x32_bf16 v[164:167], v[80:83], v[44:47], v[164:167]
    v_mfma_f32_16x16x32_bf16 v[164:167], v[84:87], v[40:43], v[164:167]
    v_mfma_f32_16x16x32_bf16 v[164:167], v[88:91], v[36:39], v[164:167]
    v_mfma_f32_16x16x32_bf16 v[164:167], v[92:95], v[32:35], v[164:167]
    s_branch A_CQD
A_CQ1:
    s_cmp_eq_u32 s48, 1
    s_cbranch_scc0 A_CQ2
    v_mfma_f32_16x16x32_bf16 v[160:163], v[64:67], v[36:39], v[160:163]
    v_mfma_f32_16x16x32_bf16 v[164:167], v[64:67], v[56:59], v[164:167]
    v_mfma_f32_16x16x32_bf16 v[160:163], v[68:71], v[32:35], v[160:163]
    v_mfma_f32_16x16x32_bf16 v[164:167], v[68:71], v[52:55], v[164:167]
    v_mfma_f32_16x16x32_bf16 v[164:167], v[72:75], v[48:51], v[164:167]
    v_mfma_f32_16x16x32_bf16 v[164:167], v[76:79], v[44:47], v[164:167]
    v_mfma_f32_16x16x32_bf16 v[164:167], v[80:83], v[40:43], v[164:167]
    v_mfma_f32_16x16x32_bf16 v[164:167], v[84:87], v[36:39], v[164:167]
    v_mfma_f32_16x16x32_bf16 v[164:167], v[88:91], v[32:35], v[164:167]
    s_branch A_CQD
A_CQ2:
    s_cmp_eq_u32 s48, 2
    s_cbranch_scc0 A_CQ3
    v_mfma_f32_16x16x32_bf16 v[160:163], v[64:67], v[40:43], v[160:163]
    v_mfma_f32_16x16x32_bf16 v[164:167], v[64:67], v[52:55], v[164:167]
    v_mfma_f32_16x16x32_bf16 v[160:163], v[68:71], v[36:39], v[160:163]
    v_mfma_f32_16x16x32_bf16 v[164:167], v[68:71], v[48:51], v[164:167]
    v_mfma_f32_16x16x32_bf16 v[160:163], v[72:75], v[32:35], v[160:163]
    v_mfma_f32_16x16x32_bf16 v[164:167], v[72:75], v[44:47], v[164:167]
    v_mfma_f32_16x16x32_bf16 v[164:167], v[76:79], v[40:43], v[164:167]
    v_mfma_f32_16x16x32_bf16 v[164:167], v[80:83], v[36:39], v[164:167]
    v_mfma_f32_16x16x32_bf16 v[164:167], v[84:87], v[32:35], v[164:167]
    s_branch A_CQD
A_CQ3:
    v_mfma_f32_16x16x32_bf16 v[160:163], v[64:67], v[44:47], v[160:163]
    v_mfma_f32_16x16x32_bf16 v[164:167], v[64:67], v[48:51], v[164:167]
    v_mfma_f32_16x16x32_bf16 v[160:163], v[68:71], v[40:43], v[160:163]
    v_mfma_f32_16x16x32_bf16 v[164:167], v[68:71], v[44:47], v[164:167]
    v_mfma_f32_16x16x32_bf16 v[160:163], v[72:75], v[36:39], v[160:163]
    v_mfma_f32_16x16x32_bf16 v[164:167], v[72:75], v[40:43], v[164:167]
    v_mfma_f32_16x16x32_bf16 v[160:163], v[76:79], v[32:35], v[160:163]
    v_mfma_f32_16x16x32_bf16 v[164:167], v[76:79], v[36:39], v[164:167]
    v_mfma_f32_16x16x32_bf16 v[164:167], v[80:83], v[32:35], v[164:167]
A_CQD:
    s_nop 7
    s_mul_i32 s35, s22, 2048
    s_add_u32 s35, s35, 66304
    v_lshlrev_b32 v2, 4, v1
    v_add_u32 v3, s35, v2
    s_cmp_eq_u32 s42, 1
    s_cbranch_scc0 A_CG2RT1
    v_swap_b32 v8, v16
    v_swap_b32 v9, v17
    v_swap_b32 v10, v18
    v_swap_b32 v11, v19
    v_swap_b32 v12, v20
    v_swap_b32 v13, v21
    v_swap_b32 v14, v22
    v_swap_b32 v15, v23
A_CG2RT1:
    ds_write_b128 v3, v[16:19] offset:0
    ds_write_b128 v3, v[20:23] offset:1024
    s_lshl_b32 s35, s22, 11
    s_add_u32 s35, s35, 82688
    v_lshlrev_b32 v2, 4, v1
    v_add_u32 v3, s35, v2
    ds_write_b128 v3, v[160:163] offset:0
    ds_write_b128 v3, v[164:167] offset:1024
    s_waitcnt lgkmcnt(0)
    s_barrier
    v_lshlrev_b32 v2, 4, v1
    s_add_u32 s36, s42, 1
    s_and_b32 s36, s36, 1
    s_andn2_b32 s37, s22, 1
    s_add_u32 s36, s36, s37
    s_mul_i32 s36, s36, 2048
    s_add_u32 s36, s36, 66304
    v_add_u32 v4, s36, v2
    ds_read_b128 v[48:51], v4 offset:0
    ds_read_b128 v[52:55], v4 offset:1024
    s_mul_i32 s36, s42, 2
    s_add_u32 s36, s36, 0
    s_lshl_b32 s36, s36, 2
    s_mov_b32 s37, 0x7430
    s_mov_b32 s39, 0x6521
    s_cmp_eq_u32 s41, 0
    s_cselect_b32 s37, s37, s39
    s_lshr_b32 s37, s37, s36
    s_and_b32 s44, s37, 15
    s_sub_u32 s36, 7, s44
    s_lshl_b32 s36, s36, 9
    v_add_u32 v5, s36, v26
    ds_read_b64 v[72:73], v5
    s_mul_i32 s36, s42, 2
    s_add_u32 s36, s36, 1
    s_lshl_b32 s36, s36, 2
    s_mov_b32 s37, 0x7430
    s_mov_b32 s39, 0x6521
    s_cmp_eq_u32 s41, 0
    s_cselect_b32 s37, s37, s39
    s_lshr_b32 s37, s37, s36
    s_and_b32 s45, s37, 15
    s_sub_u32 s36, 7, s45
    s_lshl_b32 s36, s36, 9
    v_add_u32 v5, s36, v26
    ds_read_b64 v[74:75], v5
    s_cmp_ge_u32 s22, 2
    s_cbranch_scc1 A_CNQR
    s_lshl_b32 s35, s22, 10
    s_add_u32 s35, s35, 82688
    v_lshlrev_b32 v2, 4, v1
    v_add_u32 v4, s35, v2
    ds_read_b128 v[96:99], v4 offset:0
    ds_read_b128 v[100:103], v4 offset:2048
    ds_read_b128 v[104:107], v4 offset:4096
    ds_read_b128 v[108:111], v4 offset:6144
    ds_read_b128 v[112:115], v4 offset:8192
    ds_read_b128 v[116:119], v4 offset:10240
    ds_read_b128 v[120:123], v4 offset:12288
    ds_read_b128 v[124:127], v4 offset:14336
    s_sub_u32 s36, 7, s48
    s_cmp_eq_u32 s22, 0
    s_cselect_b32 s50, s48, s36
    s_sub_u32 s36, 7, s50
    s_lshl_b32 s36, s36, 9
    v_add_u32 v5, s36, v178
    ds_read_b64 v[128:129], v5
A_CNQR:
    s_waitcnt vmcnt(0) lgkmcnt(0)
    v_lshlrev_b32 v29, 16, v29
    v_add_f32 v8, v8, v48
    v_add_f32 v9, v9, v49
    v_add_f32 v10, v10, v50
    v_add_f32 v11, v11, v51
    v_add_f32 v12, v12, v52
    v_add_f32 v13, v13, v53
    v_add_f32 v14, v14, v54
    v_add_f32 v15, v15, v55
    v_and_b32 v76, 0xffff0000, v73
    v_lshlrev_b32 v77, 16, v73
    v_and_b32 v78, 0xffff0000, v72
    v_lshlrev_b32 v79, 16, v72
    v_fmac_f32 v8, v76, v29
    v_fmac_f32 v9, v77, v29
    v_fmac_f32 v10, v78, v29
    v_fmac_f32 v11, v79, v29
    v_cvt_pk_bf16_f32 v80, v8, v9
    v_cvt_pk_bf16_f32 v81, v10, v11
    s_lshl_b32 s36, s43, 12
    s_lshl_b32 s37, s44, 9
    s_add_u32 s36, s36, s37
    s_add_u32 s36, s36, 5718016
    buffer_store_dwordx2 v[80:81], v27, s[12:15], s36 offen sc1
    v_and_b32 v76, 0xffff0000, v75
    v_lshlrev_b32 v77, 16, v75
    v_and_b32 v78, 0xffff0000, v74
    v_lshlrev_b32 v79, 16, v74
    v_fmac_f32 v12, v76, v29
    v_fmac_f32 v13, v77, v29
    v_fmac_f32 v14, v78, v29
    v_fmac_f32 v15, v79, v29
    v_cvt_pk_bf16_f32 v82, v12, v13
    v_cvt_pk_bf16_f32 v83, v14, v15
    s_lshl_b32 s36, s43, 12
    s_lshl_b32 s37, s45, 9
    s_add_u32 s36, s36, s37
    s_add_u32 s36, s36, 5718016
    buffer_store_dwordx2 v[82:83], v27, s[12:15], s36 offen sc1
    s_cmp_ge_u32 s22, 2
    s_cbranch_scc1 A_CNQF
    v_lshlrev_b32 v30, 16, v30
    v_add_f32 v96, v96, v100
    v_add_f32 v97, v97, v101
    v_add_f32 v98, v98, v102
    v_add_f32 v99, v99, v103
    v_add_f32 v96, v96, v104
    v_add_f32 v97, v97, v105
    v_add_f32 v98, v98, v106
    v_add_f32 v99, v99, v107
    v_add_f32 v96, v96, v108
    v_add_f32 v97, v97, v109
    v_add_f32 v98, v98, v110
    v_add_f32 v99, v99, v111
    v_add_f32 v96, v96, v112
    v_add_f32 v97, v97, v113
    v_add_f32 v98, v98, v114
    v_add_f32 v99, v99, v115
    v_add_f32 v96, v96, v116
    v_add_f32 v97, v97, v117
    v_add_f32 v98, v98, v118
    v_add_f32 v99, v99, v119
    v_add_f32 v96, v96, v120
    v_add_f32 v97, v97, v121
    v_add_f32 v98, v98, v122
    v_add_f32 v99, v99, v123
    v_add_f32 v96, v96, v124
    v_add_f32 v97, v97, v125
    v_add_f32 v98, v98, v126
    v_add_f32 v99, v99, v127
    v_and_b32 v76, 0xffff0000, v129
    v_lshlrev_b32 v77, 16, v129
    v_and_b32 v78, 0xffff0000, v128
    v_lshlrev_b32 v79, 16, v128
    v_fmac_f32 v96, v76, v30
    v_fmac_f32 v97, v77, v30
    v_fmac_f32 v98, v78, v30
    v_fmac_f32 v99, v79, v30
    v_cvt_pk_bf16_f32 v132, v96, v97
    v_cvt_pk_bf16_f32 v133, v98, v99
    s_lshl_b32 s36, s49, 12
    s_lshl_b32 s37, s50, 9
    s_add_u32 s36, s36, s37
    s_add_u32 s36, s36, 5718016
    buffer_store_dwordx2 v[132:133], v179, s[12:15], s36 offen sc1
A_CNQF:
    s_cmp_ge_u32 s22, 3
    s_cbranch_scc1 A_CNWO1
    s_cmp_ge_u32 s2, 216
    s_cbranch_scc1 A_CNWO1
    v_lshlrev_b32 v208, 4, v1
    v_lshl_or_b32 v212, v201, 16, v200
    v_lshl_or_b32 v213, v203, 16, v202
    v_lshl_or_b32 v214, v205, 16, v204
    v_lshl_or_b32 v215, v207, 16, v206
    buffer_store_dwordx4 v[212:215], v208, s[12:15], s59 offen sc1
A_CNWO1:
M_ATT:
    s_and_b32 s20, s2, 7
    s_lshr_b32 s21, s2, 3
    s_lshl_b32 s20, s20, 2
    s_and_b32 s23, s21, 3
    s_add_u32 s20, s20, s23
    s_lshr_b32 s21, s21, 2
    v_and_b32 v1, 63, v0
    v_lshlrev_b32 v6, 4, v1
    v_and_b32 v7, 31, v1
    v_lshrrev_b32 v5, 5, v1
    s_and_b32 s23, s22, 3
    s_lshr_b32 s24, s22, 2
    s_lshl_b32 s25, s21, 3
    s_lshl_b32 s26, s23, 1
    s_add_u32 s25, s25, s26
    s_mul_i32 s27, s20, 155648
    s_lshl_b32 s28, s22, 10
    s_add_u32 s27, s27, s28
    s_add_u32 s27, s27, 12795904
    s_add_u32 s27, s27, s62
    s_lshl_b32 s31, s20, 16
    s_lshl_b32 s32, s25, 10
    s_add_u32 s31, s31, s32
    s_add_u32 s31, s31, 8077312
    s_add_u32 s31, s31, s63
    s_lshl_b32 s33, s20, 13
    s_lshl_b32 s32, s25, 7
    s_add_u32 s33, s33, s32
    s_add_u32 s33, s33, 12271616
    s_add_u32 s33, s33, s64
    v_lshlrev_b32 v160, 2, v7
    s_cmp_lg_u32 s22, 0
    s_cbranch_scc1 M_F1W
    s_lshr_b32 s36, s20, 1
    s_lshl_b32 s36, s36, 13
    s_lshl_b32 s35, s61, 17
    s_add_u32 s36, s36, s35
    s_add_u32 s36, s36, 30392320
    v_lshlrev_b32 v170, 7, v1
    s_mov_b32 s58, 0
M_F1:
    buffer_load_dword v171, v170, s[12:15], s36 offen sc1
    s_waitcnt vmcnt(0)
    v_cmp_eq_u32 vcc, s60, v171
    s_nop 1
    s_cmp_eq_u64 vcc, -1
    s_cbranch_scc1 M_F1_OK
    s_sleep 2
    s_add_u32 s58, s58, 1
    s_cmp_lt_u32 s58, 131072
    s_cbranch_scc1 M_F1
M_F1_OK:
M_F1W:
    s_waitcnt lgkmcnt(0)
    s_barrier
    s_mov_b32 m0, s28
    s_add_u32 s30, s27, 77824
    buffer_load_dwordx4 v6, s[12:15], s27 offen sc1 lds
    s_add_u32 m0, s28, 77824
    s_add_u32 s27, s27, 8192
    buffer_load_dwordx4 v6, s[12:15], s30 offen sc1 lds
    s_add_u32 s28, s28, 8192
    buffer_load_dwordx4 v[8:11], v6, s[12:15], s31 offen sc1
    buffer_load_dwordx4 v[16:19], v6, s[12:15], s31 offen offset:1024 sc1
    v_lshl_add_u32 v163, v5, 7, v160
    buffer_load_dword v12, v163, s[12:15], s33 offen sc1
    s_mov_b32 m0, s28
    s_add_u32 s30, s27, 77824
    buffer_load_dwordx4 v6, s[12:15], s27 offen sc1 lds
    s_add_u32 m0, s28, 77824
    s_add_u32 s27, s27, 8192
    buffer_load_dwordx4 v6, s[12:15], s30 offen sc1 lds
    s_add_u32 s28, s28, 8192
    s_mov_b32 m0, s28
    s_add_u32 s30, s27, 77824
    buffer_load_dwordx4 v6, s[12:15], s27 offen sc1 lds
    s_add_u32 m0, s28, 77824
    s_add_u32 s27, s27, 8192
    buffer_load_dwordx4 v6, s[12:15], s30 offen sc1 lds
    s_add_u32 s28, s28, 8192
    s_mul_i32 s34, s24, 77824
    s_add_u32 s35, s34, 1024
    v_add_u32 v2, s35, v6
    v_add_u32 v3, s34, v160
    v_mul_u32_u24 v161, 320, v5
    v_min_u32 v162, 19, v7
    v_lshl_add_u32 v161, v162, 4, v161
    s_add_u32 s35, s34, 2048
    v_add_u32 v4, s35, v161
    v_mov_b32 v29, 0x3f803f80
    v_mov_b32 v31, 0x3f803f80
    v_mov_b32 v13, 0
    v_mov_b32 v64, 0
    v_mov_b32 v80, 0
    v_mov_b32 v65, 0
    v_mov_b32 v81, 0
    v_mov_b32 v66, 0
    v_mov_b32 v82, 0
    v_mov_b32 v67, 0
    v_mov_b32 v83, 0
    v_mov_b32 v68, 0
    v_mov_b32 v84, 0
    v_mov_b32 v69, 0
    v_mov_b32 v85, 0
    v_mov_b32 v70, 0
    v_mov_b32 v86, 0
    v_mov_b32 v71, 0
    v_mov_b32 v87, 0
    v_mov_b32 v72, 0
    v_mov_b32 v88, 0
    v_mov_b32 v73, 0
    v_mov_b32 v89, 0
    v_mov_b32 v74, 0
    v_mov_b32 v90, 0
    v_mov_b32 v75, 0
    v_mov_b32 v91, 0
    v_mov_b32 v76, 0
    v_mov_b32 v92, 0
    v_mov_b32 v77, 0
    v_mov_b32 v93, 0
    v_mov_b32 v78, 0
    v_mov_b32 v94, 0
    v_mov_b32 v79, 0
    v_mov_b32 v95, 0
    v_mov_b32 v52, 0
    v_mov_b32 v60, 0
    v_mov_b32 v44, 0
    v_mov_b32 v156, 0
    v_mov_b32 v53, 0
    v_mov_b32 v61, 0
    v_mov_b32 v45, 0
    v_mov_b32 v157, 0
    v_mov_b32 v54, 0
    v_mov_b32 v62, 0
    v_mov_b32 v46, 0
    v_mov_b32 v158, 0
    v_mov_b32 v55, 0
    v_mov_b32 v63, 0
    v_mov_b32 v47, 0
    v_mov_b32 v159, 0
    s_cmp_eq_u32 s24, 0
    s_cbranch_scc1 AT_PR0
    s_setprio 1
    s_mov_b32 s51, 99
    s_branch AT_PR1
AT_PR0:
    s_setprio 2
    s_mov_b32 s51, 3
AT_PR1:
    s_waitcnt vmcnt(4)
    s_barrier
    s_cmp_lg_u32 s61, 0
    s_cbranch_scc1 M_NFY
    s_cmp_lg_u32 s22, 0
    s_cbranch_scc1 M_NFY
    s_lshl_b32 s36, s2, 2
    s_add_u32 s36, s36, 31212544
    v_mov_b32 v170, s60
    v_mov_b32 v171, 0
    s_mov_b64 exec, 1
    buffer_store_dword v170, v171, s[12:15], s36 offen sc1
    s_mov_b64 exec, -1
M_NFY:
    ds_read_b128 v[20:23], v2
    ds_read_b32 v28, v3
    s_waitcnt lgkmcnt(0)
    ds_read_b128 v[24:27], v2 offset:2304
    ds_read_b32 v30, v3 offset:128
    ds_read_b128 v[32:35], v4
    v_mfma_f32_32x32x4_2b_bf16 v[96:127], v[28:29], v[12:13], 0
    s_nop 15
    s_nop 3
    v_mfma_f32_32x32x16_bf16 v[96:111], v[20:23], v[8:11], v[96:111]
    v_mfma_f32_32x32x16_bf16 v[112:127], v[20:23], v[16:19], v[112:127]
    s_mov_b32 s41, 0
    s_nop 15
    s_waitcnt lgkmcnt(0)
    ds_read_b128 v[20:23], v2 offset:4608
    ds_read_b32 v28, v3 offset:256
    ds_read_b128 v[36:39], v4 offset:2304
    ds_read_b128 v[40:43], v4 offset:640
    v_cvt_pk_bf16_f32 v62, v156, v157
    v_cvt_pk_bf16_f32 v63, v158, v159
    v_mfma_f32_32x32x4_2b_bf16 v[128:159], v[30:31], v[12:13], 0
    v_exp_f32 v96, v96
    v_exp_f32 v97, v97
    v_exp_f32 v98, v98
    v_exp_f32 v99, v99
    v_exp_f32 v100, v100
    v_exp_f32 v101, v101
    v_exp_f32 v102, v102
    v_exp_f32 v103, v103
    v_cvt_pk_bf16_f32 v48, v96, v97
    v_cvt_pk_bf16_f32 v49, v98, v99
    v_mfma_f32_32x32x16_bf16 v[64:79], v[44:47], v[52:55], v[64:79]
    v_cvt_pk_bf16_f32 v50, v100, v101
    v_cvt_pk_bf16_f32 v51, v102, v103
    v_exp_f32 v104, v104
    v_exp_f32 v105, v105
    v_exp_f32 v106, v106
    v_exp_f32 v107, v107
    v_mfma_f32_32x32x16_bf16 v[80:95], v[44:47], v[60:63], v[80:95]
    v_cvt_pk_bf16_f32 v52, v104, v105
    v_cvt_pk_bf16_f32 v53, v106, v107
    v_exp_f32 v108, v108
    v_exp_f32 v109, v109
    v_exp_f32 v110, v110
    v_exp_f32 v111, v111
    v_mfma_f32_32x32x16_bf16 v[128:143], v[24:27], v[8:11], v[128:143]
    v_cvt_pk_bf16_f32 v54, v108, v109
    v_cvt_pk_bf16_f32 v55, v110, v111
    v_exp_f32 v112, v112
    v_exp_f32 v113, v113
    v_exp_f32 v114, v114
    v_exp_f32 v115, v115
    v_mfma_f32_32x32x16_bf16 v[64:79], v[32:35], v[48:51], v[64:79]
    v_cvt_pk_bf16_f32 v56, v112, v113
    v_cvt_pk_bf16_f32 v57, v114, v115
    v_exp_f32 v116, v116
    v_exp_f32 v117, v117
    v_exp_f32 v118, v118
    v_exp_f32 v119, v119
    v_mfma_f32_32x32x16_bf16 v[144:159], v[24:27], v[16:19], v[144:159]
    v_cvt_pk_bf16_f32 v58, v116, v117
    v_cvt_pk_bf16_f32 v59, v118, v119
    v_exp_f32 v120, v120
    v_exp_f32 v121, v121
    v_exp_f32 v122, v122
    v_exp_f32 v123, v123
    v_mfma_f32_32x32x16_bf16 v[80:95], v[32:35], v[56:59], v[80:95]
    v_cvt_pk_bf16_f32 v60, v120, v121
    v_cvt_pk_bf16_f32 v61, v122, v123
    v_exp_f32 v124, v124
    v_exp_f32 v125, v125
    v_exp_f32 v126, v126
    v_exp_f32 v127, v127
    s_waitcnt vmcnt(0)
    s_barrier
    s_waitcnt lgkmcnt(0)
    ds_read_b128 v[24:27], v2 offset:6912
    ds_read_b32 v30, v3 offset:384
    ds_read_b128 v[32:35], v4 offset:4608
    ds_read_b128 v[44:47], v4 offset:2944
    s_mov_b32 m0, s28
    s_add_u32 s30, s27, 77824
    buffer_load_dwordx4 v6, s[12:15], s27 offen sc1 lds
    s_add_u32 m0, s28, 77824
    s_add_u32 s27, s27, 8192
    buffer_load_dwordx4 v6, s[12:15], s30 offen sc1 lds
    s_add_u32 s28, s28, 8192
    v_cvt_pk_bf16_f32 v62, v124, v125
    v_cvt_pk_bf16_f32 v63, v126, v127
    v_mfma_f32_32x32x4_2b_bf16 v[96:127], v[28:29], v[12:13], 0
    v_exp_f32 v128, v128
    v_exp_f32 v129, v129
    v_exp_f32 v130, v130
    v_exp_f32 v131, v131
    v_exp_f32 v132, v132
    v_exp_f32 v133, v133
    v_exp_f32 v134, v134
    v_exp_f32 v135, v135
    v_cvt_pk_bf16_f32 v48, v128, v129
    v_cvt_pk_bf16_f32 v49, v130, v131
    v_mfma_f32_32x32x16_bf16 v[64:79], v[40:43], v[52:55], v[64:79]
    v_cvt_pk_bf16_f32 v50, v132, v133
    v_cvt_pk_bf16_f32 v51, v134, v135
    v_exp_f32 v136, v136
    v_exp_f32 v137, v137
    v_exp_f32 v138, v138
    v_exp_f32 v139, v139
    v_mfma_f32_32x32x16_bf16 v[80:95], v[40:43], v[60:63], v[80:95]
    v_cvt_pk_bf16_f32 v52, v136, v137
    v_cvt_pk_bf16_f32 v53, v138, v139
    v_exp_f32 v140, v140
    v_exp_f32 v141, v141
    v_exp_f32 v142, v142
    v_exp_f32 v143, v143
    v_mfma_f32_32x32x16_bf16 v[96:111], v[20:23], v[8:11], v[96:111]
    v_cvt_pk_bf16_f32 v54, v140, v141
    v_cvt_pk_bf16_f32 v55, v142, v143
    v_exp_f32 v144, v144
    v_exp_f32 v145, v145
    v_exp_f32 v146, v146
    v_exp_f32 v147, v147
    v_mfma_f32_32x32x16_bf16 v[64:79], v[36:39], v[48:51], v[64:79]
    v_cvt_pk_bf16_f32 v56, v144, v145
    v_cvt_pk_bf16_f32 v57, v146, v147
    v_exp_f32 v148, v148
    v_exp_f32 v149, v149
    v_exp_f32 v150, v150
    v_exp_f32 v151, v151
    v_mfma_f32_32x32x16_bf16 v[112:127], v[20:23], v[16:19], v[112:127]
    v_cvt_pk_bf16_f32 v58, v148, v149
    v_cvt_pk_bf16_f32 v59, v150, v151
    v_exp_f32 v152, v152
    v_exp_f32 v153, v153
    v_exp_f32 v154, v154
    v_exp_f32 v155, v155
    v_mfma_f32_32x32x16_bf16 v[80:95], v[36:39], v[56:59], v[80:95]
    v_cvt_pk_bf16_f32 v60, v152, v153
    v_cvt_pk_bf16_f32 v61, v154, v155
    v_exp_f32 v156, v156
    v_exp_f32 v157, v157
    v_exp_f32 v158, v158
    v_exp_f32 v159, v159
    s_waitcnt lgkmcnt(0)
    ds_read_b128 v[20:23], v2 offset:9216
    ds_read_b32 v28, v3 offset:512
    ds_read_b128 v[36:39], v4 offset:6912
    ds_read_b128 v[40:43], v4 offset:5248
    s_mov_b32 m0, s28
    s_add_u32 s30, s27, 77824
    buffer_load_dwordx4 v6, s[12:15], s27 offen sc1 lds
    s_add_u32 m0, s28, 77824
    s_add_u32 s27, s27, 8192
    buffer_load_dwordx4 v6, s[12:15], s30 offen sc1 lds
    s_add_u32 s28, s28, 8192
    v_cvt_pk_bf16_f32 v62, v156, v157
    v_cvt_pk_bf16_f32 v63, v158, v159
    v_mfma_f32_32x32x4_2b_bf16 v[128:159], v[30:31], v[12:13], 0
    v_exp_f32 v96, v96
    v_exp_f32 v97, v97
    v_exp_f32 v98, v98
    v_exp_f32 v99, v99
    v_exp_f32 v100, v100
    v_exp_f32 v101, v101
    v_exp_f32 v102, v102
    v_exp_f32 v103, v103
    v_cvt_pk_bf16_f32 v48, v96, v97
    v_cvt_pk_bf16_f32 v49, v98, v99
    v_mfma_f32_32x32x16_bf16 v[64:79], v[44:47], v[52:55], v[64:79]
    v_cvt_pk_bf16_f32 v50, v100, v101
    v_cvt_pk_bf16_f32 v51, v102, v103
    v_exp_f32 v104, v104
    v_exp_f32 v105, v105
    v_exp_f32 v106, v106
    v_exp_f32 v107, v107
    v_mfma_f32_32x32x16_bf16 v[80:95], v[44:47], v[60:63], v[80:95]
    v_cvt_pk_bf16_f32 v52, v104, v105
    v_cvt_pk_bf16_f32 v53, v106, v107
    v_exp_f32 v108, v108
    v_exp_f32 v109, v109
    v_exp_f32 v110, v110
    v_exp_f32 v111, v111
    v_mfma_f32_32x32x16_bf16 v[128:143], v[24:27], v[8:11], v[128:143]
    v_cvt_pk_bf16_f32 v54, v108, v109
    v_cvt_pk_bf16_f32 v55, v110, v111
    v_exp_f32 v112, v112
    v_exp_f32 v113, v113
    v_exp_f32 v114, v114
    v_exp_f32 v115, v115
    v_mfma_f32_32x32x16_bf16 v[64:79], v[32:35], v[48:51], v[64:79]
    v_cvt_pk_bf16_f32 v56, v112, v113
    v_cvt_pk_bf16_f32 v57, v114, v115
    v_exp_f32 v116, v116
    v_exp_f32 v117, v117
    v_exp_f32 v118, v118
    v_exp_f32 v119, v119
    v_mfma_f32_32x32x16_bf16 v[144:159], v[24:27], v[16:19], v[144:159]
    v_cvt_pk_bf16_f32 v58, v116, v117
    v_cvt_pk_bf16_f32 v59, v118, v119
    v_exp_f32 v120, v120
    v_exp_f32 v121, v121
    v_exp_f32 v122, v122
    v_exp_f32 v123, v123
    v_mfma_f32_32x32x16_bf16 v[80:95], v[32:35], v[56:59], v[80:95]
    v_cvt_pk_bf16_f32 v60, v120, v121
    v_cvt_pk_bf16_f32 v61, v122, v123
    v_exp_f32 v124, v124
    v_exp_f32 v125, v125
    v_exp_f32 v126, v126
    v_exp_f32 v127, v127
    s_waitcnt lgkmcnt(0)
    ds_read_b128 v[24:27], v2 offset:11520
    ds_read_b32 v30, v3 offset:640
    ds_read_b128 v[32:35], v4 offset:9216
    ds_read_b128 v[44:47], v4 offset:7552
    s_mov_b32 m0, s28
    s_add_u32 s30, s27, 77824
    buffer_load_dwordx4 v6, s[12:15], s27 offen sc1 lds
    s_add_u32 m0, s28, 77824
    s_add_u32 s27, s27, 8192
    buffer_load_dwordx4 v6, s[12:15], s30 offen sc1 lds
    s_add_u32 s28, s28, 8192
    v_cvt_pk_bf16_f32 v62, v124, v125
    v_cvt_pk_bf16_f32 v63, v126, v127
    v_mfma_f32_32x32x4_2b_bf16 v[96:127], v[28:29], v[12:13], 0
    v_exp_f32 v128, v128
    v_exp_f32 v129, v129
    v_exp_f32 v130, v130
    v_exp_f32 v131, v131
    v_exp_f32 v132, v132
    v_exp_f32 v133, v133
    v_exp_f32 v134, v134
    v_exp_f32 v135, v135
    v_cvt_pk_bf16_f32 v48, v128, v129
    v_cvt_pk_bf16_f32 v49, v130, v131
    v_mfma_f32_32x32x16_bf16 v[64:79], v[40:43], v[52:55], v[64:79]
    v_cvt_pk_bf16_f32 v50, v132, v133
    v_cvt_pk_bf16_f32 v51, v134, v135
    v_exp_f32 v136, v136
    v_exp_f32 v137, v137
    v_exp_f32 v138, v138
    v_exp_f32 v139, v139
    v_mfma_f32_32x32x16_bf16 v[80:95], v[40:43], v[60:63], v[80:95]
    v_cvt_pk_bf16_f32 v52, v136, v137
    v_cvt_pk_bf16_f32 v53, v138, v139
    v_exp_f32 v140, v140
    v_exp_f32 v141, v141
    v_exp_f32 v142, v142
    v_exp_f32 v143, v143
    v_mfma_f32_32x32x16_bf16 v[96:111], v[20:23], v[8:11], v[96:111]
    v_cvt_pk_bf16_f32 v54, v140, v141
    v_cvt_pk_bf16_f32 v55, v142, v143
    v_exp_f32 v144, v144
    v_exp_f32 v145, v145
    v_exp_f32 v146, v146
    v_exp_f32 v147, v147
    v_mfma_f32_32x32x16_bf16 v[64:79], v[36:39], v[48:51], v[64:79]
    v_cvt_pk_bf16_f32 v56, v144, v145
    v_cvt_pk_bf16_f32 v57, v146, v147
    v_exp_f32 v148, v148
    v_exp_f32 v149, v149
    v_exp_f32 v150, v150
    v_exp_f32 v151, v151
    v_mfma_f32_32x32x16_bf16 v[112:127], v[20:23], v[16:19], v[112:127]
    v_cvt_pk_bf16_f32 v58, v148, v149
    v_cvt_pk_bf16_f32 v59, v150, v151
    v_exp_f32 v152, v152
    v_exp_f32 v153, v153
    v_exp_f32 v154, v154
    v_exp_f32 v155, v155
    v_mfma_f32_32x32x16_bf16 v[80:95], v[36:39], v[56:59], v[80:95]
    v_cvt_pk_bf16_f32 v60, v152, v153
    v_cvt_pk_bf16_f32 v61, v154, v155
    v_exp_f32 v156, v156
    v_exp_f32 v157, v157
    v_exp_f32 v158, v158
    v_exp_f32 v159, v159
    s_waitcnt lgkmcnt(0)
    ds_read_b128 v[20:23], v2 offset:13824
    ds_read_b32 v28, v3 offset:768
    ds_read_b128 v[36:39], v4 offset:11520
    ds_read_b128 v[40:43], v4 offset:9856
    s_mov_b32 m0, s28
    s_add_u32 s30, s27, 77824
    buffer_load_dwordx4 v6, s[12:15], s27 offen sc1 lds
    s_add_u32 m0, s28, 77824
    s_add_u32 s27, s27, 8192
    buffer_load_dwordx4 v6, s[12:15], s30 offen sc1 lds
    s_add_u32 s28, s28, 8192
    v_cvt_pk_bf16_f32 v62, v156, v157
    v_cvt_pk_bf16_f32 v63, v158, v159
    v_mfma_f32_32x32x4_2b_bf16 v[128:159], v[30:31], v[12:13], 0
    v_exp_f32 v96, v96
    v_exp_f32 v97, v97
    v_exp_f32 v98, v98
    v_exp_f32 v99, v99
    v_exp_f32 v100, v100
    v_exp_f32 v101, v101
    v_exp_f32 v102, v102
    v_exp_f32 v103, v103
    v_cvt_pk_bf16_f32 v48, v96, v97
    v_cvt_pk_bf16_f32 v49, v98, v99
    v_mfma_f32_32x32x16_bf16 v[64:79], v[44:47], v[52:55], v[64:79]
    v_cvt_pk_bf16_f32 v50, v100, v101
    v_cvt_pk_bf16_f32 v51, v102, v103
    v_exp_f32 v104, v104
    v_exp_f32 v105, v105
    v_exp_f32 v106, v106
    v_exp_f32 v107, v107
    v_mfma_f32_32x32x16_bf16 v[80:95], v[44:47], v[60:63], v[80:95]
    v_cvt_pk_bf16_f32 v52, v104, v105
    v_cvt_pk_bf16_f32 v53, v106, v107
    v_exp_f32 v108, v108
    v_exp_f32 v109, v109
    v_exp_f32 v110, v110
    v_exp_f32 v111, v111
    v_mfma_f32_32x32x16_bf16 v[128:143], v[24:27], v[8:11], v[128:143]
    v_cvt_pk_bf16_f32 v54, v108, v109
    v_cvt_pk_bf16_f32 v55, v110, v111
    v_exp_f32 v112, v112
    v_exp_f32 v113, v113
    v_exp_f32 v114, v114
    v_exp_f32 v115, v115
    v_mfma_f32_32x32x16_bf16 v[64:79], v[32:35], v[48:51], v[64:79]
    v_cvt_pk_bf16_f32 v56, v112, v113
    v_cvt_pk_bf16_f32 v57, v114, v115
    v_exp_f32 v116, v116
    v_exp_f32 v117, v117
    v_exp_f32 v118, v118
    v_exp_f32 v119, v119
    v_mfma_f32_32x32x16_bf16 v[144:159], v[24:27], v[16:19], v[144:159]
    v_cvt_pk_bf16_f32 v58, v116, v117
    v_cvt_pk_bf16_f32 v59, v118, v119
    v_exp_f32 v120, v120
    v_exp_f32 v121, v121
    v_exp_f32 v122, v122
    v_exp_f32 v123, v123
    v_mfma_f32_32x32x16_bf16 v[80:95], v[32:35], v[56:59], v[80:95]
    v_cvt_pk_bf16_f32 v60, v120, v121
    v_cvt_pk_bf16_f32 v61, v122, v123
    v_exp_f32 v124, v124
    v_exp_f32 v125, v125
    v_exp_f32 v126, v126
    v_exp_f32 v127, v127
    s_waitcnt lgkmcnt(0)
    ds_read_b128 v[24:27], v2 offset:16128
    ds_read_b32 v30, v3 offset:896
    ds_read_b128 v[32:35], v4 offset:13824
    ds_read_b128 v[44:47], v4 offset:12160
    s_mov_b32 m0, s28
    s_add_u32 s30, s27, 77824
    buffer_load_dwordx4 v6, s[12:15], s27 offen sc1 lds
    s_add_u32 m0, s28, 77824
    s_add_u32 s27, s27, 8192
    buffer_load_dwordx4 v6, s[12:15], s30 offen sc1 lds
    s_add_u32 s28, s28, 8192
    v_cvt_pk_bf16_f32 v62, v124, v125
    v_cvt_pk_bf16_f32 v63, v126, v127
    v_mfma_f32_32x32x4_2b_bf16 v[96:127], v[28:29], v[12:13], 0
    v_exp_f32 v128, v128
    v_exp_f32 v129, v129
    v_exp_f32 v130, v130
    v_exp_f32 v131, v131
    v_exp_f32 v132, v132
    v_exp_f32 v133, v133
    v_exp_f32 v134, v134
    v_exp_f32 v135, v135
    v_cvt_pk_bf16_f32 v48, v128, v129
    v_cvt_pk_bf16_f32 v49, v130, v131
    v_mfma_f32_32x32x16_bf16 v[64:79], v[40:43], v[52:55], v[64:79]
    v_cvt_pk_bf16_f32 v50, v132, v133
    v_cvt_pk_bf16_f32 v51, v134, v135
    v_exp_f32 v136, v136
    v_exp_f32 v137, v137
    v_exp_f32 v138, v138
    v_exp_f32 v139, v139
    v_mfma_f32_32x32x16_bf16 v[80:95], v[40:43], v[60:63], v[80:95]
    v_cvt_pk_bf16_f32 v52, v136, v137
    v_cvt_pk_bf16_f32 v53, v138, v139
    v_exp_f32 v140, v140
    v_exp_f32 v141, v141
    v_exp_f32 v142, v142
    v_exp_f32 v143, v143
    v_mfma_f32_32x32x16_bf16 v[96:111], v[20:23], v[8:11], v[96:111]
    v_cvt_pk_bf16_f32 v54, v140, v141
    v_cvt_pk_bf16_f32 v55, v142, v143
    v_exp_f32 v144, v144
    v_exp_f32 v145, v145
    v_exp_f32 v146, v146
    v_exp_f32 v147, v147
    v_mfma_f32_32x32x16_bf16 v[64:79], v[36:39], v[48:51], v[64:79]
    v_cvt_pk_bf16_f32 v56, v144, v145
    v_cvt_pk_bf16_f32 v57, v146, v147
    v_exp_f32 v148, v148
    v_exp_f32 v149, v149
    v_exp_f32 v150, v150
    v_exp_f32 v151, v151
    v_mfma_f32_32x32x16_bf16 v[112:127], v[20:23], v[16:19], v[112:127]
    v_cvt_pk_bf16_f32 v58, v148, v149
    v_cvt_pk_bf16_f32 v59, v150, v151
    v_exp_f32 v152, v152
    v_exp_f32 v153, v153
    v_exp_f32 v154, v154
    v_exp_f32 v155, v155
    v_mfma_f32_32x32x16_bf16 v[80:95], v[36:39], v[56:59], v[80:95]
    v_cvt_pk_bf16_f32 v60, v152, v153
    v_cvt_pk_bf16_f32 v61, v154, v155
    v_exp_f32 v156, v156
    v_exp_f32 v157, v157
    v_exp_f32 v158, v158
    v_exp_f32 v159, v159
    s_waitcnt lgkmcnt(0)
    ds_read_b128 v[20:23], v2 offset:19456
    ds_read_b32 v28, v3 offset:19456
    ds_read_b128 v[36:39], v4 offset:16128
    ds_read_b128 v[40:43], v4 offset:14464
    s_mov_b32 m0, s28
    s_add_u32 s30, s27, 77824
    buffer_load_dwordx4 v6, s[12:15], s27 offen sc1 lds
    s_add_u32 m0, s28, 77824
    s_add_u32 s27, s27, 8192
    buffer_load_dwordx4 v6, s[12:15], s30 offen sc1 lds
    s_add_u32 s28, s28, 8192
    v_cvt_pk_bf16_f32 v62, v156, v157
    v_cvt_pk_bf16_f32 v63, v158, v159
    v_mfma_f32_32x32x4_2b_bf16 v[128:159], v[30:31], v[12:13], 0
    v_exp_f32 v96, v96
    v_exp_f32 v97, v97
    v_exp_f32 v98, v98
    v_exp_f32 v99, v99
    v_exp_f32 v100, v100
    v_exp_f32 v101, v101
    v_exp_f32 v102, v102
    v_exp_f32 v103, v103
    v_cvt_pk_bf16_f32 v48, v96, v97
    v_cvt_pk_bf16_f32 v49, v98, v99
    v_mfma_f32_32x32x16_bf16 v[64:79], v[44:47], v[52:55], v[64:79]
    v_cvt_pk_bf16_f32 v50, v100, v101
    v_cvt_pk_bf16_f32 v51, v102, v103
    v_exp_f32 v104, v104
    v_exp_f32 v105, v105
    v_exp_f32 v106, v106
    v_exp_f32 v107, v107
    v_mfma_f32_32x32x16_bf16 v[80:95], v[44:47], v[60:63], v[80:95]
    v_cvt_pk_bf16_f32 v52, v104, v105
    v_cvt_pk_bf16_f32 v53, v106, v107
    v_exp_f32 v108, v108
    v_exp_f32 v109, v109
    v_exp_f32 v110, v110
    v_exp_f32 v111, v111
    v_mfma_f32_32x32x16_bf16 v[128:143], v[24:27], v[8:11], v[128:143]
    v_cvt_pk_bf16_f32 v54, v108, v109
    v_cvt_pk_bf16_f32 v55, v110, v111
    v_exp_f32 v112, v112
    v_exp_f32 v113, v113
    v_exp_f32 v114, v114
    v_exp_f32 v115, v115
    v_mfma_f32_32x32x16_bf16 v[64:79], v[32:35], v[48:51], v[64:79]
    v_cvt_pk_bf16_f32 v56, v112, v113
    v_cvt_pk_bf16_f32 v57, v114, v115
    v_exp_f32 v116, v116
    v_exp_f32 v117, v117
    v_exp_f32 v118, v118
    v_exp_f32 v119, v119
    v_mfma_f32_32x32x16_bf16 v[144:159], v[24:27], v[16:19], v[144:159]
    v_cvt_pk_bf16_f32 v58, v116, v117
    v_cvt_pk_bf16_f32 v59, v118, v119
    v_exp_f32 v120, v120
    v_exp_f32 v121, v121
    v_exp_f32 v122, v122
    v_exp_f32 v123, v123
    v_mfma_f32_32x32x16_bf16 v[80:95], v[32:35], v[56:59], v[80:95]
    v_cvt_pk_bf16_f32 v60, v120, v121
    v_cvt_pk_bf16_f32 v61, v122, v123
    v_exp_f32 v124, v124
    v_exp_f32 v125, v125
    v_exp_f32 v126, v126
    v_exp_f32 v127, v127
    s_waitcnt lgkmcnt(0)
    ds_read_b128 v[24:27], v2 offset:21760
    ds_read_b32 v30, v3 offset:19584
    ds_read_b128 v[32:35], v4 offset:19456
    ds_read_b128 v[44:47], v4 offset:16768
    s_mov_b32 m0, s28
    s_add_u32 s30, s27, 77824
    buffer_load_dwordx4 v6, s[12:15], s27 offen sc1 lds
    s_add_u32 m0, s28, 77824
    s_add_u32 s27, s27, 8192
    buffer_load_dwordx4 v6, s[12:15], s30 offen sc1 lds
    s_add_u32 s28, s28, 8192
    v_cvt_pk_bf16_f32 v62, v124, v125
    v_cvt_pk_bf16_f32 v63, v126, v127
    v_mfma_f32_32x32x4_2b_bf16 v[96:127], v[28:29], v[12:13], 0
    v_exp_f32 v128, v128
    v_exp_f32 v129, v129
    v_exp_f32 v130, v130
    v_exp_f32 v131, v131
    v_exp_f32 v132, v132
    v_exp_f32 v133, v133
    v_exp_f32 v134, v134
    v_exp_f32 v135, v135
    v_cvt_pk_bf16_f32 v48, v128, v129
    v_cvt_pk_bf16_f32 v49, v130, v131
    v_mfma_f32_32x32x16_bf16 v[64:79], v[40:43], v[52:55], v[64:79]
    v_cvt_pk_bf16_f32 v50, v132, v133
    v_cvt_pk_bf16_f32 v51, v134, v135
    v_exp_f32 v136, v136
    v_exp_f32 v137, v137
    v_exp_f32 v138, v138
    v_exp_f32 v139, v139
    v_mfma_f32_32x32x16_bf16 v[80:95], v[40:43], v[60:63], v[80:95]
    v_cvt_pk_bf16_f32 v52, v136, v137
    v_cvt_pk_bf16_f32 v53, v138, v139
    v_exp_f32 v140, v140
    v_exp_f32 v141, v141
    v_exp_f32 v142, v142
    v_exp_f32 v143, v143
    v_mfma_f32_32x32x16_bf16 v[96:111], v[20:23], v[8:11], v[96:111]
    v_cvt_pk_bf16_f32 v54, v140, v141
    v_cvt_pk_bf16_f32 v55, v142, v143
    v_exp_f32 v144, v144
    v_exp_f32 v145, v145
    v_exp_f32 v146, v146
    v_exp_f32 v147, v147
    v_mfma_f32_32x32x16_bf16 v[64:79], v[36:39], v[48:51], v[64:79]
    v_cvt_pk_bf16_f32 v56, v144, v145
    v_cvt_pk_bf16_f32 v57, v146, v147
    v_exp_f32 v148, v148
    v_exp_f32 v149, v149
    v_exp_f32 v150, v150
    v_exp_f32 v151, v151
    v_mfma_f32_32x32x16_bf16 v[112:127], v[20:23], v[16:19], v[112:127]
    v_cvt_pk_bf16_f32 v58, v148, v149
    v_cvt_pk_bf16_f32 v59, v150, v151
    v_exp_f32 v152, v152
    v_exp_f32 v153, v153
    v_exp_f32 v154, v154
    v_exp_f32 v155, v155
    v_mfma_f32_32x32x16_bf16 v[80:95], v[36:39], v[56:59], v[80:95]
    v_cvt_pk_bf16_f32 v60, v152, v153
    v_cvt_pk_bf16_f32 v61, v154, v155
    v_exp_f32 v156, v156
    v_exp_f32 v157, v157
    v_exp_f32 v158, v158
    v_exp_f32 v159, v159
    v_add_u32 v2, 19456, v2
    v_add_u32 v3, 19456, v3
    v_add_u32 v4, 19456, v4
    s_mov_b32 s41, 1
    s_waitcnt vmcnt(0)
    s_barrier
AT_LOOP:
    s_waitcnt lgkmcnt(0)
    ds_read_b128 v[20:23], v2 offset:4608
    ds_read_b32 v28, v3 offset:256
    ds_read_b128 v[36:39], v4 offset:2304
    ds_read_b128 v[40:43], v4 offset:640
    v_cvt_pk_bf16_f32 v62, v156, v157
    v_cvt_pk_bf16_f32 v63, v158, v159
    v_mfma_f32_32x32x4_2b_bf16 v[128:159], v[30:31], v[12:13], 0
    v_exp_f32 v96, v96
    v_exp_f32 v97, v97
    v_exp_f32 v98, v98
    v_exp_f32 v99, v99
    v_exp_f32 v100, v100
    v_exp_f32 v101, v101
    v_exp_f32 v102, v102
    v_exp_f32 v103, v103
    v_cvt_pk_bf16_f32 v48, v96, v97
    v_cvt_pk_bf16_f32 v49, v98, v99
    v_mfma_f32_32x32x16_bf16 v[64:79], v[44:47], v[52:55], v[64:79]
    v_cvt_pk_bf16_f32 v50, v100, v101
    v_cvt_pk_bf16_f32 v51, v102, v103
    v_exp_f32 v104, v104
    v_exp_f32 v105, v105
    v_exp_f32 v106, v106
    v_exp_f32 v107, v107
    v_mfma_f32_32x32x16_bf16 v[80:95], v[44:47], v[60:63], v[80:95]
    v_cvt_pk_bf16_f32 v52, v104, v105
    v_cvt_pk_bf16_f32 v53, v106, v107
    v_exp_f32 v108, v108
    v_exp_f32 v109, v109
    v_exp_f32 v110, v110
    v_exp_f32 v111, v111
    v_mfma_f32_32x32x16_bf16 v[128:143], v[24:27], v[8:11], v[128:143]
    v_cvt_pk_bf16_f32 v54, v108, v109
    v_cvt_pk_bf16_f32 v55, v110, v111
    v_exp_f32 v112, v112
    v_exp_f32 v113, v113
    v_exp_f32 v114, v114
    v_exp_f32 v115, v115
    v_mfma_f32_32x32x16_bf16 v[64:79], v[32:35], v[48:51], v[64:79]
    v_cvt_pk_bf16_f32 v56, v112, v113
    v_cvt_pk_bf16_f32 v57, v114, v115
    v_exp_f32 v116, v116
    v_exp_f32 v117, v117
    v_exp_f32 v118, v118
    v_exp_f32 v119, v119
    v_mfma_f32_32x32x16_bf16 v[144:159], v[24:27], v[16:19], v[144:159]
    v_cvt_pk_bf16_f32 v58, v116, v117
    v_cvt_pk_bf16_f32 v59, v118, v119
    v_exp_f32 v120, v120
    v_exp_f32 v121, v121
    v_exp_f32 v122, v122
    v_exp_f32 v123, v123
    v_mfma_f32_32x32x16_bf16 v[80:95], v[32:35], v[56:59], v[80:95]
    v_cvt_pk_bf16_f32 v60, v120, v121
    v_cvt_pk_bf16_f32 v61, v122, v123
    v_exp_f32 v124, v124
    v_exp_f32 v125, v125
    v_exp_f32 v126, v126
    v_exp_f32 v127, v127
    s_waitcnt lgkmcnt(0)
    ds_read_b128 v[24:27], v2 offset:6912
    ds_read_b32 v30, v3 offset:384
    ds_read_b128 v[32:35], v4 offset:4608
    ds_read_b128 v[44:47], v4 offset:2944
    v_cvt_pk_bf16_f32 v62, v124, v125
    v_cvt_pk_bf16_f32 v63, v126, v127
    v_mfma_f32_32x32x4_2b_bf16 v[96:127], v[28:29], v[12:13], 0
    v_exp_f32 v128, v128
    v_exp_f32 v129, v129
    v_exp_f32 v130, v130
    v_exp_f32 v131, v131
    v_exp_f32 v132, v132
    v_exp_f32 v133, v133
    v_exp_f32 v134, v134
    v_exp_f32 v135, v135
    v_cvt_pk_bf16_f32 v48, v128, v129
    v_cvt_pk_bf16_f32 v49, v130, v131
    v_mfma_f32_32x32x16_bf16 v[64:79], v[40:43], v[52:55], v[64:79]
    v_cvt_pk_bf16_f32 v50, v132, v133
    v_cvt_pk_bf16_f32 v51, v134, v135
    v_exp_f32 v136, v136
    v_exp_f32 v137, v137
    v_exp_f32 v138, v138
    v_exp_f32 v139, v139
    v_mfma_f32_32x32x16_bf16 v[80:95], v[40:43], v[60:63], v[80:95]
    v_cvt_pk_bf16_f32 v52, v136, v137
    v_cvt_pk_bf16_f32 v53, v138, v139
    v_exp_f32 v140, v140
    v_exp_f32 v141, v141
    v_exp_f32 v142, v142
    v_exp_f32 v143, v143
    v_mfma_f32_32x32x16_bf16 v[96:111], v[20:23], v[8:11], v[96:111]
    v_cvt_pk_bf16_f32 v54, v140, v141
    v_cvt_pk_bf16_f32 v55, v142, v143
    v_exp_f32 v144, v144
    v_exp_f32 v145, v145
    v_exp_f32 v146, v146
    v_exp_f32 v147, v147
    v_mfma_f32_32x32x16_bf16 v[64:79], v[36:39], v[48:51], v[64:79]
    v_cvt_pk_bf16_f32 v56, v144, v145
    v_cvt_pk_bf16_f32 v57, v146, v147
    v_exp_f32 v148, v148
    v_exp_f32 v149, v149
    v_exp_f32 v150, v150
    v_exp_f32 v151, v151
    v_mfma_f32_32x32x16_bf16 v[112:127], v[20:23], v[16:19], v[112:127]
    v_cvt_pk_bf16_f32 v58, v148, v149
    v_cvt_pk_bf16_f32 v59, v150, v151
    v_exp_f32 v152, v152
    v_exp_f32 v153, v153
    v_exp_f32 v154, v154
    v_exp_f32 v155, v155
    v_mfma_f32_32x32x16_bf16 v[80:95], v[36:39], v[56:59], v[80:95]
    v_cvt_pk_bf16_f32 v60, v152, v153
    v_cvt_pk_bf16_f32 v61, v154, v155
    v_exp_f32 v156, v156
    v_exp_f32 v157, v157
    v_exp_f32 v158, v158
    v_exp_f32 v159, v159
    s_waitcnt lgkmcnt(0)
    ds_read_b128 v[20:23], v2 offset:9216
    ds_read_b32 v28, v3 offset:512
    ds_read_b128 v[36:39], v4 offset:6912
    ds_read_b128 v[40:43], v4 offset:5248
    v_cvt_pk_bf16_f32 v62, v156, v157
    v_cvt_pk_bf16_f32 v63, v158, v159
    v_mfma_f32_32x32x4_2b_bf16 v[128:159], v[30:31], v[12:13], 0
    v_exp_f32 v96, v96
    v_exp_f32 v97, v97
    v_exp_f32 v98, v98
    v_exp_f32 v99, v99
    v_exp_f32 v100, v100
    v_exp_f32 v101, v101
    v_exp_f32 v102, v102
    v_exp_f32 v103, v103
    v_cvt_pk_bf16_f32 v48, v96, v97
    v_cvt_pk_bf16_f32 v49, v98, v99
    v_mfma_f32_32x32x16_bf16 v[64:79], v[44:47], v[52:55], v[64:79]
    v_cvt_pk_bf16_f32 v50, v100, v101
    v_cvt_pk_bf16_f32 v51, v102, v103
    v_exp_f32 v104, v104
    v_exp_f32 v105, v105
    v_exp_f32 v106, v106
    v_exp_f32 v107, v107
    v_mfma_f32_32x32x16_bf16 v[80:95], v[44:47], v[60:63], v[80:95]
    v_cvt_pk_bf16_f32 v52, v104, v105
    v_cvt_pk_bf16_f32 v53, v106, v107
    v_exp_f32 v108, v108
    v_exp_f32 v109, v109
    v_exp_f32 v110, v110
    v_exp_f32 v111, v111
    v_mfma_f32_32x32x16_bf16 v[128:143], v[24:27], v[8:11], v[128:143]
    v_cvt_pk_bf16_f32 v54, v108, v109
    v_cvt_pk_bf16_f32 v55, v110, v111
    v_exp_f32 v112, v112
    v_exp_f32 v113, v113
    v_exp_f32 v114, v114
    v_exp_f32 v115, v115
    v_mfma_f32_32x32x16_bf16 v[64:79], v[32:35], v[48:51], v[64:79]
    v_cvt_pk_bf16_f32 v56, v112, v113
    v_cvt_pk_bf16_f32 v57, v114, v115
    v_exp_f32 v116, v116
    v_exp_f32 v117, v117
    v_exp_f32 v118, v118
    v_exp_f32 v119, v119
    v_mfma_f32_32x32x16_bf16 v[144:159], v[24:27], v[16:19], v[144:159]
    v_cvt_pk_bf16_f32 v58, v116, v117
    v_cvt_pk_bf16_f32 v59, v118, v119
    v_exp_f32 v120, v120
    v_exp_f32 v121, v121
    v_exp_f32 v122, v122
    v_exp_f32 v123, v123
    v_mfma_f32_32x32x16_bf16 v[80:95], v[32:35], v[56:59], v[80:95]
    v_cvt_pk_bf16_f32 v60, v120, v121
    v_cvt_pk_bf16_f32 v61, v122, v123
    v_exp_f32 v124, v124
    v_exp_f32 v125, v125
    v_exp_f32 v126, v126
    v_exp_f32 v127, v127
    s_waitcnt lgkmcnt(0)
    ds_read_b128 v[24:27], v2 offset:11520
    ds_read_b32 v30, v3 offset:640
    ds_read_b128 v[32:35], v4 offset:9216
    ds_read_b128 v[44:47], v4 offset:7552
    v_cvt_pk_bf16_f32 v62, v124, v125
    v_cvt_pk_bf16_f32 v63, v126, v127
    v_mfma_f32_32x32x4_2b_bf16 v[96:127], v[28:29], v[12:13], 0
    v_exp_f32 v128, v128
    v_exp_f32 v129, v129
    v_exp_f32 v130, v130
    v_exp_f32 v131, v131
    v_exp_f32 v132, v132
    v_exp_f32 v133, v133
    v_exp_f32 v134, v134
    v_exp_f32 v135, v135
    v_cvt_pk_bf16_f32 v48, v128, v129
    v_cvt_pk_bf16_f32 v49, v130, v131
    v_mfma_f32_32x32x16_bf16 v[64:79], v[40:43], v[52:55], v[64:79]
    v_cvt_pk_bf16_f32 v50, v132, v133
    v_cvt_pk_bf16_f32 v51, v134, v135
    v_exp_f32 v136, v136
    v_exp_f32 v137, v137
    v_exp_f32 v138, v138
    v_exp_f32 v139, v139
    v_mfma_f32_32x32x16_bf16 v[80:95], v[40:43], v[60:63], v[80:95]
    v_cvt_pk_bf16_f32 v52, v136, v137
    v_cvt_pk_bf16_f32 v53, v138, v139
    v_exp_f32 v140, v140
    v_exp_f32 v141, v141
    v_exp_f32 v142, v142
    v_exp_f32 v143, v143
    v_mfma_f32_32x32x16_bf16 v[96:111], v[20:23], v[8:11], v[96:111]
    v_cvt_pk_bf16_f32 v54, v140, v141
    v_cvt_pk_bf16_f32 v55, v142, v143
    v_exp_f32 v144, v144
    v_exp_f32 v145, v145
    v_exp_f32 v146, v146
    v_exp_f32 v147, v147
    v_mfma_f32_32x32x16_bf16 v[64:79], v[36:39], v[48:51], v[64:79]
    v_cvt_pk_bf16_f32 v56, v144, v145
    v_cvt_pk_bf16_f32 v57, v146, v147
    v_exp_f32 v148, v148
    v_exp_f32 v149, v149
    v_exp_f32 v150, v150
    v_exp_f32 v151, v151
    v_mfma_f32_32x32x16_bf16 v[112:127], v[20:23], v[16:19], v[112:127]
    v_cvt_pk_bf16_f32 v58, v148, v149
    v_cvt_pk_bf16_f32 v59, v150, v151
    v_exp_f32 v152, v152
    v_exp_f32 v153, v153
    v_exp_f32 v154, v154
    v_exp_f32 v155, v155
    v_mfma_f32_32x32x16_bf16 v[80:95], v[36:39], v[56:59], v[80:95]
    v_cvt_pk_bf16_f32 v60, v152, v153
    v_cvt_pk_bf16_f32 v61, v154, v155
    v_exp_f32 v156, v156
    v_exp_f32 v157, v157
    v_exp_f32 v158, v158
    v_exp_f32 v159, v159
    s_waitcnt lgkmcnt(0)
    ds_read_b128 v[20:23], v2 offset:13824
    ds_read_b32 v28, v3 offset:768
    ds_read_b128 v[36:39], v4 offset:11520
    ds_read_b128 v[40:43], v4 offset:9856
    v_cvt_pk_bf16_f32 v62, v156, v157
    v_cvt_pk_bf16_f32 v63, v158, v159
    v_mfma_f32_32x32x4_2b_bf16 v[128:159], v[30:31], v[12:13], 0
    v_exp_f32 v96, v96
    v_exp_f32 v97, v97
    v_exp_f32 v98, v98
    v_exp_f32 v99, v99
    v_exp_f32 v100, v100
    v_exp_f32 v101, v101
    v_exp_f32 v102, v102
    v_exp_f32 v103, v103
    v_cvt_pk_bf16_f32 v48, v96, v97
    v_cvt_pk_bf16_f32 v49, v98, v99
    v_mfma_f32_32x32x16_bf16 v[64:79], v[44:47], v[52:55], v[64:79]
    v_cvt_pk_bf16_f32 v50, v100, v101
    v_cvt_pk_bf16_f32 v51, v102, v103
    v_exp_f32 v104, v104
    v_exp_f32 v105, v105
    v_exp_f32 v106, v106
    v_exp_f32 v107, v107
    v_mfma_f32_32x32x16_bf16 v[80:95], v[44:47], v[60:63], v[80:95]
    v_cvt_pk_bf16_f32 v52, v104, v105
    v_cvt_pk_bf16_f32 v53, v106, v107
    v_exp_f32 v108, v108
    v_exp_f32 v109, v109
    v_exp_f32 v110, v110
    v_exp_f32 v111, v111
    v_mfma_f32_32x32x16_bf16 v[128:143], v[24:27], v[8:11], v[128:143]
    v_cvt_pk_bf16_f32 v54, v108, v109
    v_cvt_pk_bf16_f32 v55, v110, v111
    v_exp_f32 v112, v112
    v_exp_f32 v113, v113
    v_exp_f32 v114, v114
    v_exp_f32 v115, v115
    v_mfma_f32_32x32x16_bf16 v[64:79], v[32:35], v[48:51], v[64:79]
    v_cvt_pk_bf16_f32 v56, v112, v113
    v_cvt_pk_bf16_f32 v57, v114, v115
    v_exp_f32 v116, v116
    v_exp_f32 v117, v117
    v_exp_f32 v118, v118
    v_exp_f32 v119, v119
    v_mfma_f32_32x32x16_bf16 v[144:159], v[24:27], v[16:19], v[144:159]
    v_cvt_pk_bf16_f32 v58, v116, v117
    v_cvt_pk_bf16_f32 v59, v118, v119
    v_exp_f32 v120, v120
    v_exp_f32 v121, v121
    v_exp_f32 v122, v122
    v_exp_f32 v123, v123
    v_mfma_f32_32x32x16_bf16 v[80:95], v[32:35], v[56:59], v[80:95]
    v_cvt_pk_bf16_f32 v60, v120, v121
    v_cvt_pk_bf16_f32 v61, v122, v123
    v_exp_f32 v124, v124
    v_exp_f32 v125, v125
    v_exp_f32 v126, v126
    v_exp_f32 v127, v127
    s_cmp_eq_u32 s41, s51
    s_cbranch_scc0 AT_NP
    s_setprio 0
AT_NP:
    s_waitcnt lgkmcnt(0)
    ds_read_b128 v[24:27], v2 offset:16128
    ds_read_b32 v30, v3 offset:896
    ds_read_b128 v[32:35], v4 offset:13824
    ds_read_b128 v[44:47], v4 offset:12160
    v_cvt_pk_bf16_f32 v62, v124, v125
    v_cvt_pk_bf16_f32 v63, v126, v127
    v_mfma_f32_32x32x4_2b_bf16 v[96:127], v[28:29], v[12:13], 0
    v_exp_f32 v128, v128
    v_exp_f32 v129, v129
    v_exp_f32 v130, v130
    v_exp_f32 v131, v131
    v_exp_f32 v132, v132
    v_exp_f32 v133, v133
    v_exp_f32 v134, v134
    v_exp_f32 v135, v135
    v_cvt_pk_bf16_f32 v48, v128, v129
    v_cvt_pk_bf16_f32 v49, v130, v131
    v_mfma_f32_32x32x16_bf16 v[64:79], v[40:43], v[52:55], v[64:79]
    v_cvt_pk_bf16_f32 v50, v132, v133
    v_cvt_pk_bf16_f32 v51, v134, v135
    v_exp_f32 v136, v136
    v_exp_f32 v137, v137
    v_exp_f32 v138, v138
    v_exp_f32 v139, v139
    v_mfma_f32_32x32x16_bf16 v[80:95], v[40:43], v[60:63], v[80:95]
    v_cvt_pk_bf16_f32 v52, v136, v137
    v_cvt_pk_bf16_f32 v53, v138, v139
    v_exp_f32 v140, v140
    v_exp_f32 v141, v141
    v_exp_f32 v142, v142
    v_exp_f32 v143, v143
    v_mfma_f32_32x32x16_bf16 v[96:111], v[20:23], v[8:11], v[96:111]
    v_cvt_pk_bf16_f32 v54, v140, v141
    v_cvt_pk_bf16_f32 v55, v142, v143
    v_exp_f32 v144, v144
    v_exp_f32 v145, v145
    v_exp_f32 v146, v146
    v_exp_f32 v147, v147
    v_mfma_f32_32x32x16_bf16 v[64:79], v[36:39], v[48:51], v[64:79]
    v_cvt_pk_bf16_f32 v56, v144, v145
    v_cvt_pk_bf16_f32 v57, v146, v147
    v_exp_f32 v148, v148
    v_exp_f32 v149, v149
    v_exp_f32 v150, v150
    v_exp_f32 v151, v151
    v_mfma_f32_32x32x16_bf16 v[112:127], v[20:23], v[16:19], v[112:127]
    v_cvt_pk_bf16_f32 v58, v148, v149
    v_cvt_pk_bf16_f32 v59, v150, v151
    v_exp_f32 v152, v152
    v_exp_f32 v153, v153
    v_exp_f32 v154, v154
    v_exp_f32 v155, v155
    v_mfma_f32_32x32x16_bf16 v[80:95], v[36:39], v[56:59], v[80:95]
    v_cvt_pk_bf16_f32 v60, v152, v153
    v_cvt_pk_bf16_f32 v61, v154, v155
    v_exp_f32 v156, v156
    v_exp_f32 v157, v157
    v_exp_f32 v158, v158
    v_exp_f32 v159, v159
    s_waitcnt lgkmcnt(0)
    ds_read_b128 v[20:23], v2 offset:19456
    ds_read_b32 v28, v3 offset:19456
    ds_read_b128 v[36:39], v4 offset:16128
    ds_read_b128 v[40:43], v4 offset:14464
    v_cvt_pk_bf16_f32 v62, v156, v157
    v_cvt_pk_bf16_f32 v63, v158, v159
    v_mfma_f32_32x32x4_2b_bf16 v[128:159], v[30:31], v[12:13], 0
    v_exp_f32 v96, v96
    v_exp_f32 v97, v97
    v_exp_f32 v98, v98
    v_exp_f32 v99, v99
    v_exp_f32 v100, v100
    v_exp_f32 v101, v101
    v_exp_f32 v102, v102
    v_exp_f32 v103, v103
    v_cvt_pk_bf16_f32 v48, v96, v97
    v_cvt_pk_bf16_f32 v49, v98, v99
    v_mfma_f32_32x32x16_bf16 v[64:79], v[44:47], v[52:55], v[64:79]
    v_cvt_pk_bf16_f32 v50, v100, v101
    v_cvt_pk_bf16_f32 v51, v102, v103
    v_exp_f32 v104, v104
    v_exp_f32 v105, v105
    v_exp_f32 v106, v106
    v_exp_f32 v107, v107
    v_mfma_f32_32x32x16_bf16 v[80:95], v[44:47], v[60:63], v[80:95]
    v_cvt_pk_bf16_f32 v52, v104, v105
    v_cvt_pk_bf16_f32 v53, v106, v107
    v_exp_f32 v108, v108
    v_exp_f32 v109, v109
    v_exp_f32 v110, v110
    v_exp_f32 v111, v111
    v_mfma_f32_32x32x16_bf16 v[128:143], v[24:27], v[8:11], v[128:143]
    v_cvt_pk_bf16_f32 v54, v108, v109
    v_cvt_pk_bf16_f32 v55, v110, v111
    v_exp_f32 v112, v112
    v_exp_f32 v113, v113
    v_exp_f32 v114, v114
    v_exp_f32 v115, v115
    v_mfma_f32_32x32x16_bf16 v[64:79], v[32:35], v[48:51], v[64:79]
    v_cvt_pk_bf16_f32 v56, v112, v113
    v_cvt_pk_bf16_f32 v57, v114, v115
    v_exp_f32 v116, v116
    v_exp_f32 v117, v117
    v_exp_f32 v118, v118
    v_exp_f32 v119, v119
    v_mfma_f32_32x32x16_bf16 v[144:159], v[24:27], v[16:19], v[144:159]
    v_cvt_pk_bf16_f32 v58, v116, v117
    v_cvt_pk_bf16_f32 v59, v118, v119
    v_exp_f32 v120, v120
    v_exp_f32 v121, v121
    v_exp_f32 v122, v122
    v_exp_f32 v123, v123
    v_mfma_f32_32x32x16_bf16 v[80:95], v[32:35], v[56:59], v[80:95]
    v_cvt_pk_bf16_f32 v60, v120, v121
    v_cvt_pk_bf16_f32 v61, v122, v123
    v_exp_f32 v124, v124
    v_exp_f32 v125, v125
    v_exp_f32 v126, v126
    v_exp_f32 v127, v127
    s_waitcnt lgkmcnt(0)
    ds_read_b128 v[24:27], v2 offset:21760
    ds_read_b32 v30, v3 offset:19584
    ds_read_b128 v[32:35], v4 offset:19456
    ds_read_b128 v[44:47], v4 offset:16768
    v_cvt_pk_bf16_f32 v62, v124, v125
    v_cvt_pk_bf16_f32 v63, v126, v127
    v_mfma_f32_32x32x4_2b_bf16 v[96:127], v[28:29], v[12:13], 0
    v_exp_f32 v128, v128
    v_exp_f32 v129, v129
    v_exp_f32 v130, v130
    v_exp_f32 v131, v131
    v_exp_f32 v132, v132
    v_exp_f32 v133, v133
    v_exp_f32 v134, v134
    v_exp_f32 v135, v135
    v_cvt_pk_bf16_f32 v48, v128, v129
    v_cvt_pk_bf16_f32 v49, v130, v131
    v_mfma_f32_32x32x16_bf16 v[64:79], v[40:43], v[52:55], v[64:79]
    v_cvt_pk_bf16_f32 v50, v132, v133
    v_cvt_pk_bf16_f32 v51, v134, v135
    v_exp_f32 v136, v136
    v_exp_f32 v137, v137
    v_exp_f32 v138, v138
    v_exp_f32 v139, v139
    v_mfma_f32_32x32x16_bf16 v[80:95], v[40:43], v[60:63], v[80:95]
    v_cvt_pk_bf16_f32 v52, v136, v137
    v_cvt_pk_bf16_f32 v53, v138, v139
    v_exp_f32 v140, v140
    v_exp_f32 v141, v141
    v_exp_f32 v142, v142
    v_exp_f32 v143, v143
    v_mfma_f32_32x32x16_bf16 v[96:111], v[20:23], v[8:11], v[96:111]
    v_cvt_pk_bf16_f32 v54, v140, v141
    v_cvt_pk_bf16_f32 v55, v142, v143
    v_exp_f32 v144, v144
    v_exp_f32 v145, v145
    v_exp_f32 v146, v146
    v_exp_f32 v147, v147
    v_mfma_f32_32x32x16_bf16 v[64:79], v[36:39], v[48:51], v[64:79]
    v_cvt_pk_bf16_f32 v56, v144, v145
    v_cvt_pk_bf16_f32 v57, v146, v147
    v_exp_f32 v148, v148
    v_exp_f32 v149, v149
    v_exp_f32 v150, v150
    v_exp_f32 v151, v151
    v_mfma_f32_32x32x16_bf16 v[112:127], v[20:23], v[16:19], v[112:127]
    v_cvt_pk_bf16_f32 v58, v148, v149
    v_cvt_pk_bf16_f32 v59, v150, v151
    v_exp_f32 v152, v152
    v_exp_f32 v153, v153
    v_exp_f32 v154, v154
    v_exp_f32 v155, v155
    v_mfma_f32_32x32x16_bf16 v[80:95], v[36:39], v[56:59], v[80:95]
    v_cvt_pk_bf16_f32 v60, v152, v153
    v_cvt_pk_bf16_f32 v61, v154, v155
    v_exp_f32 v156, v156
    v_exp_f32 v157, v157
    v_exp_f32 v158, v158
    v_exp_f32 v159, v159
    v_add_u32 v2, 19456, v2
    v_add_u32 v3, 19456, v3
    v_add_u32 v4, 19456, v4
    s_add_u32 s41, s41, 1
    s_cmp_lt_u32 s41, 4
    s_cbranch_scc1 AT_LOOP
    s_nop 0
    v_cvt_pk_bf16_f32 v62, v156, v157
    v_cvt_pk_bf16_f32 v63, v158, v159
    s_waitcnt lgkmcnt(0)
    v_mfma_f32_32x32x16_bf16 v[64:79], v[44:47], v[52:55], v[64:79]
    s_nop 0
    v_mfma_f32_32x32x16_bf16 v[80:95], v[44:47], v[60:63], v[80:95]
    s_setprio 0
    s_barrier
    s_mul_i32 s47, s22, 3072
    v_add_u32 v161, s47, v6
    s_xor_b32 s47, s22, 4
    s_mul_i32 s47, s47, 3072
    v_add_u32 v162, s47, v6
    s_nop 7
    s_cmp_eq_u32 s24, 0
    s_cbranch_scc0 AT_SND1
    ds_write_b128 v161, v[80:83] offset:0
    ds_write_b128 v161, v[84:87] offset:1024
    ds_write_b128 v161, v[88:91] offset:2048
    s_branch AT_SND2
AT_SND1:
    ds_write_b128 v161, v[64:67] offset:0
    ds_write_b128 v161, v[68:71] offset:1024
    ds_write_b128 v161, v[72:75] offset:2048
    s_add_u32 s25, s25, 1
AT_SND2:
    s_waitcnt lgkmcnt(0)
    s_barrier
    ds_read_b128 v[96:99], v162 offset:0
    ds_read_b128 v[100:103], v162 offset:1024
    ds_read_b128 v[104:107], v162 offset:2048
    s_mov_b32 s42, 0x2b800000
    s_mov_b32 s43, 0x5d800000
    s_mov_b32 s50, 0x7b800000
    v_cmp_eq_u32 vcc, 0, v5
    s_cmp_eq_u32 s24, 0
    s_cbranch_scc0 AT_ADD1
    s_waitcnt lgkmcnt(0)
    v_add_f32 v64, v64, v96
    v_add_f32 v65, v65, v97
    v_add_f32 v66, v66, v98
    v_add_f32 v67, v67, v99
    v_add_f32 v68, v68, v100
    v_add_f32 v69, v69, v101
    v_add_f32 v70, v70, v102
    v_add_f32 v71, v71, v103
    v_add_f32 v72, v72, v104
    v_add_f32 v73, v73, v105
    v_add_f32 v74, v74, v106
    s_branch AT_ADD2
AT_ADD1:
    s_waitcnt lgkmcnt(0)
    v_add_f32 v64, v80, v96
    v_add_f32 v65, v81, v97
    v_add_f32 v66, v82, v98
    v_add_f32 v67, v83, v99
    v_add_f32 v68, v84, v100
    v_add_f32 v69, v85, v101
    v_add_f32 v70, v86, v102
    v_add_f32 v71, v87, v103
    v_add_f32 v72, v88, v104
    v_add_f32 v73, v89, v105
    v_add_f32 v74, v90, v106
AT_ADD2:
    v_mov_b32 v160, v74
    v_mov_b32 v161, v74
    v_add_f32 v162, |v64|, |v65|
    v_add_f32 v163, |v72|, |v73|
    v_permlane32_swap_b32 v160, v161
    v_add_f32 v162, v162, |v66|
    v_add_f32 v162, v162, |v67|
    v_add_f32 v162, v162, |v68|
    v_add_f32 v162, v162, |v69|
    v_add_f32 v162, v162, |v70|
    v_add_f32 v162, v162, |v71|
    v_cndmask_b32 v163, 0, v163, vcc
    v_cmp_le_f32 s[46:47], s42, v160
    v_add_f32 v162, v162, v163
    v_cmp_ge_f32 s[48:49], s43, v160
    v_cmp_ge_f32 s[52:53], s50, v162
    s_nop 1
    s_and_b64 s[46:47], s[46:47], s[48:49]
    s_and_b64 s[46:47], s[46:47], s[52:53]
    s_cmp_eq_u64 s[46:47], -1
    s_cbranch_scc1 AT_NORM
    s_cmp_eq_u32 s24, 0
    s_cbranch_scc1 AT_SLQ
    v_mov_b32 v8, v16
    v_mov_b32 v9, v17
    v_mov_b32 v10, v18
    v_mov_b32 v11, v19
    v_mov_b32 v167, v12
    s_nop 1
    v_permlane32_swap_b32 v167, v12
AT_SLQ:
    v_cmp_eq_u32 vcc, 0, v5
    s_nop 1
    v_cndmask_b32 v12, 0, v12, vcc
    s_mul_i32 s46, s20, 155648
    s_add_u32 s46, s46, 12795904
    s_add_u32 s46, s46, s62
    v_mov_b32 v164, 0xff800000
    v_mov_b32 v13, 0
    v_lshlrev_b32 v160, 2, v7
    v_mul_u32_u24 v161, 320, v5
    v_min_u32 v162, 19, v7
    v_lshl_add_u32 v161, v162, 4, v161
    v_add_u32 v2, 1024, v6
    v_mov_b32 v3, v160
    v_add_u32 v4, 2048, v161
    s_mov_b32 s41, 0
AT_SL0:
    buffer_load_dwordx4 v[20:23], v2, s[12:15], s46 offen sc1
    buffer_load_dword v28, v3, s[12:15], s46 offen sc1
    s_waitcnt vmcnt(0)
    v_mfma_f32_32x32x8_bf16 v[96:111], v[28:29], v[12:13], 0
    v_mfma_f32_32x32x16_bf16 v[96:111], v[20:23], v[8:11], v[96:111]
    s_and_b32 s47, s41, 7
    s_cmp_eq_u32 s47, 7
    s_cselect_b32 s47, 3328, 0
    s_cselect_b32 s48, 1, 0
    s_max_u32 s47, s47, 2304
    s_mul_i32 s48, s48, 18432
    s_add_u32 s48, s48, 128
    v_add_u32 v2, s47, v2
    v_add_u32 v4, s47, v4
    v_add_u32 v3, s48, v3
    s_nop 15
    v_max3_f32 v164, v96, v97, v164
    v_max3_f32 v164, v98, v99, v164
    v_max3_f32 v164, v100, v101, v164
    v_max3_f32 v164, v102, v103, v164
    v_max3_f32 v164, v104, v105, v164
    v_max3_f32 v164, v106, v107, v164
    v_max3_f32 v164, v108, v109, v164
    v_max3_f32 v164, v110, v111, v164
    s_add_u32 s41, s41, 1
    s_cmp_lt_u32 s41, 64
    s_cbranch_scc1 AT_SL0
    v_mov_b32 v165, v164
    s_nop 1
    v_permlane32_swap_b32 v164, v165
    s_nop 1
    v_max_f32 v164, v164, v165
    v_sub_f32 v164, 0, v164
    v_and_b32 v165, 0xffff0000, v164
    v_sub_f32 v166, v164, v165
    v_cmp_eq_u32 vcc, 0, v5
    v_lshrrev_b32 v165, 16, v165
    v_and_b32 v166, 0xffff0000, v166
    v_or_b32 v165, v165, v166
    v_cndmask_b32 v13, 0, v165, vcc
    v_add_u32 v2, 1024, v6
    v_mov_b32 v3, v160
    v_add_u32 v4, 2048, v161
    v_mov_b32 v64, 0
    v_mov_b32 v65, 0
    v_mov_b32 v66, 0
    v_mov_b32 v67, 0
    v_mov_b32 v68, 0
    v_mov_b32 v69, 0
    v_mov_b32 v70, 0
    v_mov_b32 v71, 0
    v_mov_b32 v72, 0
    v_mov_b32 v73, 0
    v_mov_b32 v74, 0
    v_mov_b32 v75, 0
    v_mov_b32 v76, 0
    v_mov_b32 v77, 0
    v_mov_b32 v78, 0
    v_mov_b32 v79, 0
    s_mov_b32 s41, 0
AT_SL1:
    buffer_load_dwordx4 v[20:23], v2, s[12:15], s46 offen sc1
    buffer_load_dword v28, v3, s[12:15], s46 offen sc1
    buffer_load_dwordx4 v[32:35], v4, s[12:15], s46 offen sc1
    buffer_load_dwordx4 v[40:43], v4, s[12:15], s46 offen offset:640 sc1
    s_waitcnt vmcnt(0)
    v_mfma_f32_32x32x8_bf16 v[96:111], v[28:29], v[12:13], 0
    v_mfma_f32_32x32x16_bf16 v[96:111], v[20:23], v[8:11], v[96:111]
    s_and_b32 s47, s41, 7
    s_cmp_eq_u32 s47, 7
    s_cselect_b32 s47, 3328, 0
    s_cselect_b32 s48, 1, 0
    s_max_u32 s47, s47, 2304
    s_mul_i32 s48, s48, 18432
    s_add_u32 s48, s48, 128
    v_add_u32 v2, s47, v2
    v_add_u32 v4, s47, v4
    v_add_u32 v3, s48, v3
    s_nop 15
    v_exp_f32 v96, v96
    v_exp_f32 v97, v97
    v_exp_f32 v98, v98
    v_exp_f32 v99, v99
    v_exp_f32 v100, v100
    v_exp_f32 v101, v101
    v_exp_f32 v102, v102
    v_exp_f32 v103, v103
    v_exp_f32 v104, v104
    v_exp_f32 v105, v105
    v_exp_f32 v106, v106
    v_exp_f32 v107, v107
    v_exp_f32 v108, v108
    v_exp_f32 v109, v109
    v_exp_f32 v110, v110
    v_exp_f32 v111, v111
    s_nop 0
    v_cvt_pk_bf16_f32 v48, v96, v97
    v_cvt_pk_bf16_f32 v49, v98, v99
    v_cvt_pk_bf16_f32 v50, v100, v101
    v_cvt_pk_bf16_f32 v51, v102, v103
    v_cvt_pk_bf16_f32 v52, v104, v105
    v_cvt_pk_bf16_f32 v53, v106, v107
    v_cvt_pk_bf16_f32 v54, v108, v109
    v_cvt_pk_bf16_f32 v55, v110, v111
    s_nop 1
    v_mfma_f32_32x32x16_bf16 v[64:79], v[32:35], v[48:51], v[64:79]
    v_mfma_f32_32x32x16_bf16 v[64:79], v[40:43], v[52:55], v[64:79]
    s_add_u32 s41, s41, 1
    s_cmp_lt_u32 s41, 64
    s_cbranch_scc1 AT_SL1
    s_nop 15
    v_mov_b32 v160, v74
    v_mov_b32 v161, v74
    s_nop 1
    v_permlane32_swap_b32 v160, v161
AT_NORM:
    s_nop 0
    v_rcp_f32 v160, v160
    s_nop 0
    v_mul_f32 v64, v160, v64
    v_mul_f32 v65, v160, v65
    v_mul_f32 v66, v160, v66
    v_mul_f32 v67, v160, v67
    v_mul_f32 v68, v160, v68
    v_mul_f32 v69, v160, v69
    v_mul_f32 v70, v160, v70
    v_mul_f32 v71, v160, v71
    v_mul_f32 v72, v160, v72
    v_mul_f32 v73, v160, v73
    v_cvt_pk_bf16_f32 v48, v64, v65
    v_cvt_pk_bf16_f32 v49, v66, v67
    v_cvt_pk_bf16_f32 v50, v68, v69
    v_cvt_pk_bf16_f32 v51, v70, v71
    v_cvt_pk_bf16_f32 v52, v72, v73
    v_lshlrev_b32 v161, 5, v7
    v_lshl_add_u32 v161, v5, 4, v161
    s_lshl_b32 s26, s20, 16
    s_lshl_b32 s27, s25, 10
    s_add_u32 s26, s26, s27
    s_add_u32 s26, s26, 22773760
    s_add_u32 s26, s26, s63
    buffer_store_dwordx4 v[48:51], v161, s[12:15], s26 offen sc1
    s_lshr_b32 s26, s20, 2
    s_lshl_b32 s26, s26, 15
    s_and_b32 s27, s20, 3
    s_lshl_b32 s27, s27, 2
    s_add_u32 s26, s26, s27
    s_lshl_b32 s27, s25, 9
    s_add_u32 s26, s26, s27
    s_add_u32 s26, s26, 26968064
    s_add_u32 s26, s26, s64
    v_lshlrev_b32 v162, 4, v7
    s_mov_b32 exec_hi, 0
    buffer_store_dword v52, v162, s[12:15], s26 offen sc1
    s_mov_b32 exec_hi, -1
    s_waitcnt vmcnt(0)
    s_lshl_b32 s34, s25, 5
    s_add_u32 s34, s34, s20
    s_lshl_b32 s34, s34, 7
    s_lshl_b32 s35, s61, 18
    s_add_u32 s34, s34, s35
    s_add_u32 s34, s34, 30654464
    v_mov_b32 v170, s60
    v_mov_b32 v171, 0
    s_mov_b64 exec, 1
    buffer_store_dword v170, v171, s[12:15], s34 offen sc1
    s_mov_b64 exec, -1
    s_cmp_lg_u32 s61, 0
    s_cbranch_scc1 M_L1
    v_and_b32 v1, 63, v0
    v_lshlrev_b32 v2, 4, v1
    s_mov_b32 s34, 31212544
    s_mov_b32 s58, 0
M_FY:
    buffer_load_dwordx4 v[4:7], v2, s[12:15], s34 offen sc1
    s_waitcnt vmcnt(0)
    v_cmp_eq_u32 vcc, s60, v4
    v_cmp_eq_u32 s[56:57], s60, v5
    s_nop 1
    s_and_b64 vcc, vcc, s[56:57]
    v_cmp_eq_u32 s[56:57], s60, v6
    s_nop 1
    s_and_b64 vcc, vcc, s[56:57]
    v_cmp_eq_u32 s[56:57], s60, v7
    s_nop 1
    s_and_b64 vcc, vcc, s[56:57]
    s_nop 1
    s_cmp_eq_u64 vcc, -1
    s_cbranch_scc1 M_FY_OK
    s_sleep 2
    s_add_u32 s58, s58, 1
    s_cmp_lt_u32 s58, 131072
    s_cbranch_scc1 M_FY
M_FY_OK:
    s_mov_b32 s8, s4
    s_mov_b32 s9, s5
    s_mov_b32 s10, 0x240000
    s_mov_b32 s11, 0x20000
    s_add_u32 s16, s6, 0x1a38000
    s_addc_u32 s17, s7, 0
    s_mov_b32 s18, 0x240000
    s_mov_b32 s19, 0x20000
    s_branch M_L2
M_L1:
    s_load_dwordx2 s[4:5], s[0:1], 72
    s_add_u32 s8, s6, 0x1a38000
    s_addc_u32 s9, s7, 0
    s_mov_b32 s10, 0x240000
    s_mov_b32 s11, 0x20000
    s_waitcnt lgkmcnt(0)
    s_mov_b32 s16, s4
    s_mov_b32 s17, s5
    s_mov_b32 s18, 0x240000
    s_mov_b32 s19, 0x20000
M_L2:
    s_and_b32 s20, s2, 7
    s_lshr_b32 s21, s2, 3
    s_lshl_b32 s20, s20, 3
    s_lshr_b32 s23, s21, 2
    s_add_u32 s20, s20, s23
    s_and_b32 s21, s21, 3
    v_and_b32 v1, 63, v0
    v_and_b32 v3, 15, v1
    v_lshrrev_b32 v4, 4, v1
    v_lshlrev_b32 v5, 4, v1
    s_and_b32 s36, s20, 7
    s_mul_i32 s40, s21, 9
    s_add_u32 s41, s40, 8
    s_add_u32 s40, s40, s22
    s_mul_i32 s40, s40, 18432
    s_add_u32 s40, s40, 2498560
    s_mul_i32 s41, s41, 18432
    s_add_u32 s41, s41, 2498560
    s_cmp_eq_u32 s22, 7
    s_cbranch_scc1 G_W7a
    s_add_u32 s34, s36, 0
    s_sub_u32 s35, s34, 9
    s_cmp_ge_u32 s34, 9
    s_cselect_b32 s34, s35, s34
    s_lshl_b32 s34, s34, 11
    s_add_u32 s34, s34, s40
    buffer_load_dwordx4 v[64:67], v5, s[12:15], s34 offen offset:0 sc1
    buffer_load_dwordx4 v[68:71], v5, s[12:15], s34 offen offset:1024 sc1
    s_add_u32 s34, s36, 1
    s_sub_u32 s35, s34, 9
    s_cmp_ge_u32 s34, 9
    s_cselect_b32 s34, s35, s34
    s_lshl_b32 s34, s34, 11
    s_add_u32 s34, s34, s40
    buffer_load_dwordx4 v[72:75], v5, s[12:15], s34 offen offset:0 sc1
    buffer_load_dwordx4 v[76:79], v5, s[12:15], s34 offen offset:1024 sc1
    s_add_u32 s34, s36, 2
    s_sub_u32 s35, s34, 9
    s_cmp_ge_u32 s34, 9
    s_cselect_b32 s34, s35, s34
    s_lshl_b32 s34, s34, 11
    s_add_u32 s34, s34, s40
    buffer_load_dwordx4 v[80:83], v5, s[12:15], s34 offen offset:0 sc1
    buffer_load_dwordx4 v[84:87], v5, s[12:15], s34 offen offset:1024 sc1
    s_add_u32 s34, s36, 3
    s_sub_u32 s35, s34, 9
    s_cmp_ge_u32 s34, 9
    s_cselect_b32 s34, s35, s34
    s_lshl_b32 s34, s34, 11
    s_add_u32 s34, s34, s40
    buffer_load_dwordx4 v[88:91], v5, s[12:15], s34 offen offset:0 sc1
    buffer_load_dwordx4 v[92:95], v5, s[12:15], s34 offen offset:1024 sc1
    s_add_u32 s34, s36, 4
    s_sub_u32 s35, s34, 9
    s_cmp_ge_u32 s34, 9
    s_cselect_b32 s34, s35, s34
    s_lshl_b32 s34, s34, 11
    s_add_u32 s34, s34, s40
    buffer_load_dwordx4 v[96:99], v5, s[12:15], s34 offen offset:0 sc1
    buffer_load_dwordx4 v[100:103], v5, s[12:15], s34 offen offset:1024 sc1
    s_add_u32 s34, s36, 5
    s_sub_u32 s35, s34, 9
    s_cmp_ge_u32 s34, 9
    s_cselect_b32 s34, s35, s34
    s_lshl_b32 s34, s34, 11
    s_add_u32 s34, s34, s40
    buffer_load_dwordx4 v[104:107], v5, s[12:15], s34 offen offset:0 sc1
    buffer_load_dwordx4 v[108:111], v5, s[12:15], s34 offen offset:1024 sc1
    s_add_u32 s34, s36, 6
    s_sub_u32 s35, s34, 9
    s_cmp_ge_u32 s34, 9
    s_cselect_b32 s34, s35, s34
    s_lshl_b32 s34, s34, 11
    s_add_u32 s34, s34, s40
    buffer_load_dwordx4 v[112:115], v5, s[12:15], s34 offen offset:0 sc1
    buffer_load_dwordx4 v[116:119], v5, s[12:15], s34 offen offset:1024 sc1
    s_branch G_WDa
G_W7a:
    s_add_u32 s34, s36, 0
    s_sub_u32 s35, s34, 9
    s_cmp_ge_u32 s34, 9
    s_cselect_b32 s34, s35, s34
    s_lshl_b32 s34, s34, 11
    s_add_u32 s34, s34, s40
    buffer_load_dwordx4 v[64:67], v5, s[12:15], s34 offen offset:0 sc1
    buffer_load_dwordx4 v[68:71], v5, s[12:15], s34 offen offset:1024 sc1
    s_add_u32 s34, s36, 0
    s_sub_u32 s35, s34, 9
    s_cmp_ge_u32 s34, 9
    s_cselect_b32 s34, s35, s34
    s_lshl_b32 s34, s34, 11
    s_add_u32 s34, s34, s41
    buffer_load_dwordx4 v[136:139], v5, s[12:15], s34 offen offset:0 sc1
    buffer_load_dwordx4 v[140:143], v5, s[12:15], s34 offen offset:1024 sc1
    s_add_u32 s34, s36, 1
    s_sub_u32 s35, s34, 9
    s_cmp_ge_u32 s34, 9
    s_cselect_b32 s34, s35, s34
    s_lshl_b32 s34, s34, 11
    s_add_u32 s34, s34, s40
    buffer_load_dwordx4 v[72:75], v5, s[12:15], s34 offen offset:0 sc1
    buffer_load_dwordx4 v[76:79], v5, s[12:15], s34 offen offset:1024 sc1
    s_add_u32 s34, s36, 1
    s_sub_u32 s35, s34, 9
    s_cmp_ge_u32 s34, 9
    s_cselect_b32 s34, s35, s34
    s_lshl_b32 s34, s34, 11
    s_add_u32 s34, s34, s41
    buffer_load_dwordx4 v[144:147], v5, s[12:15], s34 offen offset:0 sc1
    buffer_load_dwordx4 v[148:151], v5, s[12:15], s34 offen offset:1024 sc1
    s_add_u32 s34, s36, 2
    s_sub_u32 s35, s34, 9
    s_cmp_ge_u32 s34, 9
    s_cselect_b32 s34, s35, s34
    s_lshl_b32 s34, s34, 11
    s_add_u32 s34, s34, s40
    buffer_load_dwordx4 v[80:83], v5, s[12:15], s34 offen offset:0 sc1
    buffer_load_dwordx4 v[84:87], v5, s[12:15], s34 offen offset:1024 sc1
    s_add_u32 s34, s36, 2
    s_sub_u32 s35, s34, 9
    s_cmp_ge_u32 s34, 9
    s_cselect_b32 s34, s35, s34
    s_lshl_b32 s34, s34, 11
    s_add_u32 s34, s34, s41
    buffer_load_dwordx4 v[152:155], v5, s[12:15], s34 offen offset:0 sc1
    buffer_load_dwordx4 v[156:159], v5, s[12:15], s34 offen offset:1024 sc1
    s_add_u32 s34, s36, 3
    s_sub_u32 s35, s34, 9
    s_cmp_ge_u32 s34, 9
    s_cselect_b32 s34, s35, s34
    s_lshl_b32 s34, s34, 11
    s_add_u32 s34, s34, s40
    buffer_load_dwordx4 v[88:91], v5, s[12:15], s34 offen offset:0 sc1
    buffer_load_dwordx4 v[92:95], v5, s[12:15], s34 offen offset:1024 sc1
    s_add_u32 s34, s36, 3
    s_sub_u32 s35, s34, 9
    s_cmp_ge_u32 s34, 9
    s_cselect_b32 s34, s35, s34
    s_lshl_b32 s34, s34, 11
    s_add_u32 s34, s34, s41
    buffer_load_dwordx4 v[160:163], v5, s[12:15], s34 offen offset:0 sc1
    buffer_load_dwordx4 v[164:167], v5, s[12:15], s34 offen offset:1024 sc1
    s_add_u32 s34, s36, 4
    s_sub_u32 s35, s34, 9
    s_cmp_ge_u32 s34, 9
    s_cselect_b32 s34, s35, s34
    s_lshl_b32 s34, s34, 11
    s_add_u32 s34, s34, s40
    buffer_load_dwordx4 v[96:99], v5, s[12:15], s34 offen offset:0 sc1
    buffer_load_dwordx4 v[100:103], v5, s[12:15], s34 offen offset:1024 sc1
    s_add_u32 s34, s36, 4
    s_sub_u32 s35, s34, 9
    s_cmp_ge_u32 s34, 9
    s_cselect_b32 s34, s35, s34
    s_lshl_b32 s34, s34, 11
    s_add_u32 s34, s34, s41
    buffer_load_dwordx4 v[168:171], v5, s[12:15], s34 offen offset:0 sc1
    buffer_load_dwordx4 v[172:175], v5, s[12:15], s34 offen offset:1024 sc1
    s_add_u32 s34, s36, 5
    s_sub_u32 s35, s34, 9
    s_cmp_ge_u32 s34, 9
    s_cselect_b32 s34, s35, s34
    s_lshl_b32 s34, s34, 11
    s_add_u32 s34, s34, s40
    buffer_load_dwordx4 v[104:107], v5, s[12:15], s34 offen offset:0 sc1
    buffer_load_dwordx4 v[108:111], v5, s[12:15], s34 offen offset:1024 sc1
    s_add_u32 s34, s36, 5
    s_sub_u32 s35, s34, 9
    s_cmp_ge_u32 s34, 9
    s_cselect_b32 s34, s35, s34
    s_lshl_b32 s34, s34, 11
    s_add_u32 s34, s34, s41
    buffer_load_dwordx4 v[176:179], v5, s[12:15], s34 offen offset:0 sc1
    buffer_load_dwordx4 v[180:183], v5, s[12:15], s34 offen offset:1024 sc1
    s_add_u32 s34, s36, 6
    s_sub_u32 s35, s34, 9
    s_cmp_ge_u32 s34, 9
    s_cselect_b32 s34, s35, s34
    s_lshl_b32 s34, s34, 11
    s_add_u32 s34, s34, s40
    buffer_load_dwordx4 v[112:115], v5, s[12:15], s34 offen offset:0 sc1
    buffer_load_dwordx4 v[116:119], v5, s[12:15], s34 offen offset:1024 sc1
    s_add_u32 s34, s36, 6
    s_sub_u32 s35, s34, 9
    s_cmp_ge_u32 s34, 9
    s_cselect_b32 s34, s35, s34
    s_lshl_b32 s34, s34, 11
    s_add_u32 s34, s34, s41
    buffer_load_dwordx4 v[184:187], v5, s[12:15], s34 offen offset:0 sc1
    buffer_load_dwordx4 v[188:191], v5, s[12:15], s34 offen offset:1024 sc1
G_WDa:
    s_mov_b32 s31, 238609295
    s_mul_i32 s32, s20, 36864
    s_mul_i32 s33, s21, 288
    s_add_u32 s32, s32, s33
    v_mul_hi_u32 v7, v0, s31
    v_mul_u32_u24 v8, 18, v7
    v_sub_u32 v8, v0, v8
    v_mul_u32_u24 v9, 1152, v7
    v_lshl_add_u32 v60, v8, 4, v9
    v_add_u32 v6, 512, v1
    v_mul_hi_u32 v7, v6, s31
    v_mul_u32_u24 v8, 18, v7
    v_sub_u32 v8, v6, v8
    v_mul_u32_u24 v9, 1152, v7
    v_lshl_add_u32 v61, v8, 4, v9
    s_cmp_lg_u32 s22, 0
    s_cbranch_scc1 M_F2W
    s_lshl_b32 s38, s20, 12
    s_lshl_b32 s35, s61, 18
    s_add_u32 s38, s38, s35
    s_add_u32 s38, s38, 30654464
    v_and_b32 v52, 31, v0
    v_lshlrev_b32 v52, 7, v52
    s_mov_b32 s58, 0
M_F2:
    buffer_load_dword v53, v52, s[12:15], s38 offen sc1
    s_waitcnt vmcnt(0)
    v_cmp_eq_u32 vcc, s60, v53
    s_nop 1
    s_cmp_eq_u64 vcc, -1
    s_cbranch_scc1 M_F2_OK
    s_sleep 2
    s_add_u32 s58, s58, 1
    s_cmp_lt_u32 s58, 131072
    s_cbranch_scc1 M_F2
M_F2_OK:
M_F2W:
    s_barrier
    v_lshrrev_b32 v6, 1, v4
    v_lshlrev_b32 v6, 16, v6
    v_lshl_add_u32 v6, v3, 5, v6
    v_and_b32 v7, 1, v4
    v_lshl_add_u32 v6, v7, 4, v6
    s_lshl_b32 s24, s22, 18
    s_lshl_b32 s25, s20, 10
    s_add_u32 s24, s24, s25
    s_add_u32 s24, s24, 22773760
    s_add_u32 s24, s24, s63
    s_and_b32 s36, s20, 7
    s_add_u32 s28, s22, 9
    s_sub_u32 s28, s28, s36
    s_sub_u32 s29, s28, 9
    s_cmp_ge_u32 s28, 9
    s_cselect_b32 s28, s29, s28
    s_lshl_b32 s28, s28, 11
    s_add_u32 m0, s28, 24576
    s_add_u32 s30, s24, 0
    buffer_load_dwordx4 v6, s[12:15], s30 offen sc1 lds
    s_add_u32 m0, s28, 25600
    s_add_u32 s30, s24, 131072
    buffer_load_dwordx4 v6, s[12:15], s30 offen sc1 lds
    s_add_u32 m0, s28, 43008
    s_add_u32 s30, s24, 512
    buffer_load_dwordx4 v6, s[12:15], s30 offen sc1 lds
    s_add_u32 m0, s28, 44032
    s_add_u32 s30, s24, 131584
    buffer_load_dwordx4 v6, s[12:15], s30 offen sc1 lds
    s_cmp_ge_u32 s22, 4
    s_cbranch_scc1 G_NE
    v_lshlrev_b32 v6, 15, v4
    v_lshl_add_u32 v6, v3, 4, v6
    s_lshr_b32 s24, s22, 1
    s_and_b32 s25, s22, 1
    s_lshl_b32 s26, s20, 9
    s_lshl_b32 s27, s24, 8
    s_add_u32 s26, s26, s27
    s_lshl_b32 s27, s25, 17
    s_add_u32 s26, s26, s27
    s_add_u32 s26, s26, 26968064
    s_add_u32 s26, s26, s64
    s_mul_i32 s27, s24, 18432
    s_lshl_b32 s28, s25, 10
    s_add_u32 s27, s27, s28
    s_sub_u32 s28, 8, s36
    s_lshl_b32 s28, s28, 11
    s_add_u32 s27, s27, s28
    s_add_u32 m0, s27, 24576
    s_nop 0
    buffer_load_dwordx4 v6, s[12:15], s26 offen sc1 lds
G_NE:
    v_mov_b32 v8, 0
    v_mov_b32 v208, 0
    v_mov_b32 v9, 0
    v_mov_b32 v209, 0
    v_mov_b32 v10, 0
    v_mov_b32 v210, 0
    v_mov_b32 v11, 0
    v_mov_b32 v211, 0
    v_mov_b32 v12, 0
    v_mov_b32 v212, 0
    v_mov_b32 v13, 0
    v_mov_b32 v213, 0
    v_mov_b32 v14, 0
    v_mov_b32 v214, 0
    v_mov_b32 v15, 0
    v_mov_b32 v215, 0
    s_waitcnt vmcnt(0)
    s_barrier
    s_cmp_eq_u32 s22, 7
    s_cbranch_scc1 G_W7b
    s_add_u32 s34, s36, 7
    s_sub_u32 s35, s34, 9
    s_cmp_ge_u32 s34, 9
    s_cselect_b32 s34, s35, s34
    s_lshl_b32 s34, s34, 11
    s_add_u32 s34, s34, s40
    buffer_load_dwordx4 v[120:123], v5, s[12:15], s34 offen offset:0 sc1
    buffer_load_dwordx4 v[124:127], v5, s[12:15], s34 offen offset:1024 sc1
    s_add_u32 s34, s36, 8
    s_sub_u32 s35, s34, 9
    s_cmp_ge_u32 s34, 9
    s_cselect_b32 s34, s35, s34
    s_lshl_b32 s34, s34, 11
    s_add_u32 s34, s34, s40
    buffer_load_dwordx4 v[128:131], v5, s[12:15], s34 offen offset:0 sc1
    buffer_load_dwordx4 v[132:135], v5, s[12:15], s34 offen offset:1024 sc1
    s_branch G_WDb
G_W7b:
    s_add_u32 s34, s36, 7
    s_sub_u32 s35, s34, 9
    s_cmp_ge_u32 s34, 9
    s_cselect_b32 s34, s35, s34
    s_lshl_b32 s34, s34, 11
    s_add_u32 s34, s34, s40
    buffer_load_dwordx4 v[120:123], v5, s[12:15], s34 offen offset:0 sc1
    buffer_load_dwordx4 v[124:127], v5, s[12:15], s34 offen offset:1024 sc1
    s_add_u32 s34, s36, 7
    s_sub_u32 s35, s34, 9
    s_cmp_ge_u32 s34, 9
    s_cselect_b32 s34, s35, s34
    s_lshl_b32 s34, s34, 11
    s_add_u32 s34, s34, s41
    buffer_load_dwordx4 v[192:195], v5, s[12:15], s34 offen offset:0 sc1
    buffer_load_dwordx4 v[196:199], v5, s[12:15], s34 offen offset:1024 sc1
    s_add_u32 s34, s36, 8
    s_sub_u32 s35, s34, 9
    s_cmp_ge_u32 s34, 9
    s_cselect_b32 s34, s35, s34
    s_lshl_b32 s34, s34, 11
    s_add_u32 s34, s34, s40
    buffer_load_dwordx4 v[128:131], v5, s[12:15], s34 offen offset:0 sc1
    buffer_load_dwordx4 v[132:135], v5, s[12:15], s34 offen offset:1024 sc1
    s_add_u32 s34, s36, 8
    s_sub_u32 s35, s34, 9
    s_cmp_ge_u32 s34, 9
    s_cselect_b32 s34, s35, s34
    s_lshl_b32 s34, s34, 11
    s_add_u32 s34, s34, s41
    buffer_load_dwordx4 v[200:203], v5, s[12:15], s34 offen offset:0 sc1
    buffer_load_dwordx4 v[204:207], v5, s[12:15], s34 offen offset:1024 sc1
G_WDb:
    s_lshl_b32 s34, s22, 10
    s_add_u32 m0, s34, 61440
    s_nop 0
    buffer_load_dwordx4 v60, s[8:11], s32 offen sc1 lds
    s_mul_i32 s33, s21, 589824
    s_lshl_b32 s35, s20, 6
    s_add_u32 s33, s33, s35
    s_add_u32 s33, s33, 5718016
    v_lshrrev_b32 v63, 2, v0
    v_lshlrev_b32 v63, 12, v63
    v_and_b32 v62, 3, v0
    v_lshl_add_u32 v63, v62, 4, v63
    s_add_u32 m0, s34, 70656
    s_nop 0
    buffer_load_dwordx4 v63, s[12:15], s33 offen sc1 lds
    s_cmp_lg_u32 s22, 0
    s_cbranch_scc1 G_NX
    s_mov_b32 m0, 69632
    s_nop 0
    buffer_load_dwordx4 v61, s[8:11], s32 offen sc1 lds
    v_add_u32 v63, 524288, v63
    s_mov_b32 m0, 78848
    s_nop 0
    buffer_load_dwordx4 v63, s[12:15], s33 offen sc1 lds
G_NX:
    s_cmp_eq_u32 s22, 7
    s_cbranch_scc1 G_ML2
    ds_read_b128 v[16:19], v5 offset:24576
    ds_read_b128 v[20:23], v5 offset:43008
    ds_read_b128 v[24:27], v5 offset:25600
    ds_read_b128 v[28:31], v5 offset:44032
    ds_read_b128 v[32:35], v5 offset:26624
    ds_read_b128 v[36:39], v5 offset:45056
    s_waitcnt lgkmcnt(4)
    v_mfma_f32_16x16x32_bf16 v[8:11], v[64:67], v[16:19], v[8:11]
    v_mfma_f32_16x16x32_bf16 v[12:15], v[64:67], v[20:23], v[12:15]
    ds_read_b128 v[16:19], v5 offset:27648
    ds_read_b128 v[20:23], v5 offset:46080
    s_waitcnt lgkmcnt(4)
    v_mfma_f32_16x16x32_bf16 v[8:11], v[68:71], v[24:27], v[8:11]
    v_mfma_f32_16x16x32_bf16 v[12:15], v[68:71], v[28:31], v[12:15]
    ds_read_b128 v[24:27], v5 offset:28672
    ds_read_b128 v[28:31], v5 offset:47104
    s_waitcnt lgkmcnt(4)
    v_mfma_f32_16x16x32_bf16 v[8:11], v[72:75], v[32:35], v[8:11]
    v_mfma_f32_16x16x32_bf16 v[12:15], v[72:75], v[36:39], v[12:15]
    ds_read_b128 v[32:35], v5 offset:29696
    ds_read_b128 v[36:39], v5 offset:48128
    s_waitcnt lgkmcnt(4)
    v_mfma_f32_16x16x32_bf16 v[8:11], v[76:79], v[16:19], v[8:11]
    v_mfma_f32_16x16x32_bf16 v[12:15], v[76:79], v[20:23], v[12:15]
    ds_read_b128 v[16:19], v5 offset:30720
    ds_read_b128 v[20:23], v5 offset:49152
    s_waitcnt lgkmcnt(4)
    v_mfma_f32_16x16x32_bf16 v[8:11], v[80:83], v[24:27], v[8:11]
    v_mfma_f32_16x16x32_bf16 v[12:15], v[80:83], v[28:31], v[12:15]
    ds_read_b128 v[24:27], v5 offset:31744
    ds_read_b128 v[28:31], v5 offset:50176
    s_waitcnt lgkmcnt(4)
    v_mfma_f32_16x16x32_bf16 v[8:11], v[84:87], v[32:35], v[8:11]
    v_mfma_f32_16x16x32_bf16 v[12:15], v[84:87], v[36:39], v[12:15]
    ds_read_b128 v[32:35], v5 offset:32768
    ds_read_b128 v[36:39], v5 offset:51200
    s_waitcnt lgkmcnt(4)
    v_mfma_f32_16x16x32_bf16 v[8:11], v[88:91], v[16:19], v[8:11]
    v_mfma_f32_16x16x32_bf16 v[12:15], v[88:91], v[20:23], v[12:15]
    ds_read_b128 v[16:19], v5 offset:33792
    ds_read_b128 v[20:23], v5 offset:52224
    s_waitcnt lgkmcnt(4)
    v_mfma_f32_16x16x32_bf16 v[8:11], v[92:95], v[24:27], v[8:11]
    v_mfma_f32_16x16x32_bf16 v[12:15], v[92:95], v[28:31], v[12:15]
    ds_read_b128 v[24:27], v5 offset:34816
    ds_read_b128 v[28:31], v5 offset:53248
    s_waitcnt lgkmcnt(4)
    v_mfma_f32_16x16x32_bf16 v[8:11], v[96:99], v[32:35], v[8:11]
    v_mfma_f32_16x16x32_bf16 v[12:15], v[96:99], v[36:39], v[12:15]
    ds_read_b128 v[32:35], v5 offset:35840
    ds_read_b128 v[36:39], v5 offset:54272
    s_waitcnt lgkmcnt(4)
    v_mfma_f32_16x16x32_bf16 v[8:11], v[100:103], v[16:19], v[8:11]
    v_mfma_f32_16x16x32_bf16 v[12:15], v[100:103], v[20:23], v[12:15]
    ds_read_b128 v[16:19], v5 offset:36864
    ds_read_b128 v[20:23], v5 offset:55296
    s_waitcnt lgkmcnt(4)
    v_mfma_f32_16x16x32_bf16 v[8:11], v[104:107], v[24:27], v[8:11]
    v_mfma_f32_16x16x32_bf16 v[12:15], v[104:107], v[28:31], v[12:15]
    ds_read_b128 v[24:27], v5 offset:37888
    ds_read_b128 v[28:31], v5 offset:56320
    s_waitcnt lgkmcnt(4)
    v_mfma_f32_16x16x32_bf16 v[8:11], v[108:111], v[32:35], v[8:11]
    v_mfma_f32_16x16x32_bf16 v[12:15], v[108:111], v[36:39], v[12:15]
    ds_read_b128 v[32:35], v5 offset:38912
    ds_read_b128 v[36:39], v5 offset:57344
    s_waitcnt lgkmcnt(4)
    v_mfma_f32_16x16x32_bf16 v[8:11], v[112:115], v[16:19], v[8:11]
    v_mfma_f32_16x16x32_bf16 v[12:15], v[112:115], v[20:23], v[12:15]
    ds_read_b128 v[16:19], v5 offset:39936
    ds_read_b128 v[20:23], v5 offset:58368
    s_waitcnt lgkmcnt(4)
    v_mfma_f32_16x16x32_bf16 v[8:11], v[116:119], v[24:27], v[8:11]
    v_mfma_f32_16x16x32_bf16 v[12:15], v[116:119], v[28:31], v[12:15]
    ds_read_b128 v[24:27], v5 offset:40960
    ds_read_b128 v[28:31], v5 offset:59392
    s_waitcnt vmcnt(4) lgkmcnt(4)
    v_mfma_f32_16x16x32_bf16 v[8:11], v[120:123], v[32:35], v[8:11]
    v_mfma_f32_16x16x32_bf16 v[12:15], v[120:123], v[36:39], v[12:15]
    ds_read_b128 v[32:35], v5 offset:41984
    ds_read_b128 v[36:39], v5 offset:60416
    s_waitcnt lgkmcnt(4)
    v_mfma_f32_16x16x32_bf16 v[8:11], v[124:127], v[16:19], v[8:11]
    v_mfma_f32_16x16x32_bf16 v[12:15], v[124:127], v[20:23], v[12:15]
    s_waitcnt vmcnt(2) lgkmcnt(2)
    v_mfma_f32_16x16x32_bf16 v[8:11], v[128:131], v[24:27], v[8:11]
    v_mfma_f32_16x16x32_bf16 v[12:15], v[128:131], v[28:31], v[12:15]
    s_waitcnt lgkmcnt(0)
    v_mfma_f32_16x16x32_bf16 v[8:11], v[132:135], v[32:35], v[8:11]
    v_mfma_f32_16x16x32_bf16 v[12:15], v[132:135], v[36:39], v[12:15]
    s_branch G_MLD
G_ML2:
    ds_read_b128 v[16:19], v5 offset:24576
    ds_read_b128 v[20:23], v5 offset:43008
    ds_read_b128 v[24:27], v5 offset:25600
    ds_read_b128 v[28:31], v5 offset:44032
    ds_read_b128 v[32:35], v5 offset:26624
    ds_read_b128 v[36:39], v5 offset:45056
    s_waitcnt lgkmcnt(4)
    v_mfma_f32_16x16x32_bf16 v[8:11], v[64:67], v[16:19], v[8:11]
    v_mfma_f32_16x16x32_bf16 v[12:15], v[64:67], v[20:23], v[12:15]
    v_mfma_f32_16x16x32_bf16 v[208:211], v[136:139], v[16:19], v[208:211]
    v_mfma_f32_16x16x32_bf16 v[212:215], v[136:139], v[20:23], v[212:215]
    ds_read_b128 v[16:19], v5 offset:27648
    ds_read_b128 v[20:23], v5 offset:46080
    s_waitcnt lgkmcnt(4)
    v_mfma_f32_16x16x32_bf16 v[8:11], v[68:71], v[24:27], v[8:11]
    v_mfma_f32_16x16x32_bf16 v[12:15], v[68:71], v[28:31], v[12:15]
    v_mfma_f32_16x16x32_bf16 v[208:211], v[140:143], v[24:27], v[208:211]
    v_mfma_f32_16x16x32_bf16 v[212:215], v[140:143], v[28:31], v[212:215]
    ds_read_b128 v[24:27], v5 offset:28672
    ds_read_b128 v[28:31], v5 offset:47104
    s_waitcnt lgkmcnt(4)
    v_mfma_f32_16x16x32_bf16 v[8:11], v[72:75], v[32:35], v[8:11]
    v_mfma_f32_16x16x32_bf16 v[12:15], v[72:75], v[36:39], v[12:15]
    v_mfma_f32_16x16x32_bf16 v[208:211], v[144:147], v[32:35], v[208:211]
    v_mfma_f32_16x16x32_bf16 v[212:215], v[144:147], v[36:39], v[212:215]
    ds_read_b128 v[32:35], v5 offset:29696
    ds_read_b128 v[36:39], v5 offset:48128
    s_waitcnt lgkmcnt(4)
    v_mfma_f32_16x16x32_bf16 v[8:11], v[76:79], v[16:19], v[8:11]
    v_mfma_f32_16x16x32_bf16 v[12:15], v[76:79], v[20:23], v[12:15]
    v_mfma_f32_16x16x32_bf16 v[208:211], v[148:151], v[16:19], v[208:211]
    v_mfma_f32_16x16x32_bf16 v[212:215], v[148:151], v[20:23], v[212:215]
    ds_read_b128 v[16:19], v5 offset:30720
    ds_read_b128 v[20:23], v5 offset:49152
    s_waitcnt lgkmcnt(4)
    v_mfma_f32_16x16x32_bf16 v[8:11], v[80:83], v[24:27], v[8:11]
    v_mfma_f32_16x16x32_bf16 v[12:15], v[80:83], v[28:31], v[12:15]
    v_mfma_f32_16x16x32_bf16 v[208:211], v[152:155], v[24:27], v[208:211]
    v_mfma_f32_16x16x32_bf16 v[212:215], v[152:155], v[28:31], v[212:215]
    ds_read_b128 v[24:27], v5 offset:31744
    ds_read_b128 v[28:31], v5 offset:50176
    s_waitcnt lgkmcnt(4)
    v_mfma_f32_16x16x32_bf16 v[8:11], v[84:87], v[32:35], v[8:11]
    v_mfma_f32_16x16x32_bf16 v[12:15], v[84:87], v[36:39], v[12:15]
    v_mfma_f32_16x16x32_bf16 v[208:211], v[156:159], v[32:35], v[208:211]
    v_mfma_f32_16x16x32_bf16 v[212:215], v[156:159], v[36:39], v[212:215]
    ds_read_b128 v[32:35], v5 offset:32768
    ds_read_b128 v[36:39], v5 offset:51200
    s_waitcnt lgkmcnt(4)
    v_mfma_f32_16x16x32_bf16 v[8:11], v[88:91], v[16:19], v[8:11]
    v_mfma_f32_16x16x32_bf16 v[12:15], v[88:91], v[20:23], v[12:15]
    v_mfma_f32_16x16x32_bf16 v[208:211], v[160:163], v[16:19], v[208:211]
    v_mfma_f32_16x16x32_bf16 v[212:215], v[160:163], v[20:23], v[212:215]
    ds_read_b128 v[16:19], v5 offset:33792
    ds_read_b128 v[20:23], v5 offset:52224
    s_waitcnt lgkmcnt(4)
    v_mfma_f32_16x16x32_bf16 v[8:11], v[92:95], v[24:27], v[8:11]
    v_mfma_f32_16x16x32_bf16 v[12:15], v[92:95], v[28:31], v[12:15]
    v_mfma_f32_16x16x32_bf16 v[208:211], v[164:167], v[24:27], v[208:211]
    v_mfma_f32_16x16x32_bf16 v[212:215], v[164:167], v[28:31], v[212:215]
    ds_read_b128 v[24:27], v5 offset:34816
    ds_read_b128 v[28:31], v5 offset:53248
    s_waitcnt lgkmcnt(4)
    v_mfma_f32_16x16x32_bf16 v[8:11], v[96:99], v[32:35], v[8:11]
    v_mfma_f32_16x16x32_bf16 v[12:15], v[96:99], v[36:39], v[12:15]
    v_mfma_f32_16x16x32_bf16 v[208:211], v[168:171], v[32:35], v[208:211]
    v_mfma_f32_16x16x32_bf16 v[212:215], v[168:171], v[36:39], v[212:215]
    ds_read_b128 v[32:35], v5 offset:35840
    ds_read_b128 v[36:39], v5 offset:54272
    s_waitcnt lgkmcnt(4)
    v_mfma_f32_16x16x32_bf16 v[8:11], v[100:103], v[16:19], v[8:11]
    v_mfma_f32_16x16x32_bf16 v[12:15], v[100:103], v[20:23], v[12:15]
    v_mfma_f32_16x16x32_bf16 v[208:211], v[172:175], v[16:19], v[208:211]
    v_mfma_f32_16x16x32_bf16 v[212:215], v[172:175], v[20:23], v[212:215]
    ds_read_b128 v[16:19], v5 offset:36864
    ds_read_b128 v[20:23], v5 offset:55296
    s_waitcnt lgkmcnt(4)
    v_mfma_f32_16x16x32_bf16 v[8:11], v[104:107], v[24:27], v[8:11]
    v_mfma_f32_16x16x32_bf16 v[12:15], v[104:107], v[28:31], v[12:15]
    v_mfma_f32_16x16x32_bf16 v[208:211], v[176:179], v[24:27], v[208:211]
    v_mfma_f32_16x16x32_bf16 v[212:215], v[176:179], v[28:31], v[212:215]
    ds_read_b128 v[24:27], v5 offset:37888
    ds_read_b128 v[28:31], v5 offset:56320
    s_waitcnt lgkmcnt(4)
    v_mfma_f32_16x16x32_bf16 v[8:11], v[108:111], v[32:35], v[8:11]
    v_mfma_f32_16x16x32_bf16 v[12:15], v[108:111], v[36:39], v[12:15]
    v_mfma_f32_16x16x32_bf16 v[208:211], v[180:183], v[32:35], v[208:211]
    v_mfma_f32_16x16x32_bf16 v[212:215], v[180:183], v[36:39], v[212:215]
    ds_read_b128 v[32:35], v5 offset:38912
    ds_read_b128 v[36:39], v5 offset:57344
    s_waitcnt lgkmcnt(4)
    v_mfma_f32_16x16x32_bf16 v[8:11], v[112:115], v[16:19], v[8:11]
    v_mfma_f32_16x16x32_bf16 v[12:15], v[112:115], v[20:23], v[12:15]
    v_mfma_f32_16x16x32_bf16 v[208:211], v[184:187], v[16:19], v[208:211]
    v_mfma_f32_16x16x32_bf16 v[212:215], v[184:187], v[20:23], v[212:215]
    ds_read_b128 v[16:19], v5 offset:39936
    ds_read_b128 v[20:23], v5 offset:58368
    s_waitcnt lgkmcnt(4)
    v_mfma_f32_16x16x32_bf16 v[8:11], v[116:119], v[24:27], v[8:11]
    v_mfma_f32_16x16x32_bf16 v[12:15], v[116:119], v[28:31], v[12:15]
    v_mfma_f32_16x16x32_bf16 v[208:211], v[188:191], v[24:27], v[208:211]
    v_mfma_f32_16x16x32_bf16 v[212:215], v[188:191], v[28:31], v[212:215]
    ds_read_b128 v[24:27], v5 offset:40960
    ds_read_b128 v[28:31], v5 offset:59392
    s_waitcnt vmcnt(6) lgkmcnt(4)
    v_mfma_f32_16x16x32_bf16 v[8:11], v[120:123], v[32:35], v[8:11]
    v_mfma_f32_16x16x32_bf16 v[12:15], v[120:123], v[36:39], v[12:15]
    v_mfma_f32_16x16x32_bf16 v[208:211], v[192:195], v[32:35], v[208:211]
    v_mfma_f32_16x16x32_bf16 v[212:215], v[192:195], v[36:39], v[212:215]
    ds_read_b128 v[32:35], v5 offset:41984
    ds_read_b128 v[36:39], v5 offset:60416
    s_waitcnt lgkmcnt(4)
    v_mfma_f32_16x16x32_bf16 v[8:11], v[124:127], v[16:19], v[8:11]
    v_mfma_f32_16x16x32_bf16 v[12:15], v[124:127], v[20:23], v[12:15]
    v_mfma_f32_16x16x32_bf16 v[208:211], v[196:199], v[16:19], v[208:211]
    v_mfma_f32_16x16x32_bf16 v[212:215], v[196:199], v[20:23], v[212:215]
    s_waitcnt vmcnt(2) lgkmcnt(2)
    v_mfma_f32_16x16x32_bf16 v[8:11], v[128:131], v[24:27], v[8:11]
    v_mfma_f32_16x16x32_bf16 v[12:15], v[128:131], v[28:31], v[12:15]
    v_mfma_f32_16x16x32_bf16 v[208:211], v[200:203], v[24:27], v[208:211]
    v_mfma_f32_16x16x32_bf16 v[212:215], v[200:203], v[28:31], v[212:215]
    s_waitcnt lgkmcnt(0)
    v_mfma_f32_16x16x32_bf16 v[8:11], v[132:135], v[32:35], v[8:11]
    v_mfma_f32_16x16x32_bf16 v[12:15], v[132:135], v[36:39], v[12:15]
    v_mfma_f32_16x16x32_bf16 v[208:211], v[204:207], v[32:35], v[208:211]
    v_mfma_f32_16x16x32_bf16 v[212:215], v[204:207], v[36:39], v[212:215]
G_MLD:
    s_waitcnt vmcnt(0)
    s_barrier
    v_mul_u32_u24 v40, 288, v3
    v_lshl_add_u32 v40, v4, 3, v40
    s_lshl_b32 s33, s22, 5
    s_add_u32 s33, s33, 61440
    v_add_u32 v40, s33, v40
    v_lshrrev_b32 v41, 2, v3
    v_lshl_add_u32 v41, v4, 2, v41
    v_lshlrev_b32 v41, 6, v41
    v_and_b32 v42, 3, v1
    v_lshl_add_u32 v41, v42, 3, v41
    s_lshl_b32 s33, s22, 10
    s_add_u32 s33, s33, 70656
    v_add_u32 v41, s33, v41
    ds_read_b64 v[44:45], v40 offset:0
    ds_read_b64 v[46:47], v40 offset:4608
    ds_read_b64_tr_b16 v[48:49], v41 offset:0
    ds_read_b64_tr_b16 v[50:51], v41 offset:32
    s_cmp_lg_u32 s22, 7
    s_cbranch_scc1 G_NBr
    ds_read_b64 v[216:217], v40 offset:32
    ds_read_b64 v[218:219], v40 offset:4640
    ds_read_b64_tr_b16 v[220:221], v41 offset:1024
    ds_read_b64_tr_b16 v[222:223], v41 offset:1056
G_NBr:
    s_waitcnt lgkmcnt(0)
    s_nop 3
    v_lshlrev_b32 v52, 16, v44
    v_and_b32 v53, 0xffff0000, v44
    v_lshlrev_b32 v54, 16, v45
    v_and_b32 v55, 0xffff0000, v45
    v_add_f32 v8, v8, v52
    v_add_f32 v9, v9, v53
    v_add_f32 v10, v10, v54
    v_add_f32 v11, v11, v55
    v_cvt_pk_bf16_f32 v56, v8, v9
    v_cvt_pk_bf16_f32 v57, v10, v11
    v_lshlrev_b32 v8, 16, v56
    v_and_b32 v9, 0xffff0000, v56
    v_lshlrev_b32 v10, 16, v57
    v_and_b32 v11, 0xffff0000, v57
    v_lshlrev_b32 v52, 16, v46
    v_and_b32 v53, 0xffff0000, v46
    v_lshlrev_b32 v54, 16, v47
    v_and_b32 v55, 0xffff0000, v47
    v_add_f32 v12, v12, v52
    v_add_f32 v13, v13, v53
    v_add_f32 v14, v14, v54
    v_add_f32 v15, v15, v55
    v_cvt_pk_bf16_f32 v56, v12, v13
    v_cvt_pk_bf16_f32 v57, v14, v15
    v_lshlrev_b32 v12, 16, v56
    v_and_b32 v13, 0xffff0000, v56
    v_lshlrev_b32 v14, 16, v57
    v_and_b32 v15, 0xffff0000, v57
    s_cmp_lg_u32 s22, 7
    s_cbranch_scc1 G_NBx
    v_lshlrev_b32 v52, 16, v216
    v_and_b32 v53, 0xffff0000, v216
    v_lshlrev_b32 v54, 16, v217
    v_and_b32 v55, 0xffff0000, v217
    v_add_f32 v208, v208, v52
    v_add_f32 v209, v209, v53
    v_add_f32 v210, v210, v54
    v_add_f32 v211, v211, v55
    v_cvt_pk_bf16_f32 v56, v208, v209
    v_cvt_pk_bf16_f32 v57, v210, v211
    v_lshlrev_b32 v208, 16, v56
    v_and_b32 v209, 0xffff0000, v56
    v_lshlrev_b32 v210, 16, v57
    v_and_b32 v211, 0xffff0000, v57
    v_lshlrev_b32 v52, 16, v218
    v_and_b32 v53, 0xffff0000, v218
    v_lshlrev_b32 v54, 16, v219
    v_and_b32 v55, 0xffff0000, v219
    v_add_f32 v212, v212, v52
    v_add_f32 v213, v213, v53
    v_add_f32 v214, v214, v54
    v_add_f32 v215, v215, v55
    v_cvt_pk_bf16_f32 v56, v212, v213
    v_cvt_pk_bf16_f32 v57, v214, v215
    v_lshlrev_b32 v212, 16, v56
    v_and_b32 v213, 0xffff0000, v56
    v_lshlrev_b32 v214, 16, v57
    v_and_b32 v215, 0xffff0000, v57
G_NBx:
    v_add_f32 v16, v8, v9
    v_mul_f32 v17, v8, v8
    v_add_f32 v16, v16, v10
    v_add_f32 v16, v16, v11
    v_fmac_f32 v17, v9, v9
    v_fmac_f32 v17, v10, v10
    v_fmac_f32 v17, v11, v11
    v_add_f32 v18, v12, v13
    v_mul_f32 v19, v12, v12
    v_add_f32 v18, v18, v14
    v_add_f32 v18, v18, v15
    v_fmac_f32 v19, v13, v13
    v_fmac_f32 v19, v14, v14
    v_fmac_f32 v19, v15, v15
    s_cmp_lg_u32 s22, 7
    s_cbranch_scc1 G_NBsa
    v_add_f32 v16, v16, v208
    v_add_f32 v16, v16, v209
    v_fmac_f32 v17, v208, v208
    v_add_f32 v16, v16, v210
    v_add_f32 v16, v16, v211
    v_fmac_f32 v17, v209, v209
    v_fmac_f32 v17, v210, v210
    v_fmac_f32 v17, v211, v211
    v_add_f32 v18, v18, v212
    v_add_f32 v18, v18, v213
    v_fmac_f32 v19, v212, v212
    v_add_f32 v18, v18, v214
    v_add_f32 v18, v18, v215
    v_fmac_f32 v19, v213, v213
    v_fmac_f32 v19, v214, v214
    v_fmac_f32 v19, v215, v215
G_NBsa:
    v_mov_b32 v52, v16
    v_mov_b32 v53, v17
    v_mov_b32 v54, v18
    v_mov_b32 v55, v19
    v_permlane16_swap_b32 v16, v52
    v_permlane16_swap_b32 v17, v53
    v_permlane16_swap_b32 v18, v54
    v_permlane16_swap_b32 v19, v55
    v_add_f32 v16, v16, v52
    v_add_f32 v17, v17, v53
    v_add_f32 v18, v18, v54
    v_add_f32 v19, v19, v55
    v_mov_b32 v52, v16
    v_mov_b32 v53, v17
    v_mov_b32 v54, v18
    v_mov_b32 v55, v19
    v_permlane32_swap_b32 v16, v52
    v_permlane32_swap_b32 v17, v53
    v_permlane32_swap_b32 v18, v54
    v_permlane32_swap_b32 v19, v55
    v_add_f32 v16, v16, v52
    v_add_f32 v17, v17, v53
    v_add_f32 v18, v18, v54
    v_add_f32 v19, v19, v55
    s_lshl_b32 s33, s22, 8
    v_lshl_add_u32 v53, v3, 3, s33
    s_mov_b64 exec, 0xffff
    ds_write_b64 v53, v[16:17] offset:0
    ds_write_b64 v53, v[18:19] offset:128
    s_mov_b64 exec, -1
    s_waitcnt lgkmcnt(0)
    s_barrier
    s_cmp_lg_u32 s22, 0
    s_cbranch_scc1 G_WAITST
    v_and_b32 v54, 31, v1
    v_lshlrev_b32 v54, 3, v54
    ds_read_b64 v[22:23], v54 offset:0
    ds_read_b64 v[24:25], v54 offset:256
    ds_read_b64 v[26:27], v54 offset:512
    ds_read_b64 v[28:29], v54 offset:768
    ds_read_b64 v[30:31], v54 offset:1024
    ds_read_b64 v[32:33], v54 offset:1280
    ds_read_b64 v[34:35], v54 offset:1536
    ds_read_b64 v[36:37], v54 offset:1792
    s_waitcnt lgkmcnt(0)
    v_add_f32 v20, v22, v24
    v_add_f32 v21, v23, v25
    v_add_f32 v20, v20, v26
    v_add_f32 v21, v21, v27
    v_add_f32 v20, v20, v28
    v_add_f32 v21, v21, v29
    v_add_f32 v20, v20, v30
    v_add_f32 v21, v21, v31
    v_add_f32 v20, v20, v32
    v_add_f32 v21, v21, v33
    v_add_f32 v20, v20, v34
    v_add_f32 v21, v21, v35
    v_add_f32 v20, v20, v36
    v_add_f32 v21, v21, v37
    s_mul_i32 s33, s61, 131072
    s_lshl_b32 s35, s20, 11
    s_add_u32 s33, s33, s35
    s_add_u32 s33, s33, 29851648
    s_lshl_b32 s35, s21, 9
    s_add_u32 s35, s35, s33
    v_mov_b32 v24, v20
    v_mov_b32 v25, s60
    v_mov_b32 v26, v21
    v_mov_b32 v27, s60
    v_lshlrev_b32 v55, 1, v54
    s_mov_b32 exec_hi, 0
    buffer_store_dwordx4 v[24:27], v55, s[12:15], s35 offen sc1
    s_mov_b32 exec_hi, -1
    v_lshrrev_b32 v56, 5, v1
    v_lshl_add_u32 v55, v56, 9, v55
    s_mov_b32 s58, 0
G_EX:
    buffer_load_dwordx4 v[24:27], v55, s[12:15], s33 offen sc1
    buffer_load_dwordx4 v[28:31], v55, s[12:15], s33 offen offset:1024 sc1
    s_waitcnt vmcnt(0)
    v_cmp_eq_u32 vcc, s60, v25
    v_cmp_eq_u32 s[56:57], s60, v27
    s_nop 1
    s_and_b64 vcc, vcc, s[56:57]
    v_cmp_eq_u32 s[56:57], s60, v29
    s_nop 1
    s_and_b64 vcc, vcc, s[56:57]
    v_cmp_eq_u32 s[56:57], s60, v31
    s_nop 1
    s_and_b64 vcc, vcc, s[56:57]
    s_nop 1
    s_cmp_eq_u64 vcc, -1
    s_cbranch_scc1 G_EX_OK
    s_sleep 2
    s_add_u32 s58, s58, 1
    s_cmp_lt_u32 s58, 131072
    s_cbranch_scc1 G_EX
G_EX_OK:
    v_add_f32 v22, v24, v28
    v_add_f32 v23, v26, v30
    v_mov_b32 v24, v22
    s_nop 1
    v_permlane32_swap_b32 v22, v24
    s_nop 1
    v_add_f32 v22, v22, v24
    v_mov_b32 v24, v23
    s_nop 1
    v_permlane32_swap_b32 v23, v24
    s_nop 1
    v_add_f32 v23, v23, v24
    v_mul_f32 v22, 0x3ae38e39, v22
    v_mul_f32 v23, 0x3ae38e39, v23
    v_fma_f32 v23, -v22, v22, v23
    v_max_f32 v23, 0, v23
    v_add_f32 v23, 0x3727c5ac, v23
    v_rsq_f32 v23, v23
    s_nop 0
    ds_write_b64 v54, v[22:23] offset:2048
    s_waitcnt lgkmcnt(0)
G_WAITST:
    s_barrier
    v_lshlrev_b32 v53, 3, v3
    ds_read_b64 v[24:25], v53 offset:2048
    ds_read_b64 v[26:27], v53 offset:2176
    s_waitcnt lgkmcnt(0)
    v_lshlrev_b32 v52, 16, v48
    v_and_b32 v53, 0xffff0000, v48
    v_lshlrev_b32 v54, 16, v49
    v_and_b32 v55, 0xffff0000, v49
    v_sub_f32 v56, v8, v24
    v_mul_f32 v56, v56, v25
    v_fmac_f32 v8, v56, v52
    v_sub_f32 v56, v9, v24
    v_mul_f32 v56, v56, v25
    v_fmac_f32 v9, v56, v53
    v_sub_f32 v56, v10, v24
    v_mul_f32 v56, v56, v25
    v_fmac_f32 v10, v56, v54
    v_sub_f32 v56, v11, v24
    v_mul_f32 v56, v56, v25
    v_fmac_f32 v11, v56, v55
    v_cvt_pk_bf16_f32 v44, v8, v9
    v_cvt_pk_bf16_f32 v45, v10, v11
    v_lshlrev_b32 v52, 16, v50
    v_and_b32 v53, 0xffff0000, v50
    v_lshlrev_b32 v54, 16, v51
    v_and_b32 v55, 0xffff0000, v51
    v_sub_f32 v56, v12, v26
    v_mul_f32 v56, v56, v27
    v_fmac_f32 v12, v56, v52
    v_sub_f32 v56, v13, v26
    v_mul_f32 v56, v56, v27
    v_fmac_f32 v13, v56, v53
    v_sub_f32 v56, v14, v26
    v_mul_f32 v56, v56, v27
    v_fmac_f32 v14, v56, v54
    v_sub_f32 v56, v15, v26
    v_mul_f32 v56, v56, v27
    v_fmac_f32 v15, v56, v55
    v_cvt_pk_bf16_f32 v46, v12, v13
    v_cvt_pk_bf16_f32 v47, v14, v15
    ds_write_b64 v40, v[44:45] offset:0
    ds_write_b64 v40, v[46:47] offset:4608
    s_cmp_lg_u32 s22, 7
    s_cbranch_scc1 G_NBg
    v_lshlrev_b32 v52, 16, v220
    v_and_b32 v53, 0xffff0000, v220
    v_lshlrev_b32 v54, 16, v221
    v_and_b32 v55, 0xffff0000, v221
    v_sub_f32 v56, v208, v24
    v_mul_f32 v56, v56, v25
    v_fmac_f32 v208, v56, v52
    v_sub_f32 v56, v209, v24
    v_mul_f32 v56, v56, v25
    v_fmac_f32 v209, v56, v53
    v_sub_f32 v56, v210, v24
    v_mul_f32 v56, v56, v25
    v_fmac_f32 v210, v56, v54
    v_sub_f32 v56, v211, v24
    v_mul_f32 v56, v56, v25
    v_fmac_f32 v211, v56, v55
    v_cvt_pk_bf16_f32 v216, v208, v209
    v_cvt_pk_bf16_f32 v217, v210, v211
    v_lshlrev_b32 v52, 16, v222
    v_and_b32 v53, 0xffff0000, v222
    v_lshlrev_b32 v54, 16, v223
    v_and_b32 v55, 0xffff0000, v223
    v_sub_f32 v56, v212, v26
    v_mul_f32 v56, v56, v27
    v_fmac_f32 v212, v56, v52
    v_sub_f32 v56, v213, v26
    v_mul_f32 v56, v56, v27
    v_fmac_f32 v213, v56, v53
    v_sub_f32 v56, v214, v26
    v_mul_f32 v56, v56, v27
    v_fmac_f32 v214, v56, v54
    v_sub_f32 v56, v215, v26
    v_mul_f32 v56, v56, v27
    v_fmac_f32 v215, v56, v55
    v_cvt_pk_bf16_f32 v218, v212, v213
    v_cvt_pk_bf16_f32 v219, v214, v215
    ds_write_b64 v40, v[216:217] offset:32
    ds_write_b64 v40, v[218:219] offset:4640
G_NBg:
    s_waitcnt lgkmcnt(0)
    s_barrier
    v_lshlrev_b32 v53, 4, v0
    v_add_u32 v53, 61440, v53
    v_add_u32 v54, 69632, v5
    ds_read_b128 v[28:31], v53
    ds_read_b128 v[32:35], v54
    s_waitcnt lgkmcnt(0)
    buffer_store_dwordx4 v[28:31], v60, s[16:19], s32 offen sc1
    s_cmp_lg_u32 s22, 0
    s_cbranch_scc1 G_NS2
    buffer_store_dwordx4 v[32:35], v61, s[16:19], s32 offen sc1
G_NS2:
    s_cmp_lg_u32 s61, 0
    s_cbranch_scc1 M_FIN
    v_lshlrev_b32 v8, 16, v44
    v_and_b32 v9, 0xffff0000, v44
    v_lshlrev_b32 v10, 16, v45
    v_and_b32 v11, 0xffff0000, v45
    v_lshlrev_b32 v12, 16, v46
    v_and_b32 v13, 0xffff0000, v46
    v_lshlrev_b32 v14, 16, v47
    v_and_b32 v15, 0xffff0000, v47
    s_cmp_lg_u32 s22, 7
    s_cbranch_scc1 G_NBu
    v_lshlrev_b32 v208, 16, v216
    v_and_b32 v209, 0xffff0000, v216
    v_lshlrev_b32 v210, 16, v217
    v_and_b32 v211, 0xffff0000, v217
    v_lshlrev_b32 v212, 16, v218
    v_and_b32 v213, 0xffff0000, v218
    v_lshlrev_b32 v214, 16, v219
    v_and_b32 v215, 0xffff0000, v219
G_NBu:
    v_add_f32 v16, v8, v9
    v_mul_f32 v17, v8, v8
    v_add_f32 v16, v16, v10
    v_add_f32 v16, v16, v11
    v_fmac_f32 v17, v9, v9
    v_fmac_f32 v17, v10, v10
    v_fmac_f32 v17, v11, v11
    v_add_f32 v18, v12, v13
    v_mul_f32 v19, v12, v12
    v_add_f32 v18, v18, v14
    v_add_f32 v18, v18, v15
    v_fmac_f32 v19, v13, v13
    v_fmac_f32 v19, v14, v14
    v_fmac_f32 v19, v15, v15
    s_cmp_lg_u32 s22, 7
    s_cbranch_scc1 G_NBsb
    v_add_f32 v16, v16, v208
    v_add_f32 v16, v16, v209
    v_fmac_f32 v17, v208, v208
    v_add_f32 v16, v16, v210
    v_add_f32 v16, v16, v211
    v_fmac_f32 v17, v209, v209
    v_fmac_f32 v17, v210, v210
    v_fmac_f32 v17, v211, v211
    v_add_f32 v18, v18, v212
    v_add_f32 v18, v18, v213
    v_fmac_f32 v19, v212, v212
    v_add_f32 v18, v18, v214
    v_add_f32 v18, v18, v215
    v_fmac_f32 v19, v213, v213
    v_fmac_f32 v19, v214, v214
    v_fmac_f32 v19, v215, v215
G_NBsb:
    v_mov_b32 v52, v16
    v_mov_b32 v53, v17
    v_mov_b32 v54, v18
    v_mov_b32 v55, v19
    v_permlane16_swap_b32 v16, v52
    v_permlane16_swap_b32 v17, v53
    v_permlane16_swap_b32 v18, v54
    v_permlane16_swap_b32 v19, v55
    v_add_f32 v16, v16, v52
    v_add_f32 v17, v17, v53
    v_add_f32 v18, v18, v54
    v_add_f32 v19, v19, v55
    v_mov_b32 v52, v16
    v_mov_b32 v53, v17
    v_mov_b32 v54, v18
    v_mov_b32 v55, v19
    v_permlane32_swap_b32 v16, v52
    v_permlane32_swap_b32 v17, v53
    v_permlane32_swap_b32 v18, v54
    v_permlane32_swap_b32 v19, v55
    v_add_f32 v16, v16, v52
    v_add_f32 v17, v17, v53
    v_add_f32 v18, v18, v54
    v_add_f32 v19, v19, v55
    s_lshl_b32 s33, s22, 8
    v_lshl_add_u32 v53, v3, 3, s33
    s_mov_b64 exec, 0xffff
    ds_write_b64 v53, v[16:17] offset:0
    ds_write_b64 v53, v[18:19] offset:128
    s_mov_b64 exec, -1
    s_waitcnt vmcnt(0) lgkmcnt(0)
    s_barrier
    s_cmp_lg_u32 s22, 0
    s_cbranch_scc1 G_NST
    s_lshr_b32 s33, s20, 2
    s_lshl_b32 s33, s33, 4
    s_and_b32 s34, s20, 3
    s_lshl_b32 s34, s34, 2
    s_add_u32 s34, s34, s21
    s_add_u32 s33, s33, s34
    s_lshl_b32 s33, s33, 7
    s_add_u32 s33, s33, 31178752
    v_mov_b32 v52, s60
    v_mov_b32 v53, 0
    s_mov_b64 exec, 1
    buffer_store_dword v52, v53, s[12:15], s33 offen sc1
    s_mov_b64 exec, -1
    v_and_b32 v54, 31, v1
    v_lshlrev_b32 v54, 3, v54
    ds_read_b64 v[22:23], v54 offset:0
    ds_read_b64 v[24:25], v54 offset:256
    ds_read_b64 v[26:27], v54 offset:512
    ds_read_b64 v[28:29], v54 offset:768
    ds_read_b64 v[30:31], v54 offset:1024
    ds_read_b64 v[32:33], v54 offset:1280
    ds_read_b64 v[34:35], v54 offset:1536
    ds_read_b64 v[36:37], v54 offset:1792
    s_waitcnt lgkmcnt(0)
    v_add_f32 v20, v22, v24
    v_add_f32 v21, v23, v25
    v_add_f32 v20, v20, v26
    v_add_f32 v21, v21, v27
    v_add_f32 v20, v20, v28
    v_add_f32 v21, v21, v29
    v_add_f32 v20, v20, v30
    v_add_f32 v21, v21, v31
    v_add_f32 v20, v20, v32
    v_add_f32 v21, v21, v33
    v_add_f32 v20, v20, v34
    v_add_f32 v21, v21, v35
    v_add_f32 v20, v20, v36
    v_add_f32 v21, v21, v37
    v_mov_b32 v24, v20
    v_mov_b32 v25, s60
    v_mov_b32 v26, v21
    v_mov_b32 v27, s60
    v_and_b32 v54, 31, v1
    v_lshlrev_b32 v54, 6, v54
    s_lshl_b32 s33, s20, 11
    s_lshl_b32 s35, s21, 4
    s_add_u32 s33, s33, s35
    s_add_u32 s33, s33, 3227648
    s_mov_b32 exec_hi, 0
    buffer_store_dwordx4 v[24:27], v54, s[12:15], s33 offen sc1
    s_mov_b32 exec_hi, -1
G_NST:
    s_barrier
    s_and_b32 s20, s2, 7
    s_lshr_b32 s21, s2, 3
    s_lshr_b32 s23, s20, 1
    s_lshl_b32 s23, s23, 2
    s_lshr_b32 s24, s21, 3
    s_add_u32 s23, s23, s24
    s_and_b32 s24, s20, 1
    s_lshl_b32 s24, s24, 3
    s_and_b32 s25, s21, 7
    s_add_u32 s24, s24, s25
    s_and_b32 s25, s22, 3
    s_mul_i32 s26, s23, 147456
    s_lshl_b32 s28, s24, 2
    s_add_u32 s28, s28, s25
    s_mul_i32 s28, s28, 36864
    s_lshl_b32 s29, s25, 12
    s_and_b32 s27, s24, 7
    s_and_b32 s30, s23, 3
    s_lshl_b32 s30, s30, 1
    s_add_u32 s27, s27, s30
    s_sub_u32 s30, s27, 9
    s_cmp_ge_u32 s27, 9
    s_cselect_b32 s27, s30, s27
    v_and_b32 v1, 63, v0
    v_lshlrev_b32 v248, 4, v1
    v_and_b32 v249, 31, v1
    v_lshrrev_b32 v250, 5, v1
    s_cmp_ge_u32 s22, 4
    s_cbranch_scc1 B_HELP
    s_barrier
    s_add_u32 s31, s27, 0
    s_sub_u32 s33, s31, 9
    s_cmp_ge_u32 s31, 9
    s_cselect_b32 s31, s33, s31
    s_lshl_b32 s31, s31, 12
    s_add_u32 s31, s31, s28
    buffer_load_dwordx4 v[8:11], v248, s[12:15], s31 offen offset:0 sc1
    buffer_load_dwordx4 v[12:15], v248, s[12:15], s31 offen offset:1024 sc1
    buffer_load_dwordx4 v[16:19], v248, s[12:15], s31 offen offset:2048 sc1
    buffer_load_dwordx4 v[20:23], v248, s[12:15], s31 offen offset:3072 sc1
    s_add_u32 s31, s27, 1
    s_sub_u32 s33, s31, 9
    s_cmp_ge_u32 s31, 9
    s_cselect_b32 s31, s33, s31
    s_lshl_b32 s31, s31, 12
    s_add_u32 s31, s31, s28
    buffer_load_dwordx4 v[24:27], v248, s[12:15], s31 offen offset:0 sc1
    buffer_load_dwordx4 v[28:31], v248, s[12:15], s31 offen offset:1024 sc1
    buffer_load_dwordx4 v[32:35], v248, s[12:15], s31 offen offset:2048 sc1
    buffer_load_dwordx4 v[36:39], v248, s[12:15], s31 offen offset:3072 sc1
    s_add_u32 s31, s27, 2
    s_sub_u32 s33, s31, 9
    s_cmp_ge_u32 s31, 9
    s_cselect_b32 s31, s33, s31
    s_lshl_b32 s31, s31, 12
    s_add_u32 s31, s31, s28
    buffer_load_dwordx4 v[40:43], v248, s[12:15], s31 offen offset:0 sc1
    buffer_load_dwordx4 v[44:47], v248, s[12:15], s31 offen offset:1024 sc1
    buffer_load_dwordx4 v[48:51], v248, s[12:15], s31 offen offset:2048 sc1
    buffer_load_dwordx4 v[52:55], v248, s[12:15], s31 offen offset:3072 sc1
    s_add_u32 s31, s27, 3
    s_sub_u32 s33, s31, 9
    s_cmp_ge_u32 s31, 9
    s_cselect_b32 s31, s33, s31
    s_lshl_b32 s31, s31, 12
    s_add_u32 s31, s31, s28
    buffer_load_dwordx4 v[56:59], v248, s[12:15], s31 offen offset:0 sc1
    buffer_load_dwordx4 v[60:63], v248, s[12:15], s31 offen offset:1024 sc1
    buffer_load_dwordx4 v[64:67], v248, s[12:15], s31 offen offset:2048 sc1
    buffer_load_dwordx4 v[68:71], v248, s[12:15], s31 offen offset:3072 sc1
    s_add_u32 s31, s27, 4
    s_sub_u32 s33, s31, 9
    s_cmp_ge_u32 s31, 9
    s_cselect_b32 s31, s33, s31
    s_lshl_b32 s31, s31, 12
    s_add_u32 s31, s31, s28
    buffer_load_dwordx4 v[72:75], v248, s[12:15], s31 offen offset:0 sc1
    buffer_load_dwordx4 v[76:79], v248, s[12:15], s31 offen offset:1024 sc1
    buffer_load_dwordx4 v[80:83], v248, s[12:15], s31 offen offset:2048 sc1
    buffer_load_dwordx4 v[84:87], v248, s[12:15], s31 offen offset:3072 sc1
    s_add_u32 s31, s27, 5
    s_sub_u32 s33, s31, 9
    s_cmp_ge_u32 s31, 9
    s_cselect_b32 s31, s33, s31
    s_lshl_b32 s31, s31, 12
    s_add_u32 s31, s31, s28
    buffer_load_dwordx4 v[88:91], v248, s[12:15], s31 offen offset:0 sc1
    buffer_load_dwordx4 v[92:95], v248, s[12:15], s31 offen offset:1024 sc1
    buffer_load_dwordx4 v[96:99], v248, s[12:15], s31 offen offset:2048 sc1
    buffer_load_dwordx4 v[100:103], v248, s[12:15], s31 offen offset:3072 sc1
    v_bfe_u32 v251, v249, 1, 3
    v_add_u32 v252, 0, v250
    v_xor_b32 v252, v252, v251
    v_lshlrev_b32 v252, 4, v252
    v_lshl_add_u32 v2, v249, 7, v252
    v_add_u32 v2, 2560, v2
    v_add_u32 v252, 2, v250
    v_xor_b32 v252, v252, v251
    v_lshlrev_b32 v252, 4, v252
    v_lshl_add_u32 v3, v249, 7, v252
    v_add_u32 v3, 2560, v3
    v_add_u32 v252, 4, v250
    v_xor_b32 v252, v252, v251
    v_lshlrev_b32 v252, 4, v252
    v_lshl_add_u32 v4, v249, 7, v252
    v_add_u32 v4, 2560, v4
    v_add_u32 v252, 6, v250
    v_xor_b32 v252, v252, v251
    v_lshlrev_b32 v252, 4, v252
    v_lshl_add_u32 v5, v249, 7, v252
    v_add_u32 v5, 2560, v5
    s_setprio 2
    v_mov_b32 v152, 0
    v_mov_b32 v153, 0
    v_mov_b32 v154, 0
    v_mov_b32 v155, 0
    v_mov_b32 v156, 0
    v_mov_b32 v157, 0
    v_mov_b32 v158, 0
    v_mov_b32 v159, 0
    v_mov_b32 v160, 0
    v_mov_b32 v161, 0
    v_mov_b32 v162, 0
    v_mov_b32 v163, 0
    v_mov_b32 v164, 0
    v_mov_b32 v165, 0
    v_mov_b32 v166, 0
    v_mov_b32 v167, 0
    v_mov_b32 v168, 0
    v_mov_b32 v169, 0
    v_mov_b32 v170, 0
    v_mov_b32 v171, 0
    v_mov_b32 v172, 0
    v_mov_b32 v173, 0
    v_mov_b32 v174, 0
    v_mov_b32 v175, 0
    v_mov_b32 v176, 0
    v_mov_b32 v177, 0
    v_mov_b32 v178, 0
    v_mov_b32 v179, 0
    v_mov_b32 v180, 0
    v_mov_b32 v181, 0
    v_mov_b32 v182, 0
    v_mov_b32 v183, 0
    v_mov_b32 v184, 0
    v_mov_b32 v185, 0
    v_mov_b32 v186, 0
    v_mov_b32 v187, 0
    v_mov_b32 v188, 0
    v_mov_b32 v189, 0
    v_mov_b32 v190, 0
    v_mov_b32 v191, 0
    v_mov_b32 v192, 0
    v_mov_b32 v193, 0
    v_mov_b32 v194, 0
    v_mov_b32 v195, 0
    v_mov_b32 v196, 0
    v_mov_b32 v197, 0
    v_mov_b32 v198, 0
    v_mov_b32 v199, 0
    v_mov_b32 v200, 0
    v_mov_b32 v201, 0
    v_mov_b32 v202, 0
    v_mov_b32 v203, 0
    v_mov_b32 v204, 0
    v_mov_b32 v205, 0
    v_mov_b32 v206, 0
    v_mov_b32 v207, 0
    v_mov_b32 v208, 0
    v_mov_b32 v209, 0
    v_mov_b32 v210, 0
    v_mov_b32 v211, 0
    v_mov_b32 v212, 0
    v_mov_b32 v213, 0
    v_mov_b32 v214, 0
    v_mov_b32 v215, 0
    s_cmp_eq_u32 s25, 2
    s_cbranch_scc1 B_KSW
    s_barrier
    ds_read_b128 v[216:219], v2 offset:0
    ds_read_b128 v[220:223], v2 offset:4096
    ds_read_b128 v[224:227], v2 offset:8192
    ds_read_b128 v[228:231], v2 offset:12288
    s_waitcnt vmcnt(23) lgkmcnt(3)
    v_mfma_f32_32x32x16_bf16 v[152:167], v[8:11], v[216:219], v[152:167]
    ds_read_b128 v[232:235], v3 offset:0
    s_waitcnt lgkmcnt(3)
    v_mfma_f32_32x32x16_bf16 v[168:183], v[8:11], v[220:223], v[168:183]
    ds_read_b128 v[236:239], v3 offset:4096
    s_add_u32 s31, s27, 6
    s_sub_u32 s33, s31, 9
    s_cmp_ge_u32 s31, 9
    s_cselect_b32 s31, s33, s31
    s_lshl_b32 s31, s31, 12
    s_add_u32 s31, s31, s28
    buffer_load_dwordx4 v[104:107], v248, s[12:15], s31 offen offset:0 sc1
    s_waitcnt lgkmcnt(3)
    v_mfma_f32_32x32x16_bf16 v[184:199], v[8:11], v[224:227], v[184:199]
    ds_read_b128 v[240:243], v3 offset:8192
    s_waitcnt lgkmcnt(3)
    v_mfma_f32_32x32x16_bf16 v[200:215], v[8:11], v[228:231], v[200:215]
    ds_read_b128 v[244:247], v3 offset:12288
    s_waitcnt vmcnt(23) lgkmcnt(3)
    v_mfma_f32_32x32x16_bf16 v[152:167], v[12:15], v[232:235], v[152:167]
    ds_read_b128 v[216:219], v4 offset:0
    s_waitcnt lgkmcnt(3)
    v_mfma_f32_32x32x16_bf16 v[168:183], v[12:15], v[236:239], v[168:183]
    ds_read_b128 v[220:223], v4 offset:4096
    buffer_load_dwordx4 v[108:111], v248, s[12:15], s31 offen offset:1024 sc1
    s_waitcnt lgkmcnt(3)
    v_mfma_f32_32x32x16_bf16 v[184:199], v[12:15], v[240:243], v[184:199]
    ds_read_b128 v[224:227], v4 offset:8192
    s_waitcnt lgkmcnt(3)
    v_mfma_f32_32x32x16_bf16 v[200:215], v[12:15], v[244:247], v[200:215]
    ds_read_b128 v[228:231], v4 offset:12288
    s_waitcnt vmcnt(23) lgkmcnt(3)
    v_mfma_f32_32x32x16_bf16 v[152:167], v[16:19], v[216:219], v[152:167]
    ds_read_b128 v[232:235], v5 offset:0
    s_waitcnt lgkmcnt(3)
    v_mfma_f32_32x32x16_bf16 v[168:183], v[16:19], v[220:223], v[168:183]
    ds_read_b128 v[236:239], v5 offset:4096
    buffer_load_dwordx4 v[112:115], v248, s[12:15], s31 offen offset:2048 sc1
    s_waitcnt lgkmcnt(3)
    v_mfma_f32_32x32x16_bf16 v[184:199], v[16:19], v[224:227], v[184:199]
    ds_read_b128 v[240:243], v5 offset:8192
    s_waitcnt lgkmcnt(3)
    v_mfma_f32_32x32x16_bf16 v[200:215], v[16:19], v[228:231], v[200:215]
    ds_read_b128 v[244:247], v5 offset:12288
    s_waitcnt vmcnt(23) lgkmcnt(3)
    v_mfma_f32_32x32x16_bf16 v[152:167], v[20:23], v[232:235], v[152:167]
    s_barrier
    ds_read_b128 v[216:219], v2 offset:16384
    s_waitcnt lgkmcnt(3)
    v_mfma_f32_32x32x16_bf16 v[168:183], v[20:23], v[236:239], v[168:183]
    ds_read_b128 v[220:223], v2 offset:20480
    buffer_load_dwordx4 v[116:119], v248, s[12:15], s31 offen offset:3072 sc1
    s_waitcnt lgkmcnt(3)
    v_mfma_f32_32x32x16_bf16 v[184:199], v[20:23], v[240:243], v[184:199]
    ds_read_b128 v[224:227], v2 offset:24576
    s_waitcnt lgkmcnt(3)
    v_mfma_f32_32x32x16_bf16 v[200:215], v[20:23], v[244:247], v[200:215]
    ds_read_b128 v[228:231], v2 offset:28672
    s_waitcnt vmcnt(23) lgkmcnt(3)
    v_mfma_f32_32x32x16_bf16 v[152:167], v[24:27], v[216:219], v[152:167]
    ds_read_b128 v[232:235], v3 offset:16384
    s_waitcnt lgkmcnt(3)
    v_mfma_f32_32x32x16_bf16 v[168:183], v[24:27], v[220:223], v[168:183]
    ds_read_b128 v[236:239], v3 offset:20480
    s_add_u32 s31, s27, 7
    s_sub_u32 s33, s31, 9
    s_cmp_ge_u32 s31, 9
    s_cselect_b32 s31, s33, s31
    s_lshl_b32 s31, s31, 12
    s_add_u32 s31, s31, s28
    buffer_load_dwordx4 v[120:123], v248, s[12:15], s31 offen offset:0 sc1
    s_waitcnt lgkmcnt(3)
    v_mfma_f32_32x32x16_bf16 v[184:199], v[24:27], v[224:227], v[184:199]
    ds_read_b128 v[240:243], v3 offset:24576
    s_waitcnt lgkmcnt(3)
    v_mfma_f32_32x32x16_bf16 v[200:215], v[24:27], v[228:231], v[200:215]
    ds_read_b128 v[244:247], v3 offset:28672
    s_waitcnt vmcnt(23) lgkmcnt(3)
    v_mfma_f32_32x32x16_bf16 v[152:167], v[28:31], v[232:235], v[152:167]
    ds_read_b128 v[216:219], v4 offset:16384
    s_waitcnt lgkmcnt(3)
    v_mfma_f32_32x32x16_bf16 v[168:183], v[28:31], v[236:239], v[168:183]
    ds_read_b128 v[220:223], v4 offset:20480
    buffer_load_dwordx4 v[124:127], v248, s[12:15], s31 offen offset:1024 sc1
    s_waitcnt lgkmcnt(3)
    v_mfma_f32_32x32x16_bf16 v[184:199], v[28:31], v[240:243], v[184:199]
    ds_read_b128 v[224:227], v4 offset:24576
    s_waitcnt lgkmcnt(3)
    v_mfma_f32_32x32x16_bf16 v[200:215], v[28:31], v[244:247], v[200:215]
    ds_read_b128 v[228:231], v4 offset:28672
    s_waitcnt vmcnt(23) lgkmcnt(3)
    v_mfma_f32_32x32x16_bf16 v[152:167], v[32:35], v[216:219], v[152:167]
    ds_read_b128 v[232:235], v5 offset:16384
    s_waitcnt lgkmcnt(3)
    v_mfma_f32_32x32x16_bf16 v[168:183], v[32:35], v[220:223], v[168:183]
    ds_read_b128 v[236:239], v5 offset:20480
    buffer_load_dwordx4 v[128:131], v248, s[12:15], s31 offen offset:2048 sc1
    s_waitcnt lgkmcnt(3)
    v_mfma_f32_32x32x16_bf16 v[184:199], v[32:35], v[224:227], v[184:199]
    ds_read_b128 v[240:243], v5 offset:24576
    s_waitcnt lgkmcnt(3)
    v_mfma_f32_32x32x16_bf16 v[200:215], v[32:35], v[228:231], v[200:215]
    ds_read_b128 v[244:247], v5 offset:28672
    s_waitcnt vmcnt(23) lgkmcnt(3)
    v_mfma_f32_32x32x16_bf16 v[152:167], v[36:39], v[232:235], v[152:167]
    s_barrier
    ds_read_b128 v[216:219], v2 offset:32768
    s_waitcnt lgkmcnt(3)
    v_mfma_f32_32x32x16_bf16 v[168:183], v[36:39], v[236:239], v[168:183]
    ds_read_b128 v[220:223], v2 offset:36864
    buffer_load_dwordx4 v[132:135], v248, s[12:15], s31 offen offset:3072 sc1
    s_waitcnt lgkmcnt(3)
    v_mfma_f32_32x32x16_bf16 v[184:199], v[36:39], v[240:243], v[184:199]
    ds_read_b128 v[224:227], v2 offset:40960
    s_waitcnt lgkmcnt(3)
    v_mfma_f32_32x32x16_bf16 v[200:215], v[36:39], v[244:247], v[200:215]
    ds_read_b128 v[228:231], v2 offset:45056
    s_waitcnt vmcnt(23) lgkmcnt(3)
    v_mfma_f32_32x32x16_bf16 v[152:167], v[40:43], v[216:219], v[152:167]
    ds_read_b128 v[232:235], v3 offset:32768
    s_waitcnt lgkmcnt(3)
    v_mfma_f32_32x32x16_bf16 v[168:183], v[40:43], v[220:223], v[168:183]
    ds_read_b128 v[236:239], v3 offset:36864
    s_add_u32 s31, s27, 8
    s_sub_u32 s33, s31, 9
    s_cmp_ge_u32 s31, 9
    s_cselect_b32 s31, s33, s31
    s_lshl_b32 s31, s31, 12
    s_add_u32 s31, s31, s28
    buffer_load_dwordx4 v[136:139], v248, s[12:15], s31 offen offset:0 sc1
    s_waitcnt lgkmcnt(3)
    v_mfma_f32_32x32x16_bf16 v[184:199], v[40:43], v[224:227], v[184:199]
    ds_read_b128 v[240:243], v3 offset:40960
    s_waitcnt lgkmcnt(3)
    v_mfma_f32_32x32x16_bf16 v[200:215], v[40:43], v[228:231], v[200:215]
    ds_read_b128 v[244:247], v3 offset:45056
    s_waitcnt vmcnt(23) lgkmcnt(3)
    v_mfma_f32_32x32x16_bf16 v[152:167], v[44:47], v[232:235], v[152:167]
    ds_read_b128 v[216:219], v4 offset:32768
    s_waitcnt lgkmcnt(3)
    v_mfma_f32_32x32x16_bf16 v[168:183], v[44:47], v[236:239], v[168:183]
    ds_read_b128 v[220:223], v4 offset:36864
    buffer_load_dwordx4 v[140:143], v248, s[12:15], s31 offen offset:1024 sc1
    s_waitcnt lgkmcnt(3)
    v_mfma_f32_32x32x16_bf16 v[184:199], v[44:47], v[240:243], v[184:199]
    ds_read_b128 v[224:227], v4 offset:40960
    s_waitcnt lgkmcnt(3)
    v_mfma_f32_32x32x16_bf16 v[200:215], v[44:47], v[244:247], v[200:215]
    ds_read_b128 v[228:231], v4 offset:45056
    s_waitcnt vmcnt(23) lgkmcnt(3)
    v_mfma_f32_32x32x16_bf16 v[152:167], v[48:51], v[216:219], v[152:167]
    ds_read_b128 v[232:235], v5 offset:32768
    s_waitcnt lgkmcnt(3)
    v_mfma_f32_32x32x16_bf16 v[168:183], v[48:51], v[220:223], v[168:183]
    ds_read_b128 v[236:239], v5 offset:36864
    buffer_load_dwordx4 v[144:147], v248, s[12:15], s31 offen offset:2048 sc1
    s_waitcnt lgkmcnt(3)
    v_mfma_f32_32x32x16_bf16 v[184:199], v[48:51], v[224:227], v[184:199]
    ds_read_b128 v[240:243], v5 offset:40960
    s_waitcnt lgkmcnt(3)
    v_mfma_f32_32x32x16_bf16 v[200:215], v[48:51], v[228:231], v[200:215]
    ds_read_b128 v[244:247], v5 offset:45056
    s_waitcnt vmcnt(23) lgkmcnt(3)
    v_mfma_f32_32x32x16_bf16 v[152:167], v[52:55], v[232:235], v[152:167]
    s_barrier
    ds_read_b128 v[216:219], v2 offset:49152
    s_waitcnt lgkmcnt(3)
    v_mfma_f32_32x32x16_bf16 v[168:183], v[52:55], v[236:239], v[168:183]
    ds_read_b128 v[220:223], v2 offset:53248
    buffer_load_dwordx4 v[148:151], v248, s[12:15], s31 offen offset:3072 sc1
    s_waitcnt lgkmcnt(3)
    v_mfma_f32_32x32x16_bf16 v[184:199], v[52:55], v[240:243], v[184:199]
    ds_read_b128 v[224:227], v2 offset:57344
    s_waitcnt lgkmcnt(3)
    v_mfma_f32_32x32x16_bf16 v[200:215], v[52:55], v[244:247], v[200:215]
    ds_read_b128 v[228:231], v2 offset:61440
    s_waitcnt vmcnt(23) lgkmcnt(3)
    v_mfma_f32_32x32x16_bf16 v[152:167], v[56:59], v[216:219], v[152:167]
    ds_read_b128 v[232:235], v3 offset:49152
    s_waitcnt lgkmcnt(3)
    v_mfma_f32_32x32x16_bf16 v[168:183], v[56:59], v[220:223], v[168:183]
    ds_read_b128 v[236:239], v3 offset:53248
    s_waitcnt lgkmcnt(3)
    v_mfma_f32_32x32x16_bf16 v[184:199], v[56:59], v[224:227], v[184:199]
    ds_read_b128 v[240:243], v3 offset:57344
    s_waitcnt lgkmcnt(3)
    v_mfma_f32_32x32x16_bf16 v[200:215], v[56:59], v[228:231], v[200:215]
    ds_read_b128 v[244:247], v3 offset:61440
    s_waitcnt vmcnt(22) lgkmcnt(3)
    v_mfma_f32_32x32x16_bf16 v[152:167], v[60:63], v[232:235], v[152:167]
    ds_read_b128 v[216:219], v4 offset:49152
    s_waitcnt lgkmcnt(3)
    v_mfma_f32_32x32x16_bf16 v[168:183], v[60:63], v[236:239], v[168:183]
    ds_read_b128 v[220:223], v4 offset:53248
    s_waitcnt lgkmcnt(3)
    v_mfma_f32_32x32x16_bf16 v[184:199], v[60:63], v[240:243], v[184:199]
    ds_read_b128 v[224:227], v4 offset:57344
    s_waitcnt lgkmcnt(3)
    v_mfma_f32_32x32x16_bf16 v[200:215], v[60:63], v[244:247], v[200:215]
    ds_read_b128 v[228:231], v4 offset:61440
    s_waitcnt vmcnt(21) lgkmcnt(3)
    v_mfma_f32_32x32x16_bf16 v[152:167], v[64:67], v[216:219], v[152:167]
    ds_read_b128 v[232:235], v5 offset:49152
    s_waitcnt lgkmcnt(3)
    v_mfma_f32_32x32x16_bf16 v[168:183], v[64:67], v[220:223], v[168:183]
    ds_read_b128 v[236:239], v5 offset:53248
    s_waitcnt lgkmcnt(3)
    v_mfma_f32_32x32x16_bf16 v[184:199], v[64:67], v[224:227], v[184:199]
    ds_read_b128 v[240:243], v5 offset:57344
    s_waitcnt lgkmcnt(3)
    v_mfma_f32_32x32x16_bf16 v[200:215], v[64:67], v[228:231], v[200:215]
    ds_read_b128 v[244:247], v5 offset:61440
    s_waitcnt vmcnt(20) lgkmcnt(3)
    v_mfma_f32_32x32x16_bf16 v[152:167], v[68:71], v[232:235], v[152:167]
    s_barrier
    v_add_u32 v2, 0x10000, v2
    v_add_u32 v3, 0x10000, v3
    v_add_u32 v4, 0x10000, v4
    v_add_u32 v5, 0x10000, v5
    ds_read_b128 v[216:219], v2 offset:0
    s_waitcnt lgkmcnt(3)
    v_mfma_f32_32x32x16_bf16 v[168:183], v[68:71], v[236:239], v[168:183]
    ds_read_b128 v[220:223], v2 offset:4096
    s_waitcnt lgkmcnt(3)
    v_mfma_f32_32x32x16_bf16 v[184:199], v[68:71], v[240:243], v[184:199]
    ds_read_b128 v[224:227], v2 offset:8192
    s_waitcnt lgkmcnt(3)
    v_mfma_f32_32x32x16_bf16 v[200:215], v[68:71], v[244:247], v[200:215]
    ds_read_b128 v[228:231], v2 offset:12288
    s_waitcnt vmcnt(19) lgkmcnt(3)
    v_mfma_f32_32x32x16_bf16 v[152:167], v[72:75], v[216:219], v[152:167]
    ds_read_b128 v[232:235], v3 offset:0
    s_waitcnt lgkmcnt(3)
    v_mfma_f32_32x32x16_bf16 v[168:183], v[72:75], v[220:223], v[168:183]
    ds_read_b128 v[236:239], v3 offset:4096
    s_waitcnt lgkmcnt(3)
    v_mfma_f32_32x32x16_bf16 v[184:199], v[72:75], v[224:227], v[184:199]
    ds_read_b128 v[240:243], v3 offset:8192
    s_waitcnt lgkmcnt(3)
    v_mfma_f32_32x32x16_bf16 v[200:215], v[72:75], v[228:231], v[200:215]
    ds_read_b128 v[244:247], v3 offset:12288
    s_waitcnt vmcnt(18) lgkmcnt(3)
    v_mfma_f32_32x32x16_bf16 v[152:167], v[76:79], v[232:235], v[152:167]
    ds_read_b128 v[216:219], v4 offset:0
    s_waitcnt lgkmcnt(3)
    v_mfma_f32_32x32x16_bf16 v[168:183], v[76:79], v[236:239], v[168:183]
    ds_read_b128 v[220:223], v4 offset:4096
    s_waitcnt lgkmcnt(3)
    v_mfma_f32_32x32x16_bf16 v[184:199], v[76:79], v[240:243], v[184:199]
    ds_read_b128 v[224:227], v4 offset:8192
    s_waitcnt lgkmcnt(3)
    v_mfma_f32_32x32x16_bf16 v[200:215], v[76:79], v[244:247], v[200:215]
    ds_read_b128 v[228:231], v4 offset:12288
    s_waitcnt vmcnt(17) lgkmcnt(3)
    v_mfma_f32_32x32x16_bf16 v[152:167], v[80:83], v[216:219], v[152:167]
    ds_read_b128 v[232:235], v5 offset:0
    s_waitcnt lgkmcnt(3)
    v_mfma_f32_32x32x16_bf16 v[168:183], v[80:83], v[220:223], v[168:183]
    ds_read_b128 v[236:239], v5 offset:4096
    s_waitcnt lgkmcnt(3)
    v_mfma_f32_32x32x16_bf16 v[184:199], v[80:83], v[224:227], v[184:199]
    ds_read_b128 v[240:243], v5 offset:8192
    s_waitcnt lgkmcnt(3)
    v_mfma_f32_32x32x16_bf16 v[200:215], v[80:83], v[228:231], v[200:215]
    ds_read_b128 v[244:247], v5 offset:12288
    s_waitcnt vmcnt(16) lgkmcnt(3)
    v_mfma_f32_32x32x16_bf16 v[152:167], v[84:87], v[232:235], v[152:167]
    s_barrier
    ds_read_b128 v[216:219], v2 offset:16384
    s_waitcnt lgkmcnt(3)
    v_mfma_f32_32x32x16_bf16 v[168:183], v[84:87], v[236:239], v[168:183]
    ds_read_b128 v[220:223], v2 offset:20480
    s_waitcnt lgkmcnt(3)
    v_mfma_f32_32x32x16_bf16 v[184:199], v[84:87], v[240:243], v[184:199]
    ds_read_b128 v[224:227], v2 offset:24576
    s_waitcnt lgkmcnt(3)
    v_mfma_f32_32x32x16_bf16 v[200:215], v[84:87], v[244:247], v[200:215]
    ds_read_b128 v[228:231], v2 offset:28672
    s_waitcnt vmcnt(15) lgkmcnt(3)
    v_mfma_f32_32x32x16_bf16 v[152:167], v[88:91], v[216:219], v[152:167]
    ds_read_b128 v[232:235], v3 offset:16384
    s_waitcnt lgkmcnt(3)
    v_mfma_f32_32x32x16_bf16 v[168:183], v[88:91], v[220:223], v[168:183]
    ds_read_b128 v[236:239], v3 offset:20480
    s_waitcnt lgkmcnt(3)
    v_mfma_f32_32x32x16_bf16 v[184:199], v[88:91], v[224:227], v[184:199]
    ds_read_b128 v[240:243], v3 offset:24576
    s_waitcnt lgkmcnt(3)
    v_mfma_f32_32x32x16_bf16 v[200:215], v[88:91], v[228:231], v[200:215]
    ds_read_b128 v[244:247], v3 offset:28672
    s_waitcnt vmcnt(14) lgkmcnt(3)
    v_mfma_f32_32x32x16_bf16 v[152:167], v[92:95], v[232:235], v[152:167]
    ds_read_b128 v[216:219], v4 offset:16384
    s_waitcnt lgkmcnt(3)
    v_mfma_f32_32x32x16_bf16 v[168:183], v[92:95], v[236:239], v[168:183]
    ds_read_b128 v[220:223], v4 offset:20480
    s_waitcnt lgkmcnt(3)
    v_mfma_f32_32x32x16_bf16 v[184:199], v[92:95], v[240:243], v[184:199]
    ds_read_b128 v[224:227], v4 offset:24576
    s_waitcnt lgkmcnt(3)
    v_mfma_f32_32x32x16_bf16 v[200:215], v[92:95], v[244:247], v[200:215]
    ds_read_b128 v[228:231], v4 offset:28672
    s_waitcnt vmcnt(13) lgkmcnt(3)
    v_mfma_f32_32x32x16_bf16 v[152:167], v[96:99], v[216:219], v[152:167]
    ds_read_b128 v[232:235], v5 offset:16384
    s_waitcnt lgkmcnt(3)
    v_mfma_f32_32x32x16_bf16 v[168:183], v[96:99], v[220:223], v[168:183]
    ds_read_b128 v[236:239], v5 offset:20480
    s_waitcnt lgkmcnt(3)
    v_mfma_f32_32x32x16_bf16 v[184:199], v[96:99], v[224:227], v[184:199]
    ds_read_b128 v[240:243], v5 offset:24576
    s_waitcnt lgkmcnt(3)
    v_mfma_f32_32x32x16_bf16 v[200:215], v[96:99], v[228:231], v[200:215]
    ds_read_b128 v[244:247], v5 offset:28672
    s_waitcnt vmcnt(12) lgkmcnt(3)
    v_mfma_f32_32x32x16_bf16 v[152:167], v[100:103], v[232:235], v[152:167]
    s_barrier
    ds_read_b128 v[216:219], v2 offset:32768
    s_waitcnt lgkmcnt(3)
    v_mfma_f32_32x32x16_bf16 v[168:183], v[100:103], v[236:239], v[168:183]
    ds_read_b128 v[220:223], v2 offset:36864
    s_waitcnt lgkmcnt(3)
    v_mfma_f32_32x32x16_bf16 v[184:199], v[100:103], v[240:243], v[184:199]
    ds_read_b128 v[224:227], v2 offset:40960
    s_waitcnt lgkmcnt(3)
    v_mfma_f32_32x32x16_bf16 v[200:215], v[100:103], v[244:247], v[200:215]
    ds_read_b128 v[228:231], v2 offset:45056
    s_waitcnt vmcnt(11) lgkmcnt(3)
    v_mfma_f32_32x32x16_bf16 v[152:167], v[104:107], v[216:219], v[152:167]
    ds_read_b128 v[232:235], v3 offset:32768
    s_waitcnt lgkmcnt(3)
    v_mfma_f32_32x32x16_bf16 v[168:183], v[104:107], v[220:223], v[168:183]
    ds_read_b128 v[236:239], v3 offset:36864
    s_waitcnt lgkmcnt(3)
    v_mfma_f32_32x32x16_bf16 v[184:199], v[104:107], v[224:227], v[184:199]
    ds_read_b128 v[240:243], v3 offset:40960
    s_waitcnt lgkmcnt(3)
    v_mfma_f32_32x32x16_bf16 v[200:215], v[104:107], v[228:231], v[200:215]
    ds_read_b128 v[244:247], v3 offset:45056
    s_waitcnt vmcnt(10) lgkmcnt(3)
    v_mfma_f32_32x32x16_bf16 v[152:167], v[108:111], v[232:235], v[152:167]
    ds_read_b128 v[216:219], v4 offset:32768
    s_waitcnt lgkmcnt(3)
    v_mfma_f32_32x32x16_bf16 v[168:183], v[108:111], v[236:239], v[168:183]
    ds_read_b128 v[220:223], v4 offset:36864
    s_waitcnt lgkmcnt(3)
    v_mfma_f32_32x32x16_bf16 v[184:199], v[108:111], v[240:243], v[184:199]
    ds_read_b128 v[224:227], v4 offset:40960
    s_waitcnt lgkmcnt(3)
    v_mfma_f32_32x32x16_bf16 v[200:215], v[108:111], v[244:247], v[200:215]
    ds_read_b128 v[228:231], v4 offset:45056
    s_waitcnt vmcnt(9) lgkmcnt(3)
    v_mfma_f32_32x32x16_bf16 v[152:167], v[112:115], v[216:219], v[152:167]
    ds_read_b128 v[232:235], v5 offset:32768
    s_waitcnt lgkmcnt(3)
    v_mfma_f32_32x32x16_bf16 v[168:183], v[112:115], v[220:223], v[168:183]
    ds_read_b128 v[236:239], v5 offset:36864
    s_waitcnt lgkmcnt(3)
    v_mfma_f32_32x32x16_bf16 v[184:199], v[112:115], v[224:227], v[184:199]
    ds_read_b128 v[240:243], v5 offset:40960
    s_waitcnt lgkmcnt(3)
    v_mfma_f32_32x32x16_bf16 v[200:215], v[112:115], v[228:231], v[200:215]
    ds_read_b128 v[244:247], v5 offset:45056
    s_waitcnt vmcnt(8) lgkmcnt(3)
    v_mfma_f32_32x32x16_bf16 v[152:167], v[116:119], v[232:235], v[152:167]
    s_barrier
    ds_read_b128 v[216:219], v2 offset:49152
    s_waitcnt lgkmcnt(3)
    v_mfma_f32_32x32x16_bf16 v[168:183], v[116:119], v[236:239], v[168:183]
    ds_read_b128 v[220:223], v2 offset:53248
    s_waitcnt lgkmcnt(3)
    v_mfma_f32_32x32x16_bf16 v[184:199], v[116:119], v[240:243], v[184:199]
    ds_read_b128 v[224:227], v2 offset:57344
    s_waitcnt lgkmcnt(3)
    v_mfma_f32_32x32x16_bf16 v[200:215], v[116:119], v[244:247], v[200:215]
    ds_read_b128 v[228:231], v2 offset:61440
    s_waitcnt vmcnt(7) lgkmcnt(3)
    v_mfma_f32_32x32x16_bf16 v[152:167], v[120:123], v[216:219], v[152:167]
    ds_read_b128 v[232:235], v3 offset:49152
    s_waitcnt lgkmcnt(3)
    v_mfma_f32_32x32x16_bf16 v[168:183], v[120:123], v[220:223], v[168:183]
    ds_read_b128 v[236:239], v3 offset:53248
    s_waitcnt lgkmcnt(3)
    v_mfma_f32_32x32x16_bf16 v[184:199], v[120:123], v[224:227], v[184:199]
    ds_read_b128 v[240:243], v3 offset:57344
    s_waitcnt lgkmcnt(3)
    v_mfma_f32_32x32x16_bf16 v[200:215], v[120:123], v[228:231], v[200:215]
    ds_read_b128 v[244:247], v3 offset:61440
    s_waitcnt vmcnt(6) lgkmcnt(3)
    v_mfma_f32_32x32x16_bf16 v[152:167], v[124:127], v[232:235], v[152:167]
    ds_read_b128 v[216:219], v4 offset:49152
    s_waitcnt lgkmcnt(3)
    v_mfma_f32_32x32x16_bf16 v[168:183], v[124:127], v[236:239], v[168:183]
    ds_read_b128 v[220:223], v4 offset:53248
    s_waitcnt lgkmcnt(3)
    v_mfma_f32_32x32x16_bf16 v[184:199], v[124:127], v[240:243], v[184:199]
    ds_read_b128 v[224:227], v4 offset:57344
    s_waitcnt lgkmcnt(3)
    v_mfma_f32_32x32x16_bf16 v[200:215], v[124:127], v[244:247], v[200:215]
    ds_read_b128 v[228:231], v4 offset:61440
    s_waitcnt vmcnt(5) lgkmcnt(3)
    v_mfma_f32_32x32x16_bf16 v[152:167], v[128:131], v[216:219], v[152:167]
    ds_read_b128 v[232:235], v5 offset:49152
    s_waitcnt lgkmcnt(3)
    v_mfma_f32_32x32x16_bf16 v[168:183], v[128:131], v[220:223], v[168:183]
    ds_read_b128 v[236:239], v5 offset:53248
    s_waitcnt lgkmcnt(3)
    v_mfma_f32_32x32x16_bf16 v[184:199], v[128:131], v[224:227], v[184:199]
    ds_read_b128 v[240:243], v5 offset:57344
    s_waitcnt lgkmcnt(3)
    v_mfma_f32_32x32x16_bf16 v[200:215], v[128:131], v[228:231], v[200:215]
    ds_read_b128 v[244:247], v5 offset:61440
    s_waitcnt vmcnt(4) lgkmcnt(3)
    v_mfma_f32_32x32x16_bf16 v[152:167], v[132:135], v[232:235], v[152:167]
    s_barrier
    v_add_u32 v2, 0x10000, v2
    v_add_u32 v3, 0x10000, v3
    v_add_u32 v4, 0x10000, v4
    v_add_u32 v5, 0x10000, v5
    ds_read_b128 v[216:219], v2 offset:0
    s_waitcnt lgkmcnt(3)
    v_mfma_f32_32x32x16_bf16 v[168:183], v[132:135], v[236:239], v[168:183]
    ds_read_b128 v[220:223], v2 offset:4096
    s_waitcnt lgkmcnt(3)
    v_mfma_f32_32x32x16_bf16 v[184:199], v[132:135], v[240:243], v[184:199]
    ds_read_b128 v[224:227], v2 offset:8192
    s_waitcnt lgkmcnt(3)
    v_mfma_f32_32x32x16_bf16 v[200:215], v[132:135], v[244:247], v[200:215]
    ds_read_b128 v[228:231], v2 offset:12288
    s_waitcnt vmcnt(3) lgkmcnt(3)
    v_mfma_f32_32x32x16_bf16 v[152:167], v[136:139], v[216:219], v[152:167]
    ds_read_b128 v[232:235], v3 offset:0
    s_waitcnt lgkmcnt(3)
    v_mfma_f32_32x32x16_bf16 v[168:183], v[136:139], v[220:223], v[168:183]
    ds_read_b128 v[236:239], v3 offset:4096
    s_waitcnt lgkmcnt(3)
    v_mfma_f32_32x32x16_bf16 v[184:199], v[136:139], v[224:227], v[184:199]
    ds_read_b128 v[240:243], v3 offset:8192
    s_waitcnt lgkmcnt(3)
    v_mfma_f32_32x32x16_bf16 v[200:215], v[136:139], v[228:231], v[200:215]
    ds_read_b128 v[244:247], v3 offset:12288
    s_waitcnt vmcnt(2) lgkmcnt(3)
    v_mfma_f32_32x32x16_bf16 v[152:167], v[140:143], v[232:235], v[152:167]
    ds_read_b128 v[216:219], v4 offset:0
    s_waitcnt lgkmcnt(3)
    v_mfma_f32_32x32x16_bf16 v[168:183], v[140:143], v[236:239], v[168:183]
    ds_read_b128 v[220:223], v4 offset:4096
    s_waitcnt lgkmcnt(3)
    v_mfma_f32_32x32x16_bf16 v[184:199], v[140:143], v[240:243], v[184:199]
    ds_read_b128 v[224:227], v4 offset:8192
    s_waitcnt lgkmcnt(3)
    v_mfma_f32_32x32x16_bf16 v[200:215], v[140:143], v[244:247], v[200:215]
    ds_read_b128 v[228:231], v4 offset:12288
    s_waitcnt vmcnt(1) lgkmcnt(3)
    v_mfma_f32_32x32x16_bf16 v[152:167], v[144:147], v[216:219], v[152:167]
    ds_read_b128 v[232:235], v5 offset:0
    s_waitcnt lgkmcnt(3)
    v_mfma_f32_32x32x16_bf16 v[168:183], v[144:147], v[220:223], v[168:183]
    ds_read_b128 v[236:239], v5 offset:4096
    s_waitcnt lgkmcnt(3)
    v_mfma_f32_32x32x16_bf16 v[184:199], v[144:147], v[224:227], v[184:199]
    ds_read_b128 v[240:243], v5 offset:8192
    s_waitcnt lgkmcnt(3)
    v_mfma_f32_32x32x16_bf16 v[200:215], v[144:147], v[228:231], v[200:215]
    ds_read_b128 v[244:247], v5 offset:12288
    s_waitcnt vmcnt(0) lgkmcnt(3)
    v_mfma_f32_32x32x16_bf16 v[152:167], v[148:151], v[232:235], v[152:167]
    s_waitcnt lgkmcnt(2)
    v_mfma_f32_32x32x16_bf16 v[168:183], v[148:151], v[236:239], v[168:183]
    s_waitcnt lgkmcnt(1)
    v_mfma_f32_32x32x16_bf16 v[184:199], v[148:151], v[240:243], v[184:199]
    s_waitcnt lgkmcnt(0)
    v_mfma_f32_32x32x16_bf16 v[200:215], v[148:151], v[244:247], v[200:215]
    s_barrier
    s_branch B_EPI
B_KSW:
    s_barrier
    ds_read_b128 v[216:219], v2 offset:0
    ds_read_b128 v[220:223], v2 offset:4096
    ds_read_b128 v[224:227], v2 offset:8192
    ds_read_b128 v[228:231], v2 offset:12288
    s_waitcnt vmcnt(23) lgkmcnt(3)
    v_mfma_f32_32x32x16_bf16 v[152:167], v[216:219], v[8:11], v[152:167]
    ds_read_b128 v[232:235], v3 offset:0
    s_waitcnt lgkmcnt(3)
    v_mfma_f32_32x32x16_bf16 v[168:183], v[220:223], v[8:11], v[168:183]
    ds_read_b128 v[236:239], v3 offset:4096
    s_add_u32 s31, s27, 6
    s_sub_u32 s33, s31, 9
    s_cmp_ge_u32 s31, 9
    s_cselect_b32 s31, s33, s31
    s_lshl_b32 s31, s31, 12
    s_add_u32 s31, s31, s28
    buffer_load_dwordx4 v[104:107], v248, s[12:15], s31 offen offset:0 sc1
    s_waitcnt lgkmcnt(3)
    v_mfma_f32_32x32x16_bf16 v[184:199], v[224:227], v[8:11], v[184:199]
    ds_read_b128 v[240:243], v3 offset:8192
    s_waitcnt lgkmcnt(3)
    v_mfma_f32_32x32x16_bf16 v[200:215], v[228:231], v[8:11], v[200:215]
    ds_read_b128 v[244:247], v3 offset:12288
    s_waitcnt vmcnt(23) lgkmcnt(3)
    v_mfma_f32_32x32x16_bf16 v[152:167], v[232:235], v[12:15], v[152:167]
    ds_read_b128 v[216:219], v4 offset:0
    s_waitcnt lgkmcnt(3)
    v_mfma_f32_32x32x16_bf16 v[168:183], v[236:239], v[12:15], v[168:183]
    ds_read_b128 v[220:223], v4 offset:4096
    buffer_load_dwordx4 v[108:111], v248, s[12:15], s31 offen offset:1024 sc1
    s_waitcnt lgkmcnt(3)
    v_mfma_f32_32x32x16_bf16 v[184:199], v[240:243], v[12:15], v[184:199]
    ds_read_b128 v[224:227], v4 offset:8192
    s_waitcnt lgkmcnt(3)
    v_mfma_f32_32x32x16_bf16 v[200:215], v[244:247], v[12:15], v[200:215]
    ds_read_b128 v[228:231], v4 offset:12288
    s_waitcnt vmcnt(23) lgkmcnt(3)
    v_mfma_f32_32x32x16_bf16 v[152:167], v[216:219], v[16:19], v[152:167]
    ds_read_b128 v[232:235], v5 offset:0
    s_waitcnt lgkmcnt(3)
    v_mfma_f32_32x32x16_bf16 v[168:183], v[220:223], v[16:19], v[168:183]
    ds_read_b128 v[236:239], v5 offset:4096
    buffer_load_dwordx4 v[112:115], v248, s[12:15], s31 offen offset:2048 sc1
    s_waitcnt lgkmcnt(3)
    v_mfma_f32_32x32x16_bf16 v[184:199], v[224:227], v[16:19], v[184:199]
    ds_read_b128 v[240:243], v5 offset:8192
    s_waitcnt lgkmcnt(3)
    v_mfma_f32_32x32x16_bf16 v[200:215], v[228:231], v[16:19], v[200:215]
    ds_read_b128 v[244:247], v5 offset:12288
    s_waitcnt vmcnt(23) lgkmcnt(3)
    v_mfma_f32_32x32x16_bf16 v[152:167], v[232:235], v[20:23], v[152:167]
    s_barrier
    ds_read_b128 v[216:219], v2 offset:16384
    s_waitcnt lgkmcnt(3)
    v_mfma_f32_32x32x16_bf16 v[168:183], v[236:239], v[20:23], v[168:183]
    ds_read_b128 v[220:223], v2 offset:20480
    buffer_load_dwordx4 v[116:119], v248, s[12:15], s31 offen offset:3072 sc1
    s_waitcnt lgkmcnt(3)
    v_mfma_f32_32x32x16_bf16 v[184:199], v[240:243], v[20:23], v[184:199]
    ds_read_b128 v[224:227], v2 offset:24576
    s_waitcnt lgkmcnt(3)
    v_mfma_f32_32x32x16_bf16 v[200:215], v[244:247], v[20:23], v[200:215]
    ds_read_b128 v[228:231], v2 offset:28672
    s_waitcnt vmcnt(23) lgkmcnt(3)
    v_mfma_f32_32x32x16_bf16 v[152:167], v[216:219], v[24:27], v[152:167]
    ds_read_b128 v[232:235], v3 offset:16384
    s_waitcnt lgkmcnt(3)
    v_mfma_f32_32x32x16_bf16 v[168:183], v[220:223], v[24:27], v[168:183]
    ds_read_b128 v[236:239], v3 offset:20480
    s_add_u32 s31, s27, 7
    s_sub_u32 s33, s31, 9
    s_cmp_ge_u32 s31, 9
    s_cselect_b32 s31, s33, s31
    s_lshl_b32 s31, s31, 12
    s_add_u32 s31, s31, s28
    buffer_load_dwordx4 v[120:123], v248, s[12:15], s31 offen offset:0 sc1
    s_waitcnt lgkmcnt(3)
    v_mfma_f32_32x32x16_bf16 v[184:199], v[224:227], v[24:27], v[184:199]
    ds_read_b128 v[240:243], v3 offset:24576
    s_waitcnt lgkmcnt(3)
    v_mfma_f32_32x32x16_bf16 v[200:215], v[228:231], v[24:27], v[200:215]
    ds_read_b128 v[244:247], v3 offset:28672
    s_waitcnt vmcnt(23) lgkmcnt(3)
    v_mfma_f32_32x32x16_bf16 v[152:167], v[232:235], v[28:31], v[152:167]
    ds_read_b128 v[216:219], v4 offset:16384
    s_waitcnt lgkmcnt(3)
    v_mfma_f32_32x32x16_bf16 v[168:183], v[236:239], v[28:31], v[168:183]
    ds_read_b128 v[220:223], v4 offset:20480
    buffer_load_dwordx4 v[124:127], v248, s[12:15], s31 offen offset:1024 sc1
    s_waitcnt lgkmcnt(3)
    v_mfma_f32_32x32x16_bf16 v[184:199], v[240:243], v[28:31], v[184:199]
    ds_read_b128 v[224:227], v4 offset:24576
    s_waitcnt lgkmcnt(3)
    v_mfma_f32_32x32x16_bf16 v[200:215], v[244:247], v[28:31], v[200:215]
    ds_read_b128 v[228:231], v4 offset:28672
    s_waitcnt vmcnt(23) lgkmcnt(3)
    v_mfma_f32_32x32x16_bf16 v[152:167], v[216:219], v[32:35], v[152:167]
    ds_read_b128 v[232:235], v5 offset:16384
    s_waitcnt lgkmcnt(3)
    v_mfma_f32_32x32x16_bf16 v[168:183], v[220:223], v[32:35], v[168:183]
    ds_read_b128 v[236:239], v5 offset:20480
    buffer_load_dwordx4 v[128:131], v248, s[12:15], s31 offen offset:2048 sc1
    s_waitcnt lgkmcnt(3)
    v_mfma_f32_32x32x16_bf16 v[184:199], v[224:227], v[32:35], v[184:199]
    ds_read_b128 v[240:243], v5 offset:24576
    s_waitcnt lgkmcnt(3)
    v_mfma_f32_32x32x16_bf16 v[200:215], v[228:231], v[32:35], v[200:215]
    ds_read_b128 v[244:247], v5 offset:28672
    s_waitcnt vmcnt(23) lgkmcnt(3)
    v_mfma_f32_32x32x16_bf16 v[152:167], v[232:235], v[36:39], v[152:167]
    s_barrier
    ds_read_b128 v[216:219], v2 offset:32768
    s_waitcnt lgkmcnt(3)
    v_mfma_f32_32x32x16_bf16 v[168:183], v[236:239], v[36:39], v[168:183]
    ds_read_b128 v[220:223], v2 offset:36864
    buffer_load_dwordx4 v[132:135], v248, s[12:15], s31 offen offset:3072 sc1
    s_waitcnt lgkmcnt(3)
    v_mfma_f32_32x32x16_bf16 v[184:199], v[240:243], v[36:39], v[184:199]
    ds_read_b128 v[224:227], v2 offset:40960
    s_waitcnt lgkmcnt(3)
    v_mfma_f32_32x32x16_bf16 v[200:215], v[244:247], v[36:39], v[200:215]
    ds_read_b128 v[228:231], v2 offset:45056
    s_waitcnt vmcnt(23) lgkmcnt(3)
    v_mfma_f32_32x32x16_bf16 v[152:167], v[216:219], v[40:43], v[152:167]
    ds_read_b128 v[232:235], v3 offset:32768
    s_waitcnt lgkmcnt(3)
    v_mfma_f32_32x32x16_bf16 v[168:183], v[220:223], v[40:43], v[168:183]
    ds_read_b128 v[236:239], v3 offset:36864
    s_add_u32 s31, s27, 8
    s_sub_u32 s33, s31, 9
    s_cmp_ge_u32 s31, 9
    s_cselect_b32 s31, s33, s31
    s_lshl_b32 s31, s31, 12
    s_add_u32 s31, s31, s28
    buffer_load_dwordx4 v[136:139], v248, s[12:15], s31 offen offset:0 sc1
    s_waitcnt lgkmcnt(3)
    v_mfma_f32_32x32x16_bf16 v[184:199], v[224:227], v[40:43], v[184:199]
    ds_read_b128 v[240:243], v3 offset:40960
    s_waitcnt lgkmcnt(3)
    v_mfma_f32_32x32x16_bf16 v[200:215], v[228:231], v[40:43], v[200:215]
    ds_read_b128 v[244:247], v3 offset:45056
    s_waitcnt vmcnt(23) lgkmcnt(3)
    v_mfma_f32_32x32x16_bf16 v[152:167], v[232:235], v[44:47], v[152:167]
    ds_read_b128 v[216:219], v4 offset:32768
    s_waitcnt lgkmcnt(3)
    v_mfma_f32_32x32x16_bf16 v[168:183], v[236:239], v[44:47], v[168:183]
    ds_read_b128 v[220:223], v4 offset:36864
    buffer_load_dwordx4 v[140:143], v248, s[12:15], s31 offen offset:1024 sc1
    s_waitcnt lgkmcnt(3)
    v_mfma_f32_32x32x16_bf16 v[184:199], v[240:243], v[44:47], v[184:199]
    ds_read_b128 v[224:227], v4 offset:40960
    s_waitcnt lgkmcnt(3)
    v_mfma_f32_32x32x16_bf16 v[200:215], v[244:247], v[44:47], v[200:215]
    ds_read_b128 v[228:231], v4 offset:45056
    s_waitcnt vmcnt(23) lgkmcnt(3)
    v_mfma_f32_32x32x16_bf16 v[152:167], v[216:219], v[48:51], v[152:167]
    ds_read_b128 v[232:235], v5 offset:32768
    s_waitcnt lgkmcnt(3)
    v_mfma_f32_32x32x16_bf16 v[168:183], v[220:223], v[48:51], v[168:183]
    ds_read_b128 v[236:239], v5 offset:36864
    buffer_load_dwordx4 v[144:147], v248, s[12:15], s31 offen offset:2048 sc1
    s_waitcnt lgkmcnt(3)
    v_mfma_f32_32x32x16_bf16 v[184:199], v[224:227], v[48:51], v[184:199]
    ds_read_b128 v[240:243], v5 offset:40960
    s_waitcnt lgkmcnt(3)
    v_mfma_f32_32x32x16_bf16 v[200:215], v[228:231], v[48:51], v[200:215]
    ds_read_b128 v[244:247], v5 offset:45056
    s_waitcnt vmcnt(23) lgkmcnt(3)
    v_mfma_f32_32x32x16_bf16 v[152:167], v[232:235], v[52:55], v[152:167]
    s_barrier
    ds_read_b128 v[216:219], v2 offset:49152
    s_waitcnt lgkmcnt(3)
    v_mfma_f32_32x32x16_bf16 v[168:183], v[236:239], v[52:55], v[168:183]
    ds_read_b128 v[220:223], v2 offset:53248
    buffer_load_dwordx4 v[148:151], v248, s[12:15], s31 offen offset:3072 sc1
    s_waitcnt lgkmcnt(3)
    v_mfma_f32_32x32x16_bf16 v[184:199], v[240:243], v[52:55], v[184:199]
    ds_read_b128 v[224:227], v2 offset:57344
    s_waitcnt lgkmcnt(3)
    v_mfma_f32_32x32x16_bf16 v[200:215], v[244:247], v[52:55], v[200:215]
    ds_read_b128 v[228:231], v2 offset:61440
    s_waitcnt vmcnt(23) lgkmcnt(3)
    v_mfma_f32_32x32x16_bf16 v[152:167], v[216:219], v[56:59], v[152:167]
    ds_read_b128 v[232:235], v3 offset:49152
    s_waitcnt lgkmcnt(3)
    v_mfma_f32_32x32x16_bf16 v[168:183], v[220:223], v[56:59], v[168:183]
    ds_read_b128 v[236:239], v3 offset:53248
    s_waitcnt lgkmcnt(3)
    v_mfma_f32_32x32x16_bf16 v[184:199], v[224:227], v[56:59], v[184:199]
    ds_read_b128 v[240:243], v3 offset:57344
    s_waitcnt lgkmcnt(3)
    v_mfma_f32_32x32x16_bf16 v[200:215], v[228:231], v[56:59], v[200:215]
    ds_read_b128 v[244:247], v3 offset:61440
    s_waitcnt vmcnt(22) lgkmcnt(3)
    v_mfma_f32_32x32x16_bf16 v[152:167], v[232:235], v[60:63], v[152:167]
    ds_read_b128 v[216:219], v4 offset:49152
    s_waitcnt lgkmcnt(3)
    v_mfma_f32_32x32x16_bf16 v[168:183], v[236:239], v[60:63], v[168:183]
    ds_read_b128 v[220:223], v4 offset:53248
    s_waitcnt lgkmcnt(3)
    v_mfma_f32_32x32x16_bf16 v[184:199], v[240:243], v[60:63], v[184:199]
    ds_read_b128 v[224:227], v4 offset:57344
    s_waitcnt lgkmcnt(3)
    v_mfma_f32_32x32x16_bf16 v[200:215], v[244:247], v[60:63], v[200:215]
    ds_read_b128 v[228:231], v4 offset:61440
    s_waitcnt vmcnt(21) lgkmcnt(3)
    v_mfma_f32_32x32x16_bf16 v[152:167], v[216:219], v[64:67], v[152:167]
    ds_read_b128 v[232:235], v5 offset:49152
    s_waitcnt lgkmcnt(3)
    v_mfma_f32_32x32x16_bf16 v[168:183], v[220:223], v[64:67], v[168:183]
    ds_read_b128 v[236:239], v5 offset:53248
    s_waitcnt lgkmcnt(3)
    v_mfma_f32_32x32x16_bf16 v[184:199], v[224:227], v[64:67], v[184:199]
    ds_read_b128 v[240:243], v5 offset:57344
    s_waitcnt lgkmcnt(3)
    v_mfma_f32_32x32x16_bf16 v[200:215], v[228:231], v[64:67], v[200:215]
    ds_read_b128 v[244:247], v5 offset:61440
    s_waitcnt vmcnt(20) lgkmcnt(3)
    v_mfma_f32_32x32x16_bf16 v[152:167], v[232:235], v[68:71], v[152:167]
    s_barrier
    v_add_u32 v2, 0x10000, v2
    v_add_u32 v3, 0x10000, v3
    v_add_u32 v4, 0x10000, v4
    v_add_u32 v5, 0x10000, v5
    ds_read_b128 v[216:219], v2 offset:0
    s_waitcnt lgkmcnt(3)
    v_mfma_f32_32x32x16_bf16 v[168:183], v[236:239], v[68:71], v[168:183]
    ds_read_b128 v[220:223], v2 offset:4096
    s_waitcnt lgkmcnt(3)
    v_mfma_f32_32x32x16_bf16 v[184:199], v[240:243], v[68:71], v[184:199]
    ds_read_b128 v[224:227], v2 offset:8192
    s_waitcnt lgkmcnt(3)
    v_mfma_f32_32x32x16_bf16 v[200:215], v[244:247], v[68:71], v[200:215]
    ds_read_b128 v[228:231], v2 offset:12288
    s_waitcnt vmcnt(19) lgkmcnt(3)
    v_mfma_f32_32x32x16_bf16 v[152:167], v[216:219], v[72:75], v[152:167]
    ds_read_b128 v[232:235], v3 offset:0
    s_waitcnt lgkmcnt(3)
    v_mfma_f32_32x32x16_bf16 v[168:183], v[220:223], v[72:75], v[168:183]
    ds_read_b128 v[236:239], v3 offset:4096
    s_waitcnt lgkmcnt(3)
    v_mfma_f32_32x32x16_bf16 v[184:199], v[224:227], v[72:75], v[184:199]
    ds_read_b128 v[240:243], v3 offset:8192
    s_waitcnt lgkmcnt(3)
    v_mfma_f32_32x32x16_bf16 v[200:215], v[228:231], v[72:75], v[200:215]
    ds_read_b128 v[244:247], v3 offset:12288
    s_waitcnt vmcnt(18) lgkmcnt(3)
    v_mfma_f32_32x32x16_bf16 v[152:167], v[232:235], v[76:79], v[152:167]
    ds_read_b128 v[216:219], v4 offset:0
    s_waitcnt lgkmcnt(3)
    v_mfma_f32_32x32x16_bf16 v[168:183], v[236:239], v[76:79], v[168:183]
    ds_read_b128 v[220:223], v4 offset:4096
    s_waitcnt lgkmcnt(3)
    v_mfma_f32_32x32x16_bf16 v[184:199], v[240:243], v[76:79], v[184:199]
    ds_read_b128 v[224:227], v4 offset:8192
    s_waitcnt lgkmcnt(3)
    v_mfma_f32_32x32x16_bf16 v[200:215], v[244:247], v[76:79], v[200:215]
    ds_read_b128 v[228:231], v4 offset:12288
    s_waitcnt vmcnt(17) lgkmcnt(3)
    v_mfma_f32_32x32x16_bf16 v[152:167], v[216:219], v[80:83], v[152:167]
    ds_read_b128 v[232:235], v5 offset:0
    s_waitcnt lgkmcnt(3)
    v_mfma_f32_32x32x16_bf16 v[168:183], v[220:223], v[80:83], v[168:183]
    ds_read_b128 v[236:239], v5 offset:4096
    s_waitcnt lgkmcnt(3)
    v_mfma_f32_32x32x16_bf16 v[184:199], v[224:227], v[80:83], v[184:199]
    ds_read_b128 v[240:243], v5 offset:8192
    s_waitcnt lgkmcnt(3)
    v_mfma_f32_32x32x16_bf16 v[200:215], v[228:231], v[80:83], v[200:215]
    ds_read_b128 v[244:247], v5 offset:12288
    s_waitcnt vmcnt(16) lgkmcnt(3)
    v_mfma_f32_32x32x16_bf16 v[152:167], v[232:235], v[84:87], v[152:167]
    s_barrier
    ds_read_b128 v[216:219], v2 offset:16384
    s_waitcnt lgkmcnt(3)
    v_mfma_f32_32x32x16_bf16 v[168:183], v[236:239], v[84:87], v[168:183]
    ds_read_b128 v[220:223], v2 offset:20480
    s_waitcnt lgkmcnt(3)
    v_mfma_f32_32x32x16_bf16 v[184:199], v[240:243], v[84:87], v[184:199]
    ds_read_b128 v[224:227], v2 offset:24576
    s_waitcnt lgkmcnt(3)
    v_mfma_f32_32x32x16_bf16 v[200:215], v[244:247], v[84:87], v[200:215]
    ds_read_b128 v[228:231], v2 offset:28672
    s_waitcnt vmcnt(15) lgkmcnt(3)
    v_mfma_f32_32x32x16_bf16 v[152:167], v[216:219], v[88:91], v[152:167]
    ds_read_b128 v[232:235], v3 offset:16384
    s_waitcnt lgkmcnt(3)
    v_mfma_f32_32x32x16_bf16 v[168:183], v[220:223], v[88:91], v[168:183]
    ds_read_b128 v[236:239], v3 offset:20480
    s_waitcnt lgkmcnt(3)
    v_mfma_f32_32x32x16_bf16 v[184:199], v[224:227], v[88:91], v[184:199]
    ds_read_b128 v[240:243], v3 offset:24576
    s_waitcnt lgkmcnt(3)
    v_mfma_f32_32x32x16_bf16 v[200:215], v[228:231], v[88:91], v[200:215]
    ds_read_b128 v[244:247], v3 offset:28672
    s_waitcnt vmcnt(14) lgkmcnt(3)
    v_mfma_f32_32x32x16_bf16 v[152:167], v[232:235], v[92:95], v[152:167]
    ds_read_b128 v[216:219], v4 offset:16384
    s_waitcnt lgkmcnt(3)
    v_mfma_f32_32x32x16_bf16 v[168:183], v[236:239], v[92:95], v[168:183]
    ds_read_b128 v[220:223], v4 offset:20480
    s_waitcnt lgkmcnt(3)
    v_mfma_f32_32x32x16_bf16 v[184:199], v[240:243], v[92:95], v[184:199]
    ds_read_b128 v[224:227], v4 offset:24576
    s_waitcnt lgkmcnt(3)
    v_mfma_f32_32x32x16_bf16 v[200:215], v[244:247], v[92:95], v[200:215]
    ds_read_b128 v[228:231], v4 offset:28672
    s_waitcnt vmcnt(13) lgkmcnt(3)
    v_mfma_f32_32x32x16_bf16 v[152:167], v[216:219], v[96:99], v[152:167]
    ds_read_b128 v[232:235], v5 offset:16384
    s_waitcnt lgkmcnt(3)
    v_mfma_f32_32x32x16_bf16 v[168:183], v[220:223], v[96:99], v[168:183]
    ds_read_b128 v[236:239], v5 offset:20480
    s_waitcnt lgkmcnt(3)
    v_mfma_f32_32x32x16_bf16 v[184:199], v[224:227], v[96:99], v[184:199]
    ds_read_b128 v[240:243], v5 offset:24576
    s_waitcnt lgkmcnt(3)
    v_mfma_f32_32x32x16_bf16 v[200:215], v[228:231], v[96:99], v[200:215]
    ds_read_b128 v[244:247], v5 offset:28672
    s_waitcnt vmcnt(12) lgkmcnt(3)
    v_mfma_f32_32x32x16_bf16 v[152:167], v[232:235], v[100:103], v[152:167]
    s_barrier
    ds_read_b128 v[216:219], v2 offset:32768
    s_waitcnt lgkmcnt(3)
    v_mfma_f32_32x32x16_bf16 v[168:183], v[236:239], v[100:103], v[168:183]
    ds_read_b128 v[220:223], v2 offset:36864
    s_waitcnt lgkmcnt(3)
    v_mfma_f32_32x32x16_bf16 v[184:199], v[240:243], v[100:103], v[184:199]
    ds_read_b128 v[224:227], v2 offset:40960
    s_waitcnt lgkmcnt(3)
    v_mfma_f32_32x32x16_bf16 v[200:215], v[244:247], v[100:103], v[200:215]
    ds_read_b128 v[228:231], v2 offset:45056
    s_waitcnt vmcnt(11) lgkmcnt(3)
    v_mfma_f32_32x32x16_bf16 v[152:167], v[216:219], v[104:107], v[152:167]
    ds_read_b128 v[232:235], v3 offset:32768
    s_waitcnt lgkmcnt(3)
    v_mfma_f32_32x32x16_bf16 v[168:183], v[220:223], v[104:107], v[168:183]
    ds_read_b128 v[236:239], v3 offset:36864
    s_waitcnt lgkmcnt(3)
    v_mfma_f32_32x32x16_bf16 v[184:199], v[224:227], v[104:107], v[184:199]
    ds_read_b128 v[240:243], v3 offset:40960
    s_waitcnt lgkmcnt(3)
    v_mfma_f32_32x32x16_bf16 v[200:215], v[228:231], v[104:107], v[200:215]
    ds_read_b128 v[244:247], v3 offset:45056
    s_waitcnt vmcnt(10) lgkmcnt(3)
    v_mfma_f32_32x32x16_bf16 v[152:167], v[232:235], v[108:111], v[152:167]
    ds_read_b128 v[216:219], v4 offset:32768
    s_waitcnt lgkmcnt(3)
    v_mfma_f32_32x32x16_bf16 v[168:183], v[236:239], v[108:111], v[168:183]
    ds_read_b128 v[220:223], v4 offset:36864
    s_waitcnt lgkmcnt(3)
    v_mfma_f32_32x32x16_bf16 v[184:199], v[240:243], v[108:111], v[184:199]
    ds_read_b128 v[224:227], v4 offset:40960
    s_waitcnt lgkmcnt(3)
    v_mfma_f32_32x32x16_bf16 v[200:215], v[244:247], v[108:111], v[200:215]
    ds_read_b128 v[228:231], v4 offset:45056
    s_waitcnt vmcnt(9) lgkmcnt(3)
    v_mfma_f32_32x32x16_bf16 v[152:167], v[216:219], v[112:115], v[152:167]
    ds_read_b128 v[232:235], v5 offset:32768
    s_waitcnt lgkmcnt(3)
    v_mfma_f32_32x32x16_bf16 v[168:183], v[220:223], v[112:115], v[168:183]
    ds_read_b128 v[236:239], v5 offset:36864
    s_waitcnt lgkmcnt(3)
    v_mfma_f32_32x32x16_bf16 v[184:199], v[224:227], v[112:115], v[184:199]
    ds_read_b128 v[240:243], v5 offset:40960
    s_waitcnt lgkmcnt(3)
    v_mfma_f32_32x32x16_bf16 v[200:215], v[228:231], v[112:115], v[200:215]
    ds_read_b128 v[244:247], v5 offset:45056
    s_waitcnt vmcnt(8) lgkmcnt(3)
    v_mfma_f32_32x32x16_bf16 v[152:167], v[232:235], v[116:119], v[152:167]
    s_barrier
    ds_read_b128 v[216:219], v2 offset:49152
    s_waitcnt lgkmcnt(3)
    v_mfma_f32_32x32x16_bf16 v[168:183], v[236:239], v[116:119], v[168:183]
    ds_read_b128 v[220:223], v2 offset:53248
    s_waitcnt lgkmcnt(3)
    v_mfma_f32_32x32x16_bf16 v[184:199], v[240:243], v[116:119], v[184:199]
    ds_read_b128 v[224:227], v2 offset:57344
    s_waitcnt lgkmcnt(3)
    v_mfma_f32_32x32x16_bf16 v[200:215], v[244:247], v[116:119], v[200:215]
    ds_read_b128 v[228:231], v2 offset:61440
    s_waitcnt vmcnt(7) lgkmcnt(3)
    v_mfma_f32_32x32x16_bf16 v[152:167], v[216:219], v[120:123], v[152:167]
    ds_read_b128 v[232:235], v3 offset:49152
    s_waitcnt lgkmcnt(3)
    v_mfma_f32_32x32x16_bf16 v[168:183], v[220:223], v[120:123], v[168:183]
    ds_read_b128 v[236:239], v3 offset:53248
    s_waitcnt lgkmcnt(3)
    v_mfma_f32_32x32x16_bf16 v[184:199], v[224:227], v[120:123], v[184:199]
    ds_read_b128 v[240:243], v3 offset:57344
    s_waitcnt lgkmcnt(3)
    v_mfma_f32_32x32x16_bf16 v[200:215], v[228:231], v[120:123], v[200:215]
    ds_read_b128 v[244:247], v3 offset:61440
    s_waitcnt vmcnt(6) lgkmcnt(3)
    v_mfma_f32_32x32x16_bf16 v[152:167], v[232:235], v[124:127], v[152:167]
    ds_read_b128 v[216:219], v4 offset:49152
    s_waitcnt lgkmcnt(3)
    v_mfma_f32_32x32x16_bf16 v[168:183], v[236:239], v[124:127], v[168:183]
    ds_read_b128 v[220:223], v4 offset:53248
    s_waitcnt lgkmcnt(3)
    v_mfma_f32_32x32x16_bf16 v[184:199], v[240:243], v[124:127], v[184:199]
    ds_read_b128 v[224:227], v4 offset:57344
    s_waitcnt lgkmcnt(3)
    v_mfma_f32_32x32x16_bf16 v[200:215], v[244:247], v[124:127], v[200:215]
    ds_read_b128 v[228:231], v4 offset:61440
    s_waitcnt vmcnt(5) lgkmcnt(3)
    v_mfma_f32_32x32x16_bf16 v[152:167], v[216:219], v[128:131], v[152:167]
    ds_read_b128 v[232:235], v5 offset:49152
    s_waitcnt lgkmcnt(3)
    v_mfma_f32_32x32x16_bf16 v[168:183], v[220:223], v[128:131], v[168:183]
    ds_read_b128 v[236:239], v5 offset:53248
    s_waitcnt lgkmcnt(3)
    v_mfma_f32_32x32x16_bf16 v[184:199], v[224:227], v[128:131], v[184:199]
    ds_read_b128 v[240:243], v5 offset:57344
    s_waitcnt lgkmcnt(3)
    v_mfma_f32_32x32x16_bf16 v[200:215], v[228:231], v[128:131], v[200:215]
    ds_read_b128 v[244:247], v5 offset:61440
    s_waitcnt vmcnt(4) lgkmcnt(3)
    v_mfma_f32_32x32x16_bf16 v[152:167], v[232:235], v[132:135], v[152:167]
    s_barrier
    v_add_u32 v2, 0x10000, v2
    v_add_u32 v3, 0x10000, v3
    v_add_u32 v4, 0x10000, v4
    v_add_u32 v5, 0x10000, v5
    ds_read_b128 v[216:219], v2 offset:0
    s_waitcnt lgkmcnt(3)
    v_mfma_f32_32x32x16_bf16 v[168:183], v[236:239], v[132:135], v[168:183]
    ds_read_b128 v[220:223], v2 offset:4096
    s_waitcnt lgkmcnt(3)
    v_mfma_f32_32x32x16_bf16 v[184:199], v[240:243], v[132:135], v[184:199]
    ds_read_b128 v[224:227], v2 offset:8192
    s_waitcnt lgkmcnt(3)
    v_mfma_f32_32x32x16_bf16 v[200:215], v[244:247], v[132:135], v[200:215]
    ds_read_b128 v[228:231], v2 offset:12288
    s_waitcnt vmcnt(3) lgkmcnt(3)
    v_mfma_f32_32x32x16_bf16 v[152:167], v[216:219], v[136:139], v[152:167]
    ds_read_b128 v[232:235], v3 offset:0
    s_waitcnt lgkmcnt(3)
    v_mfma_f32_32x32x16_bf16 v[168:183], v[220:223], v[136:139], v[168:183]
    ds_read_b128 v[236:239], v3 offset:4096
    s_waitcnt lgkmcnt(3)
    v_mfma_f32_32x32x16_bf16 v[184:199], v[224:227], v[136:139], v[184:199]
    ds_read_b128 v[240:243], v3 offset:8192
    s_waitcnt lgkmcnt(3)
    v_mfma_f32_32x32x16_bf16 v[200:215], v[228:231], v[136:139], v[200:215]
    ds_read_b128 v[244:247], v3 offset:12288
    s_waitcnt vmcnt(2) lgkmcnt(3)
    v_mfma_f32_32x32x16_bf16 v[152:167], v[232:235], v[140:143], v[152:167]
    ds_read_b128 v[216:219], v4 offset:0
    s_waitcnt lgkmcnt(3)
    v_mfma_f32_32x32x16_bf16 v[168:183], v[236:239], v[140:143], v[168:183]
    ds_read_b128 v[220:223], v4 offset:4096
    s_waitcnt lgkmcnt(3)
    v_mfma_f32_32x32x16_bf16 v[184:199], v[240:243], v[140:143], v[184:199]
    ds_read_b128 v[224:227], v4 offset:8192
    s_waitcnt lgkmcnt(3)
    v_mfma_f32_32x32x16_bf16 v[200:215], v[244:247], v[140:143], v[200:215]
    ds_read_b128 v[228:231], v4 offset:12288
    s_waitcnt vmcnt(1) lgkmcnt(3)
    v_mfma_f32_32x32x16_bf16 v[152:167], v[216:219], v[144:147], v[152:167]
    ds_read_b128 v[232:235], v5 offset:0
    s_waitcnt lgkmcnt(3)
    v_mfma_f32_32x32x16_bf16 v[168:183], v[220:223], v[144:147], v[168:183]
    ds_read_b128 v[236:239], v5 offset:4096
    s_waitcnt lgkmcnt(3)
    v_mfma_f32_32x32x16_bf16 v[184:199], v[224:227], v[144:147], v[184:199]
    ds_read_b128 v[240:243], v5 offset:8192
    s_waitcnt lgkmcnt(3)
    v_mfma_f32_32x32x16_bf16 v[200:215], v[228:231], v[144:147], v[200:215]
    ds_read_b128 v[244:247], v5 offset:12288
    s_waitcnt vmcnt(0) lgkmcnt(3)
    v_mfma_f32_32x32x16_bf16 v[152:167], v[232:235], v[148:151], v[152:167]
    s_waitcnt lgkmcnt(2)
    v_mfma_f32_32x32x16_bf16 v[168:183], v[236:239], v[148:151], v[168:183]
    s_waitcnt lgkmcnt(1)
    v_mfma_f32_32x32x16_bf16 v[184:199], v[240:243], v[148:151], v[184:199]
    s_waitcnt lgkmcnt(0)
    v_mfma_f32_32x32x16_bf16 v[200:215], v[244:247], v[148:151], v[200:215]
    s_barrier
B_EPI:
    s_setprio 0
    s_lshl_b32 s30, s25, 7
    v_lshl_add_u32 v80, v250, 4, s30
    v_lshlrev_b32 v81, 2, v249
    v_add_u32 v82, s30, v81
    ds_read_b128 v[8:11], v80 offset:2048
    ds_read_b128 v[12:15], v80 offset:2080
    ds_read_b128 v[16:19], v80 offset:2112
    ds_read_b128 v[20:23], v80 offset:2144
    ds_read_b32 v84, v82 offset:2048
    ds_read_b32 v72, v81 offset:0
    ds_read_b32 v76, v81 offset:512
    ds_read_b32 v73, v81 offset:128
    ds_read_b32 v77, v81 offset:640
    ds_read_b32 v74, v81 offset:256
    ds_read_b32 v78, v81 offset:768
    ds_read_b32 v75, v81 offset:384
    ds_read_b32 v79, v81 offset:896
    s_lshr_b32 s35, s23, 1
    s_mul_i32 s35, s35, 19456
    s_mul_i32 s38, s24, 311296
    s_add_u32 s38, s38, s35
    s_add_u32 s38, s38, 17784832
    s_and_b32 s36, s23, 1
    s_lshl_b32 s37, s36, 2
    s_mul_i32 s39, s37, 2304
    s_add_u32 s39, s39, s38
    s_waitcnt lgkmcnt(0)
    s_cmp_eq_u32 s25, 2
    s_cbranch_scc1 B_E2
    s_cmp_eq_u32 s25, 3
    s_cbranch_scc1 B_E3
    s_lshl_b32 s40, s24, 17
    s_lshl_b32 s41, s23, 12
    s_add_u32 s40, s40, s41
    s_add_u32 s40, s40, 10174464
    s_add_u32 s41, s39, 1024
    s_cmp_eq_u32 s25, 0
    s_cselect_b32 s42, 0x3eae1a93, 1.0
    s_cselect_b32 s43, s40, s41
    s_mov_b32 s40, 2304
    s_cselect_b32 s44, 1024, s40
    s_mov_b32 s40, 155648
    s_cselect_b32 s45, 65536, s40
    v_mul_f32 v80, s42, v76
    v_fma_f32 v152, -v72, v8, v152
    v_fma_f32 v153, -v72, v9, v153
    v_fma_f32 v154, -v72, v10, v154
    v_fma_f32 v155, -v72, v11, v155
    v_fma_f32 v156, -v72, v12, v156
    v_fma_f32 v157, -v72, v13, v157
    v_fma_f32 v158, -v72, v14, v158
    v_fma_f32 v159, -v72, v15, v159
    v_fma_f32 v160, -v72, v16, v160
    v_fma_f32 v161, -v72, v17, v161
    v_fma_f32 v162, -v72, v18, v162
    v_fma_f32 v163, -v72, v19, v163
    v_fma_f32 v164, -v72, v20, v164
    v_fma_f32 v165, -v72, v21, v165
    v_fma_f32 v166, -v72, v22, v166
    v_fma_f32 v167, -v72, v23, v167
    v_mul_f32 v152, v80, v152
    v_mul_f32 v153, v80, v153
    v_mul_f32 v154, v80, v154
    v_mul_f32 v155, v80, v155
    v_mul_f32 v156, v80, v156
    v_mul_f32 v157, v80, v157
    v_mul_f32 v158, v80, v158
    v_mul_f32 v159, v80, v159
    v_mul_f32 v160, v80, v160
    v_mul_f32 v161, v80, v161
    v_mul_f32 v162, v80, v162
    v_mul_f32 v163, v80, v163
    v_mul_f32 v164, v80, v164
    v_mul_f32 v165, v80, v165
    v_mul_f32 v166, v80, v166
    v_mul_f32 v167, v80, v167
    v_cvt_pk_bf16_f32 v96, v152, v153
    v_cvt_pk_bf16_f32 v97, v154, v155
    v_cvt_pk_bf16_f32 v98, v156, v157
    v_cvt_pk_bf16_f32 v99, v158, v159
    s_mov_b32 s46, s43
    buffer_store_dwordx4 v[96:99], v248, s[12:15], s46 offen sc1
    v_cvt_pk_bf16_f32 v100, v160, v161
    v_cvt_pk_bf16_f32 v101, v162, v163
    v_cvt_pk_bf16_f32 v102, v164, v165
    v_cvt_pk_bf16_f32 v103, v166, v167
    s_add_u32 s46, s43, s45
    buffer_store_dwordx4 v[100:103], v248, s[12:15], s46 offen sc1
    s_add_u32 s43, s43, s44
    v_mul_f32 v80, s42, v77
    v_fma_f32 v168, -v73, v8, v168
    v_fma_f32 v169, -v73, v9, v169
    v_fma_f32 v170, -v73, v10, v170
    v_fma_f32 v171, -v73, v11, v171
    v_fma_f32 v172, -v73, v12, v172
    v_fma_f32 v173, -v73, v13, v173
    v_fma_f32 v174, -v73, v14, v174
    v_fma_f32 v175, -v73, v15, v175
    v_fma_f32 v176, -v73, v16, v176
    v_fma_f32 v177, -v73, v17, v177
    v_fma_f32 v178, -v73, v18, v178
    v_fma_f32 v179, -v73, v19, v179
    v_fma_f32 v180, -v73, v20, v180
    v_fma_f32 v181, -v73, v21, v181
    v_fma_f32 v182, -v73, v22, v182
    v_fma_f32 v183, -v73, v23, v183
    v_mul_f32 v168, v80, v168
    v_mul_f32 v169, v80, v169
    v_mul_f32 v170, v80, v170
    v_mul_f32 v171, v80, v171
    v_mul_f32 v172, v80, v172
    v_mul_f32 v173, v80, v173
    v_mul_f32 v174, v80, v174
    v_mul_f32 v175, v80, v175
    v_mul_f32 v176, v80, v176
    v_mul_f32 v177, v80, v177
    v_mul_f32 v178, v80, v178
    v_mul_f32 v179, v80, v179
    v_mul_f32 v180, v80, v180
    v_mul_f32 v181, v80, v181
    v_mul_f32 v182, v80, v182
    v_mul_f32 v183, v80, v183
    v_cvt_pk_bf16_f32 v104, v168, v169
    v_cvt_pk_bf16_f32 v105, v170, v171
    v_cvt_pk_bf16_f32 v106, v172, v173
    v_cvt_pk_bf16_f32 v107, v174, v175
    s_mov_b32 s46, s43
    buffer_store_dwordx4 v[104:107], v248, s[12:15], s46 offen sc1
    v_cvt_pk_bf16_f32 v108, v176, v177
    v_cvt_pk_bf16_f32 v109, v178, v179
    v_cvt_pk_bf16_f32 v110, v180, v181
    v_cvt_pk_bf16_f32 v111, v182, v183
    s_add_u32 s46, s43, s45
    buffer_store_dwordx4 v[108:111], v248, s[12:15], s46 offen sc1
    s_add_u32 s43, s43, s44
    v_mul_f32 v80, s42, v78
    v_fma_f32 v184, -v74, v8, v184
    v_fma_f32 v185, -v74, v9, v185
    v_fma_f32 v186, -v74, v10, v186
    v_fma_f32 v187, -v74, v11, v187
    v_fma_f32 v188, -v74, v12, v188
    v_fma_f32 v189, -v74, v13, v189
    v_fma_f32 v190, -v74, v14, v190
    v_fma_f32 v191, -v74, v15, v191
    v_fma_f32 v192, -v74, v16, v192
    v_fma_f32 v193, -v74, v17, v193
    v_fma_f32 v194, -v74, v18, v194
    v_fma_f32 v195, -v74, v19, v195
    v_fma_f32 v196, -v74, v20, v196
    v_fma_f32 v197, -v74, v21, v197
    v_fma_f32 v198, -v74, v22, v198
    v_fma_f32 v199, -v74, v23, v199
    v_mul_f32 v184, v80, v184
    v_mul_f32 v185, v80, v185
    v_mul_f32 v186, v80, v186
    v_mul_f32 v187, v80, v187
    v_mul_f32 v188, v80, v188
    v_mul_f32 v189, v80, v189
    v_mul_f32 v190, v80, v190
    v_mul_f32 v191, v80, v191
    v_mul_f32 v192, v80, v192
    v_mul_f32 v193, v80, v193
    v_mul_f32 v194, v80, v194
    v_mul_f32 v195, v80, v195
    v_mul_f32 v196, v80, v196
    v_mul_f32 v197, v80, v197
    v_mul_f32 v198, v80, v198
    v_mul_f32 v199, v80, v199
    v_cvt_pk_bf16_f32 v112, v184, v185
    v_cvt_pk_bf16_f32 v113, v186, v187
    v_cvt_pk_bf16_f32 v114, v188, v189
    v_cvt_pk_bf16_f32 v115, v190, v191
    s_mov_b32 s46, s43
    buffer_store_dwordx4 v[112:115], v248, s[12:15], s46 offen sc1
    v_cvt_pk_bf16_f32 v116, v192, v193
    v_cvt_pk_bf16_f32 v117, v194, v195
    v_cvt_pk_bf16_f32 v118, v196, v197
    v_cvt_pk_bf16_f32 v119, v198, v199
    s_add_u32 s46, s43, s45
    buffer_store_dwordx4 v[116:119], v248, s[12:15], s46 offen sc1
    s_add_u32 s43, s43, s44
    v_mul_f32 v80, s42, v79
    v_fma_f32 v200, -v75, v8, v200
    v_fma_f32 v201, -v75, v9, v201
    v_fma_f32 v202, -v75, v10, v202
    v_fma_f32 v203, -v75, v11, v203
    v_fma_f32 v204, -v75, v12, v204
    v_fma_f32 v205, -v75, v13, v205
    v_fma_f32 v206, -v75, v14, v206
    v_fma_f32 v207, -v75, v15, v207
    v_fma_f32 v208, -v75, v16, v208
    v_fma_f32 v209, -v75, v17, v209
    v_fma_f32 v210, -v75, v18, v210
    v_fma_f32 v211, -v75, v19, v211
    v_fma_f32 v212, -v75, v20, v212
    v_fma_f32 v213, -v75, v21, v213
    v_fma_f32 v214, -v75, v22, v214
    v_fma_f32 v215, -v75, v23, v215
    v_mul_f32 v200, v80, v200
    v_mul_f32 v201, v80, v201
    v_mul_f32 v202, v80, v202
    v_mul_f32 v203, v80, v203
    v_mul_f32 v204, v80, v204
    v_mul_f32 v205, v80, v205
    v_mul_f32 v206, v80, v206
    v_mul_f32 v207, v80, v207
    v_mul_f32 v208, v80, v208
    v_mul_f32 v209, v80, v209
    v_mul_f32 v210, v80, v210
    v_mul_f32 v211, v80, v211
    v_mul_f32 v212, v80, v212
    v_mul_f32 v213, v80, v213
    v_mul_f32 v214, v80, v214
    v_mul_f32 v215, v80, v215
    v_cvt_pk_bf16_f32 v120, v200, v201
    v_cvt_pk_bf16_f32 v121, v202, v203
    v_cvt_pk_bf16_f32 v122, v204, v205
    v_cvt_pk_bf16_f32 v123, v206, v207
    s_mov_b32 s46, s43
    buffer_store_dwordx4 v[120:123], v248, s[12:15], s46 offen sc1
    v_cvt_pk_bf16_f32 v124, v208, v209
    v_cvt_pk_bf16_f32 v125, v210, v211
    v_cvt_pk_bf16_f32 v126, v212, v213
    v_cvt_pk_bf16_f32 v127, v214, v215
    s_add_u32 s46, s43, s45
    buffer_store_dwordx4 v[124:127], v248, s[12:15], s46 offen sc1
    s_add_u32 s43, s43, s44
    s_branch B_FIN
B_E3:
    v_cmp_eq_u32 vcc, 0, v250
    s_lshl_b32 s40, s24, 14
    s_lshl_b32 s41, s23, 9
    s_add_u32 s40, s40, s41
    s_add_u32 s40, s40, 12533760
    s_lshl_b32 s41, s36, 9
    s_add_u32 s41, s41, s38
    v_mov_b32 v80, 0x3eae1a93
    v_mov_b32 v81, s41
    v_mov_b32 v82, s40
    v_mov_b32 v83, 155648
    v_mov_b32 v85, 8192
    v_cndmask_b32 v80, 1.0, v80, vcc
    v_cndmask_b32 v81, v81, v82, vcc
    v_cndmask_b32 v83, v83, v85, vcc
    v_lshl_add_u32 v81, v249, 2, v81
    v_add_u32 v82, v81, v83
    v_bfe_u32 v85, v249, 2, 1
    v_bfe_u32 v86, v249, 3, 1
    v_and_b32 v87, 0x13, v249
    v_lshl_add_u32 v87, v85, 3, v87
    v_lshl_add_u32 v87, v86, 2, v87
    v_lshlrev_b32 v87, 1, v87
    v_fma_f32 v152, -v72, v8, v152
    v_fma_f32 v153, -v72, v9, v153
    v_fma_f32 v154, -v72, v10, v154
    v_fma_f32 v155, -v72, v11, v155
    v_fma_f32 v156, -v72, v12, v156
    v_fma_f32 v157, -v72, v13, v157
    v_fma_f32 v158, -v72, v14, v158
    v_fma_f32 v159, -v72, v15, v159
    v_mul_f32 v88, v80, v76
    v_mul_f32 v152, v88, v152
    v_mul_f32 v153, v88, v153
    v_mul_f32 v154, v88, v154
    v_mul_f32 v155, v88, v155
    v_mul_f32 v156, v76, v156
    v_mul_f32 v157, v76, v157
    v_mul_f32 v158, v76, v158
    v_mul_f32 v159, v76, v159
    v_cvt_pk_bf16_f32 v96, v152, v153
    v_cvt_pk_bf16_f32 v97, v154, v155
    v_cvt_pk_bf16_f32 v98, v156, v157
    v_cvt_pk_bf16_f32 v99, v158, v159
    buffer_store_dword v96, v81, s[12:15], 0 offen offset:0 sc1
    buffer_store_dword v97, v82, s[12:15], 0 offen offset:0 sc1
    s_mov_b32 exec_hi, 0
    ds_write_b16 v87, v98 offset:1024
    ds_write_b16_d16_hi v87, v98 offset:1280
    ds_write_b16 v87, v99 offset:1536
    ds_write_b16_d16_hi v87, v99 offset:1792
    s_mov_b32 exec_hi, -1
    v_fma_f32 v168, -v73, v8, v168
    v_fma_f32 v169, -v73, v9, v169
    v_fma_f32 v170, -v73, v10, v170
    v_fma_f32 v171, -v73, v11, v171
    v_fma_f32 v172, -v73, v12, v172
    v_fma_f32 v173, -v73, v13, v173
    v_fma_f32 v174, -v73, v14, v174
    v_fma_f32 v175, -v73, v15, v175
    v_mul_f32 v88, v80, v77
    v_mul_f32 v168, v88, v168
    v_mul_f32 v169, v88, v169
    v_mul_f32 v170, v88, v170
    v_mul_f32 v171, v88, v171
    v_mul_f32 v172, v77, v172
    v_mul_f32 v173, v77, v173
    v_mul_f32 v174, v77, v174
    v_mul_f32 v175, v77, v175
    v_cvt_pk_bf16_f32 v100, v168, v169
    v_cvt_pk_bf16_f32 v101, v170, v171
    v_cvt_pk_bf16_f32 v102, v172, v173
    v_cvt_pk_bf16_f32 v103, v174, v175
    buffer_store_dword v100, v81, s[12:15], 0 offen offset:128 sc1
    buffer_store_dword v101, v82, s[12:15], 0 offen offset:128 sc1
    s_mov_b32 exec_hi, 0
    ds_write_b16 v87, v102 offset:1088
    ds_write_b16_d16_hi v87, v102 offset:1344
    ds_write_b16 v87, v103 offset:1600
    ds_write_b16_d16_hi v87, v103 offset:1856
    s_mov_b32 exec_hi, -1
    v_fma_f32 v184, -v74, v8, v184
    v_fma_f32 v185, -v74, v9, v185
    v_fma_f32 v186, -v74, v10, v186
    v_fma_f32 v187, -v74, v11, v187
    v_fma_f32 v188, -v74, v12, v188
    v_fma_f32 v189, -v74, v13, v189
    v_fma_f32 v190, -v74, v14, v190
    v_fma_f32 v191, -v74, v15, v191
    v_mul_f32 v88, v80, v78
    v_mul_f32 v184, v88, v184
    v_mul_f32 v185, v88, v185
    v_mul_f32 v186, v88, v186
    v_mul_f32 v187, v88, v187
    v_mul_f32 v188, v78, v188
    v_mul_f32 v189, v78, v189
    v_mul_f32 v190, v78, v190
    v_mul_f32 v191, v78, v191
    v_cvt_pk_bf16_f32 v104, v184, v185
    v_cvt_pk_bf16_f32 v105, v186, v187
    v_cvt_pk_bf16_f32 v106, v188, v189
    v_cvt_pk_bf16_f32 v107, v190, v191
    buffer_store_dword v104, v81, s[12:15], 0 offen offset:256 sc1
    buffer_store_dword v105, v82, s[12:15], 0 offen offset:256 sc1
    s_mov_b32 exec_hi, 0
    ds_write_b16 v87, v106 offset:1152
    ds_write_b16_d16_hi v87, v106 offset:1408
    ds_write_b16 v87, v107 offset:1664
    ds_write_b16_d16_hi v87, v107 offset:1920
    s_mov_b32 exec_hi, -1
    v_fma_f32 v200, -v75, v8, v200
    v_fma_f32 v201, -v75, v9, v201
    v_fma_f32 v202, -v75, v10, v202
    v_fma_f32 v203, -v75, v11, v203
    v_fma_f32 v204, -v75, v12, v204
    v_fma_f32 v205, -v75, v13, v205
    v_fma_f32 v206, -v75, v14, v206
    v_fma_f32 v207, -v75, v15, v207
    v_mul_f32 v88, v80, v79
    v_mul_f32 v200, v88, v200
    v_mul_f32 v201, v88, v201
    v_mul_f32 v202, v88, v202
    v_mul_f32 v203, v88, v203
    v_mul_f32 v204, v79, v204
    v_mul_f32 v205, v79, v205
    v_mul_f32 v206, v79, v206
    v_mul_f32 v207, v79, v207
    v_cvt_pk_bf16_f32 v108, v200, v201
    v_cvt_pk_bf16_f32 v109, v202, v203
    v_cvt_pk_bf16_f32 v110, v204, v205
    v_cvt_pk_bf16_f32 v111, v206, v207
    buffer_store_dword v108, v81, s[12:15], 0 offen offset:384 sc1
    buffer_store_dword v109, v82, s[12:15], 0 offen offset:384 sc1
    s_mov_b32 exec_hi, 0
    ds_write_b16 v87, v110 offset:1216
    ds_write_b16_d16_hi v87, v110 offset:1472
    ds_write_b16 v87, v111 offset:1728
    ds_write_b16_d16_hi v87, v111 offset:1984
    s_mov_b32 exec_hi, -1
    s_waitcnt lgkmcnt(0)
    ds_read_b128 v[112:115], v248 offset:1024
    v_lshrrev_b32 v85, 5, v1
    v_mul_u32_u24 v85, 155648, v85
    v_bfe_u32 v86, v1, 2, 2
    v_mul_u32_u24 v86, 2304, v86
    v_add_u32 v85, v85, v86
    v_bfe_u32 v86, v1, 1, 1
    v_mul_u32_u24 v86, 640, v86
    v_add_u32 v85, v85, v86
    v_and_b32 v86, 1, v1
    v_mul_u32_u24 v86, 320, v86
    v_add_u32 v85, v85, v86
    v_bfe_u32 v86, v1, 4, 1
    v_lshl_add_u32 v85, v86, 4, v85
    s_add_u32 s41, s39, 2304
    v_cmp_eq_u32 vcc, 0, v86
    v_mov_b32 v87, 0x3f803f80
    s_waitcnt lgkmcnt(0)
    buffer_store_dwordx4 v[112:115], v85, s[12:15], s41 offen sc1
    v_cndmask_b32 v116, 0, v87, vcc
    v_cndmask_b32 v117, 0, v87, vcc
    v_cndmask_b32 v118, 0, v87, vcc
    v_cndmask_b32 v119, 0, v87, vcc
    buffer_store_dwordx4 v[116:119], v85, s[12:15], s41 offen offset:32 sc1
    s_branch B_FIN
B_E2:
    v_lshlrev_b32 v80, 4, v250
    v_lshrrev_b32 v81, 4, v249
    v_mul_u32_u24 v81, 155648, v81
    v_mul_u32_u24 v82, 320, v250
    v_and_b32 v83, 15, v249
    v_lshl_add_u32 v82, v83, 4, v82
    v_add_u32 v81, v81, v82
    ds_read_b128 v[8:11], v80 offset:0
    ds_read_b128 v[24:27], v80 offset:512
    ds_read_b128 v[12:15], v80 offset:32
    ds_read_b128 v[28:31], v80 offset:544
    ds_read_b128 v[16:19], v80 offset:64
    ds_read_b128 v[32:35], v80 offset:576
    ds_read_b128 v[20:23], v80 offset:96
    ds_read_b128 v[36:39], v80 offset:608
    ds_read_b128 v[40:43], v80 offset:128
    ds_read_b128 v[56:59], v80 offset:640
    ds_read_b128 v[44:47], v80 offset:160
    ds_read_b128 v[60:63], v80 offset:672
    ds_read_b128 v[48:51], v80 offset:192
    ds_read_b128 v[64:67], v80 offset:704
    ds_read_b128 v[52:55], v80 offset:224
    ds_read_b128 v[68:71], v80 offset:736
    s_waitcnt lgkmcnt(8)
    v_fma_f32 v152, -v8, v84, v152
    v_fma_f32 v153, -v9, v84, v153
    v_fma_f32 v154, -v10, v84, v154
    v_fma_f32 v155, -v11, v84, v155
    v_fma_f32 v156, -v12, v84, v156
    v_fma_f32 v157, -v13, v84, v157
    v_fma_f32 v158, -v14, v84, v158
    v_fma_f32 v159, -v15, v84, v159
    v_fma_f32 v160, -v16, v84, v160
    v_fma_f32 v161, -v17, v84, v161
    v_fma_f32 v162, -v18, v84, v162
    v_fma_f32 v163, -v19, v84, v163
    v_fma_f32 v164, -v20, v84, v164
    v_fma_f32 v165, -v21, v84, v165
    v_fma_f32 v166, -v22, v84, v166
    v_fma_f32 v167, -v23, v84, v167
    v_mul_f32 v152, v24, v152
    v_mul_f32 v153, v25, v153
    v_mul_f32 v154, v26, v154
    v_mul_f32 v155, v27, v155
    v_mul_f32 v156, v28, v156
    v_mul_f32 v157, v29, v157
    v_mul_f32 v158, v30, v158
    v_mul_f32 v159, v31, v159
    v_mul_f32 v160, v32, v160
    v_mul_f32 v161, v33, v161
    v_mul_f32 v162, v34, v162
    v_mul_f32 v163, v35, v163
    v_mul_f32 v164, v36, v164
    v_mul_f32 v165, v37, v165
    v_mul_f32 v166, v38, v166
    v_mul_f32 v167, v39, v167
    v_cvt_pk_bf16_f32 v96, v152, v153
    v_cvt_pk_bf16_f32 v97, v154, v155
    v_cvt_pk_bf16_f32 v98, v156, v157
    v_cvt_pk_bf16_f32 v99, v158, v159
    s_add_u32 s46, s39, 2048
    buffer_store_dwordx4 v[96:99], v81, s[12:15], s46 offen sc1
    v_cvt_pk_bf16_f32 v100, v160, v161
    v_cvt_pk_bf16_f32 v101, v162, v163
    v_cvt_pk_bf16_f32 v102, v164, v165
    v_cvt_pk_bf16_f32 v103, v166, v167
    s_add_u32 s46, s39, 2688
    buffer_store_dwordx4 v[100:103], v81, s[12:15], s46 offen sc1
    ds_read_b128 v[8:11], v80 offset:256
    ds_read_b128 v[24:27], v80 offset:768
    ds_read_b128 v[12:15], v80 offset:288
    ds_read_b128 v[28:31], v80 offset:800
    ds_read_b128 v[16:19], v80 offset:320
    ds_read_b128 v[32:35], v80 offset:832
    ds_read_b128 v[20:23], v80 offset:352
    ds_read_b128 v[36:39], v80 offset:864
    s_waitcnt lgkmcnt(8)
    v_fma_f32 v168, -v40, v84, v168
    v_fma_f32 v169, -v41, v84, v169
    v_fma_f32 v170, -v42, v84, v170
    v_fma_f32 v171, -v43, v84, v171
    v_fma_f32 v172, -v44, v84, v172
    v_fma_f32 v173, -v45, v84, v173
    v_fma_f32 v174, -v46, v84, v174
    v_fma_f32 v175, -v47, v84, v175
    v_fma_f32 v176, -v48, v84, v176
    v_fma_f32 v177, -v49, v84, v177
    v_fma_f32 v178, -v50, v84, v178
    v_fma_f32 v179, -v51, v84, v179
    v_fma_f32 v180, -v52, v84, v180
    v_fma_f32 v181, -v53, v84, v181
    v_fma_f32 v182, -v54, v84, v182
    v_fma_f32 v183, -v55, v84, v183
    v_mul_f32 v168, v56, v168
    v_mul_f32 v169, v57, v169
    v_mul_f32 v170, v58, v170
    v_mul_f32 v171, v59, v171
    v_mul_f32 v172, v60, v172
    v_mul_f32 v173, v61, v173
    v_mul_f32 v174, v62, v174
    v_mul_f32 v175, v63, v175
    v_mul_f32 v176, v64, v176
    v_mul_f32 v177, v65, v177
    v_mul_f32 v178, v66, v178
    v_mul_f32 v179, v67, v179
    v_mul_f32 v180, v68, v180
    v_mul_f32 v181, v69, v181
    v_mul_f32 v182, v70, v182
    v_mul_f32 v183, v71, v183
    v_cvt_pk_bf16_f32 v104, v168, v169
    v_cvt_pk_bf16_f32 v105, v170, v171
    v_cvt_pk_bf16_f32 v106, v172, v173
    v_cvt_pk_bf16_f32 v107, v174, v175
    s_add_u32 s46, s39, 4352
    buffer_store_dwordx4 v[104:107], v81, s[12:15], s46 offen sc1
    v_cvt_pk_bf16_f32 v108, v176, v177
    v_cvt_pk_bf16_f32 v109, v178, v179
    v_cvt_pk_bf16_f32 v110, v180, v181
    v_cvt_pk_bf16_f32 v111, v182, v183
    s_add_u32 s46, s39, 4992
    buffer_store_dwordx4 v[108:111], v81, s[12:15], s46 offen sc1
    ds_read_b128 v[40:43], v80 offset:384
    ds_read_b128 v[56:59], v80 offset:896
    ds_read_b128 v[44:47], v80 offset:416
    ds_read_b128 v[60:63], v80 offset:928
    ds_read_b128 v[48:51], v80 offset:448
    ds_read_b128 v[64:67], v80 offset:960
    ds_read_b128 v[52:55], v80 offset:480
    ds_read_b128 v[68:71], v80 offset:992
    s_waitcnt lgkmcnt(8)
    v_fma_f32 v184, -v8, v84, v184
    v_fma_f32 v185, -v9, v84, v185
    v_fma_f32 v186, -v10, v84, v186
    v_fma_f32 v187, -v11, v84, v187
    v_fma_f32 v188, -v12, v84, v188
    v_fma_f32 v189, -v13, v84, v189
    v_fma_f32 v190, -v14, v84, v190
    v_fma_f32 v191, -v15, v84, v191
    v_fma_f32 v192, -v16, v84, v192
    v_fma_f32 v193, -v17, v84, v193
    v_fma_f32 v194, -v18, v84, v194
    v_fma_f32 v195, -v19, v84, v195
    v_fma_f32 v196, -v20, v84, v196
    v_fma_f32 v197, -v21, v84, v197
    v_fma_f32 v198, -v22, v84, v198
    v_fma_f32 v199, -v23, v84, v199
    v_mul_f32 v184, v24, v184
    v_mul_f32 v185, v25, v185
    v_mul_f32 v186, v26, v186
    v_mul_f32 v187, v27, v187
    v_mul_f32 v188, v28, v188
    v_mul_f32 v189, v29, v189
    v_mul_f32 v190, v30, v190
    v_mul_f32 v191, v31, v191
    v_mul_f32 v192, v32, v192
    v_mul_f32 v193, v33, v193
    v_mul_f32 v194, v34, v194
    v_mul_f32 v195, v35, v195
    v_mul_f32 v196, v36, v196
    v_mul_f32 v197, v37, v197
    v_mul_f32 v198, v38, v198
    v_mul_f32 v199, v39, v199
    v_cvt_pk_bf16_f32 v112, v184, v185
    v_cvt_pk_bf16_f32 v113, v186, v187
    v_cvt_pk_bf16_f32 v114, v188, v189
    v_cvt_pk_bf16_f32 v115, v190, v191
    s_add_u32 s46, s39, 6656
    buffer_store_dwordx4 v[112:115], v81, s[12:15], s46 offen sc1
    v_cvt_pk_bf16_f32 v116, v192, v193
    v_cvt_pk_bf16_f32 v117, v194, v195
    v_cvt_pk_bf16_f32 v118, v196, v197
    v_cvt_pk_bf16_f32 v119, v198, v199
    s_add_u32 s46, s39, 7296
    buffer_store_dwordx4 v[116:119], v81, s[12:15], s46 offen sc1
    s_waitcnt lgkmcnt(0)
    v_fma_f32 v200, -v40, v84, v200
    v_fma_f32 v201, -v41, v84, v201
    v_fma_f32 v202, -v42, v84, v202
    v_fma_f32 v203, -v43, v84, v203
    v_fma_f32 v204, -v44, v84, v204
    v_fma_f32 v205, -v45, v84, v205
    v_fma_f32 v206, -v46, v84, v206
    v_fma_f32 v207, -v47, v84, v207
    v_fma_f32 v208, -v48, v84, v208
    v_fma_f32 v209, -v49, v84, v209
    v_fma_f32 v210, -v50, v84, v210
    v_fma_f32 v211, -v51, v84, v211
    v_fma_f32 v212, -v52, v84, v212
    v_fma_f32 v213, -v53, v84, v213
    v_fma_f32 v214, -v54, v84, v214
    v_fma_f32 v215, -v55, v84, v215
    v_mul_f32 v200, v56, v200
    v_mul_f32 v201, v57, v201
    v_mul_f32 v202, v58, v202
    v_mul_f32 v203, v59, v203
    v_mul_f32 v204, v60, v204
    v_mul_f32 v205, v61, v205
    v_mul_f32 v206, v62, v206
    v_mul_f32 v207, v63, v207
    v_mul_f32 v208, v64, v208
    v_mul_f32 v209, v65, v209
    v_mul_f32 v210, v66, v210
    v_mul_f32 v211, v67, v211
    v_mul_f32 v212, v68, v212
    v_mul_f32 v213, v69, v213
    v_mul_f32 v214, v70, v214
    v_mul_f32 v215, v71, v215
    v_cvt_pk_bf16_f32 v120, v200, v201
    v_cvt_pk_bf16_f32 v121, v202, v203
    v_cvt_pk_bf16_f32 v122, v204, v205
    v_cvt_pk_bf16_f32 v123, v206, v207
    s_add_u32 s46, s39, 8960
    buffer_store_dwordx4 v[120:123], v81, s[12:15], s46 offen sc1
    v_cvt_pk_bf16_f32 v124, v208, v209
    v_cvt_pk_bf16_f32 v125, v210, v211
    v_cvt_pk_bf16_f32 v126, v212, v213
    v_cvt_pk_bf16_f32 v127, v214, v215
    s_add_u32 s46, s39, 9600
    buffer_store_dwordx4 v[124:127], v81, s[12:15], s46 offen sc1
B_FIN:
    s_lshl_b32 s30, s24, 6
    s_lshl_b32 s31, s23, 2
    s_add_u32 s30, s30, s31
    s_add_u32 s30, s30, s25
    s_lshl_b32 s30, s30, 7
    s_add_u32 s30, s30, 30523392
    s_waitcnt vmcnt(0)
    v_mov_b32 v80, s60
    v_mov_b32 v81, 0
    s_mov_b64 exec, 1
    buffer_store_dword v80, v81, s[12:15], s30 offen sc1
    s_mov_b64 exec, -1
    s_branch B_DONE
B_HELP:
    s_add_u32 s8, s6, 0x1a38000
    s_addc_u32 s9, s7, 0
    s_mov_b32 s10, 0x240000
    s_mov_b32 s11, 0x20000
    v_lshrrev_b32 v251, 3, v1
    s_lshl_b32 s30, s25, 5
    v_add_u32 v251, s30, v251
    v_mul_u32_u24 v251, 1152, v251
    v_lshrrev_b32 v252, 4, v1
    v_and_b32 v253, 7, v1
    v_xor_b32 v253, v253, v252
    v_lshl_add_u32 v8, v253, 4, v251
    v_xor_b32 v253, 4, v253
    v_lshl_add_u32 v9, v253, 4, v251
    s_lshl_b32 s34, s23, 11
    s_add_u32 s34, s34, 31178752
    v_and_b32 v2, 15, v1
    v_lshlrev_b32 v2, 7, v2
    buffer_load_dword v4, v2, s[12:15], s34 offen sc1
    s_waitcnt vmcnt(0)
    v_cmp_eq_u32 vcc, s60, v4
    s_nop 1
    s_cmp_eq_u64 vcc, -1
    s_cselect_b32 s36, 1, 0
    s_barrier
    s_cmp_lg_u32 s36, 0
    s_cbranch_scc1 B_F3_OK2
    s_mov_b32 s58, 0
B_F3:
    buffer_load_dword v4, v2, s[12:15], s34 offen sc1
    s_waitcnt vmcnt(0)
    v_cmp_eq_u32 vcc, s60, v4
    s_nop 1
    s_cmp_eq_u64 vcc, -1
    s_cbranch_scc1 B_F3_OK
    s_sleep 2
    s_add_u32 s58, s58, 1
    s_cmp_lt_u32 s58, 131072
    s_cbranch_scc1 B_F3
B_F3_OK:
B_F3_OK2:
    s_add_u32 s32, s27, 0
    s_sub_u32 s33, s32, 9
    s_cmp_ge_u32 s32, 9
    s_cselect_b32 s32, s33, s32
    s_lshl_b32 s32, s32, 7
    s_add_u32 s32, s32, s26
    s_add_u32 m0, s29, 2560
    s_add_u32 s31, s32, 0
    buffer_load_dwordx4 v8, s[8:11], s31 offen sc1 lds
    s_add_u32 m0, s29, 3584
    s_add_u32 s31, s32, 9216
    buffer_load_dwordx4 v9, s[8:11], s31 offen sc1 lds
    s_add_u32 m0, s29, 4608
    s_add_u32 s31, s32, 18432
    buffer_load_dwordx4 v8, s[8:11], s31 offen sc1 lds
    s_add_u32 m0, s29, 5632
    s_add_u32 s31, s32, 27648
    buffer_load_dwordx4 v9, s[8:11], s31 offen sc1 lds
    s_add_u32 s32, s27, 1
    s_sub_u32 s33, s32, 9
    s_cmp_ge_u32 s32, 9
    s_cselect_b32 s32, s33, s32
    s_lshl_b32 s32, s32, 7
    s_add_u32 s32, s32, s26
    s_add_u32 m0, s29, 18944
    s_add_u32 s31, s32, 0
    buffer_load_dwordx4 v8, s[8:11], s31 offen sc1 lds
    s_add_u32 m0, s29, 19968
    s_add_u32 s31, s32, 9216
    buffer_load_dwordx4 v9, s[8:11], s31 offen sc1 lds
    s_add_u32 m0, s29, 20992
    s_add_u32 s31, s32, 18432
    buffer_load_dwordx4 v8, s[8:11], s31 offen sc1 lds
    s_add_u32 m0, s29, 22016
    s_add_u32 s31, s32, 27648
    buffer_load_dwordx4 v9, s[8:11], s31 offen sc1 lds
    s_add_u32 s32, s27, 2
    s_sub_u32 s33, s32, 9
    s_cmp_ge_u32 s32, 9
    s_cselect_b32 s32, s33, s32
    s_lshl_b32 s32, s32, 7
    s_add_u32 s32, s32, s26
    s_add_u32 m0, s29, 35328
    s_add_u32 s31, s32, 0
    buffer_load_dwordx4 v8, s[8:11], s31 offen sc1 lds
    s_add_u32 m0, s29, 36352
    s_add_u32 s31, s32, 9216
    buffer_load_dwordx4 v9, s[8:11], s31 offen sc1 lds
    s_add_u32 m0, s29, 37376
    s_add_u32 s31, s32, 18432
    buffer_load_dwordx4 v8, s[8:11], s31 offen sc1 lds
    s_add_u32 m0, s29, 38400
    s_add_u32 s31, s32, 27648
    buffer_load_dwordx4 v9, s[8:11], s31 offen sc1 lds
    s_lshl_b32 s34, s23, 7
    s_lshl_b32 s35, s25, 5
    s_add_u32 s34, s34, s35
    s_lshl_b32 s34, s34, 6
    s_add_u32 s34, s34, 3227648
    v_lshlrev_b32 v29, 6, v249
    v_lshl_add_u32 v29, v250, 5, v29
    s_waitcnt vmcnt(8)
    s_barrier
    s_add_u32 s32, s27, 3
    s_sub_u32 s33, s32, 9
    s_cmp_ge_u32 s32, 9
    s_cselect_b32 s32, s33, s32
    s_lshl_b32 s32, s32, 7
    s_add_u32 s32, s32, s26
    s_add_u32 m0, s29, 51712
    s_add_u32 s31, s32, 0
    buffer_load_dwordx4 v8, s[8:11], s31 offen sc1 lds
    s_add_u32 m0, s29, 52736
    s_add_u32 s31, s32, 9216
    buffer_load_dwordx4 v9, s[8:11], s31 offen sc1 lds
    s_add_u32 m0, s29, 53760
    s_add_u32 s31, s32, 18432
    buffer_load_dwordx4 v8, s[8:11], s31 offen sc1 lds
    s_add_u32 m0, s29, 54784
    s_add_u32 s31, s32, 27648
    buffer_load_dwordx4 v9, s[8:11], s31 offen sc1 lds
    s_waitcnt vmcnt(8)
    s_barrier
    s_add_u32 s32, s27, 4
    s_sub_u32 s33, s32, 9
    s_cmp_ge_u32 s32, 9
    s_cselect_b32 s32, s33, s32
    s_lshl_b32 s32, s32, 7
    s_add_u32 s32, s32, s26
    s_add_u32 m0, s29, 68096
    s_add_u32 s31, s32, 0
    buffer_load_dwordx4 v8, s[8:11], s31 offen sc1 lds
    s_add_u32 m0, s29, 69120
    s_add_u32 s31, s32, 9216
    buffer_load_dwordx4 v9, s[8:11], s31 offen sc1 lds
    s_add_u32 m0, s29, 70144
    s_add_u32 s31, s32, 18432
    buffer_load_dwordx4 v8, s[8:11], s31 offen sc1 lds
    s_add_u32 m0, s29, 71168
    s_add_u32 s31, s32, 27648
    buffer_load_dwordx4 v9, s[8:11], s31 offen sc1 lds
    s_waitcnt vmcnt(8)
    s_barrier
    s_add_u32 s32, s27, 5
    s_sub_u32 s33, s32, 9
    s_cmp_ge_u32 s32, 9
    s_cselect_b32 s32, s33, s32
    s_lshl_b32 s32, s32, 7
    s_add_u32 s32, s32, s26
    s_add_u32 m0, s29, 84480
    s_add_u32 s31, s32, 0
    buffer_load_dwordx4 v8, s[8:11], s31 offen sc1 lds
    s_add_u32 m0, s29, 85504
    s_add_u32 s31, s32, 9216
    buffer_load_dwordx4 v9, s[8:11], s31 offen sc1 lds
    s_add_u32 m0, s29, 86528
    s_add_u32 s31, s32, 18432
    buffer_load_dwordx4 v8, s[8:11], s31 offen sc1 lds
    s_add_u32 m0, s29, 87552
    s_add_u32 s31, s32, 27648
    buffer_load_dwordx4 v9, s[8:11], s31 offen sc1 lds
    s_waitcnt vmcnt(8)
    s_barrier
    s_add_u32 s32, s27, 6
    s_sub_u32 s33, s32, 9
    s_cmp_ge_u32 s32, 9
    s_cselect_b32 s32, s33, s32
    s_lshl_b32 s32, s32, 7
    s_add_u32 s32, s32, s26
    s_add_u32 m0, s29, 100864
    s_add_u32 s31, s32, 0
    buffer_load_dwordx4 v8, s[8:11], s31 offen sc1 lds
    s_add_u32 m0, s29, 101888
    s_add_u32 s31, s32, 9216
    buffer_load_dwordx4 v9, s[8:11], s31 offen sc1 lds
    s_add_u32 m0, s29, 102912
    s_add_u32 s31, s32, 18432
    buffer_load_dwordx4 v8, s[8:11], s31 offen sc1 lds
    s_add_u32 m0, s29, 103936
    s_add_u32 s31, s32, 27648
    buffer_load_dwordx4 v9, s[8:11], s31 offen sc1 lds
    s_waitcnt vmcnt(8)
    s_barrier
    s_add_u32 s32, s27, 7
    s_sub_u32 s33, s32, 9
    s_cmp_ge_u32 s32, 9
    s_cselect_b32 s32, s33, s32
    s_lshl_b32 s32, s32, 7
    s_add_u32 s32, s32, s26
    s_add_u32 m0, s29, 117248
    s_add_u32 s31, s32, 0
    buffer_load_dwordx4 v8, s[8:11], s31 offen sc1 lds
    s_add_u32 m0, s29, 118272
    s_add_u32 s31, s32, 9216
    buffer_load_dwordx4 v9, s[8:11], s31 offen sc1 lds
    s_add_u32 m0, s29, 119296
    s_add_u32 s31, s32, 18432
    buffer_load_dwordx4 v8, s[8:11], s31 offen sc1 lds
    s_add_u32 m0, s29, 120320
    s_add_u32 s31, s32, 27648
    buffer_load_dwordx4 v9, s[8:11], s31 offen sc1 lds
    buffer_load_dwordx4 v[16:19], v29, s[12:15], s34 offen sc1
    buffer_load_dwordx4 v[20:23], v29, s[12:15], s34 offen offset:16 sc1
    s_waitcnt vmcnt(10)
    s_barrier
    s_add_u32 s32, s27, 8
    s_sub_u32 s33, s32, 9
    s_cmp_ge_u32 s32, 9
    s_cselect_b32 s32, s33, s32
    s_lshl_b32 s32, s32, 7
    s_add_u32 s32, s32, s26
    s_add_u32 m0, s29, 133632
    s_add_u32 s31, s32, 0
    buffer_load_dwordx4 v8, s[8:11], s31 offen sc1 lds
    s_add_u32 m0, s29, 134656
    s_add_u32 s31, s32, 9216
    buffer_load_dwordx4 v9, s[8:11], s31 offen sc1 lds
    s_add_u32 m0, s29, 135680
    s_add_u32 s31, s32, 18432
    buffer_load_dwordx4 v8, s[8:11], s31 offen sc1 lds
    s_add_u32 m0, s29, 136704
    s_add_u32 s31, s32, 27648
    buffer_load_dwordx4 v9, s[8:11], s31 offen sc1 lds
    s_waitcnt vmcnt(10)
    s_barrier
    s_waitcnt vmcnt(6)
    s_barrier
    s_waitcnt vmcnt(0)
    s_barrier
    s_waitcnt vmcnt(0)
    v_cmp_eq_u32 vcc, s60, v17
    v_cmp_eq_u32 s[56:57], s60, v19
    s_nop 1
    s_and_b64 vcc, vcc, s[56:57]
    v_cmp_eq_u32 s[56:57], s60, v21
    s_nop 1
    s_and_b64 vcc, vcc, s[56:57]
    v_cmp_eq_u32 s[56:57], s60, v23
    s_nop 1
    s_and_b64 vcc, vcc, s[56:57]
    s_nop 1
    s_cmp_eq_u64 vcc, -1
    s_cbranch_scc1 B_STOK
    s_mov_b32 s58, 0
B_ST:
    buffer_load_dwordx4 v[16:19], v29, s[12:15], s34 offen sc1
    buffer_load_dwordx4 v[20:23], v29, s[12:15], s34 offen offset:16 sc1
    s_waitcnt vmcnt(0)
    v_cmp_eq_u32 vcc, s60, v17
    v_cmp_eq_u32 s[56:57], s60, v19
    s_nop 1
    s_and_b64 vcc, vcc, s[56:57]
    v_cmp_eq_u32 s[56:57], s60, v21
    s_nop 1
    s_and_b64 vcc, vcc, s[56:57]
    v_cmp_eq_u32 s[56:57], s60, v23
    s_nop 1
    s_and_b64 vcc, vcc, s[56:57]
    s_nop 1
    s_cmp_eq_u64 vcc, -1
    s_cbranch_scc1 B_ST_OK
    s_sleep 2
    s_add_u32 s58, s58, 1
    s_cmp_lt_u32 s58, 131072
    s_cbranch_scc1 B_ST
B_ST_OK:
B_STOK:
    v_add_f32 v16, v16, v20
    v_add_f32 v18, v18, v22
    v_mov_b32 v20, v16
    s_nop 1
    v_permlane32_swap_b32 v16, v20
    s_nop 1
    v_add_f32 v16, v16, v20
    v_mov_b32 v20, v18
    s_nop 1
    v_permlane32_swap_b32 v18, v20
    s_nop 1
    v_add_f32 v18, v18, v20
    v_mul_f32 v16, 0x3ae38e39, v16
    v_mul_f32 v18, 0x3ae38e39, v18
    v_fma_f32 v18, -v16, v16, v18
    v_max_f32 v18, 0, v18
    v_add_f32 v18, 0x3727c5ac, v18
    v_rsq_f32 v18, v18
    s_lshl_b32 s30, s25, 7
    v_lshl_add_u32 v251, v249, 2, s30
    ds_write_b32 v251, v16 offset:0
    ds_write_b32 v251, v18 offset:512
    ds_write_b32 v251, v240 offset:2048
    s_waitcnt lgkmcnt(0)
    s_barrier
B_DONE:
    s_mov_b32 s61, 1
    s_mov_b32 s62, 4988928
    s_mov_b32 s63, 2097152
    s_mov_b32 s64, 262144
    s_branch M_ATT
M_FIN:
    s_cmp_lg_u32 s2, 0
    s_cbranch_scc1 M_FIN2
    s_cmp_lg_u32 s22, 0
    s_cbranch_scc1 M_FIN2
    s_mov_b32 s34, 31211520
    v_mov_b32 v52, s60
    v_mov_b32 v53, 0
    s_mov_b64 exec, 1
    buffer_store_dword v52, v53, s[12:15], s34 offen sc1
    s_mov_b64 exec, -1
M_FIN2:
    s_waitcnt vmcnt(0)
M_END:
    s_endpgm

.section .rodata,"a"
.p2align 6
.amdhsa_kernel interleave_layers__softmax_full_mha__ssm_conv_h3__prompt_kernel
  .amdhsa_next_free_vgpr 256
  .amdhsa_next_free_sgpr 102
  .amdhsa_accum_offset 256
  .amdhsa_group_segment_fixed_size 0
  .amdhsa_kernarg_size 96
  .amdhsa_user_sgpr_count 2
  .amdhsa_user_sgpr_kernarg_segment_ptr 1
  .amdhsa_system_sgpr_workgroup_id_x 1
.end_amdhsa_kernel
```
